```python
import torch

def _softmax(x, axis=-1):
    return torch.softmax(x, dim=axis)
def _gelu(x):
    return torch.nn.functional.gelu(x, approximate="tanh")
def _silu(x):
    return torch.nn.functional.silu(x)
def _sigmoid(x):
    return torch.sigmoid(x)
def _layernorm(x, axis=-1, eps=1e-5):
    m = x.mean(dim=axis, keepdim=True)
    v = x.var(dim=axis, keepdim=True, unbiased=False)
    return (x - m) / torch.sqrt(v + eps)
def _scatter_add(tgt, idx, src, axis=0):
    return tgt.clone().index_add_(axis, idx, src)
def _segment_sum(src, seg, n):
    out = torch.zeros((n,) + src.shape[1:], dtype=src.dtype)
    return out.index_add_(0, seg, src)
def _pad(x, pw):
    flat = tuple(v for pair in reversed(pw) for v in pair)
    return torch.nn.functional.pad(x, flat)

kernel_name = 'parallel_sum__linear_attn_block__dense_activation_silu__prompt'

def setup_inputs():

    _w = (lambda a: (lambda t: t.to(torch.bfloat16) if t.is_floating_point() else t)(torch.as_tensor(a)))
    def _A_setup():
        B, S, D = 1, 2048, 640
        return {
            "x": _w((lambda *s: torch.randn(*s, dtype=torch.bfloat16) * 0.05)(B, S, D)),
            "wqkv": _w((lambda *s: torch.randn(*s, dtype=torch.bfloat16) * 0.1)(D, 3 * D)),
            "wo": _w((lambda *s: torch.randn(*s, dtype=torch.bfloat16) * 0.05)(D, D)),
        }
    _A_in = _A_setup()

    def _B_setup():
        B, S, D, F = 1, 2048, 640, 1728
        return {
            "x": _w((lambda *s: torch.randn(*s, dtype=torch.bfloat16) * 0.05)(B, S, D)),
            "w1": _w((lambda *s: torch.randn(*s, dtype=torch.bfloat16) * 0.8)(D, F) * (D ** -0.5)),
            "w2": _w((lambda *s: torch.randn(*s, dtype=torch.bfloat16) * 0.1)(F, D) * (F ** -0.5)),
        }
    _B_in = _B_setup()

    return {
        "A_x": _A_in["x"],
        "A_wqkv": _A_in["wqkv"],
        "A_wo": _A_in["wo"],
        "B_x": _B_in["x"],
        "B_w1": _B_in["w1"],
        "B_w2": _B_in["w2"],
    }

def reference(A_x, A_wqkv, A_wo, B_x, B_w1, B_w2):
    def _A_ref(x, wqkv, wo):
        B, S, D = x.shape
        H = 32; Dh = D // H
        qkv = (lambda x, *d: x.permute(*d))((x @ wqkv).reshape(B, S, 3, H, Dh), 2, 0, 3, 1, 4)
        q, k, v = qkv[0], qkv[1], qkv[2]
        phi = lambda t: torch.where(t > 0, t + 1, torch.exp(t)) + 1e-6
        pq, pk = phi(q), phi(k)
        kv = torch.einsum("bhsd,bhse->bhde", pk, v)
        z = torch.einsum("bhsd->bhd", pk)
        num = torch.einsum("bhqd,bhde->bhqe", pq, kv)
        den = torch.einsum("bhqd,bhd->bhq", pq, z)[..., None] + 1e-6
        o = num / den
        return (lambda x, *d: x.permute(*d))(o, 0, 2, 1, 3).reshape(B, S, D) @ wo

    def _B_ref(x, w1, w2):
        h = torch.einsum("bsd,df->bsf", x, w1)
        h = _silu(h)
        out = torch.einsum("bsf,fd->bsd", h, w2)
        return out

    x = A_x
    xn = _layernorm(x, axis=-1)
    return x + _A_ref(xn, A_wqkv, A_wo) + _B_ref(xn, B_w1, B_w2)
```

```asm
; @launch grid=(256,1,1) block=(256,1,1) lds=163840
.amdgcn_target "amdgcn-amd-amdhsa--gfx950"
.text
.globl parallel_sum__linear_attn_block__dense_activation_silu__prompt_kernel
.p2align 12
.p2align 8
.type parallel_sum__linear_attn_block__dense_activation_silu__prompt_kernel,@function
parallel_sum__linear_attn_block__dense_activation_silu__prompt_kernel:
    s_cmp_ge_u32 s2, 256
    s_cbranch_scc1 L_end
    s_load_dwordx16 s[32:47], s[0:1], 0
    s_load_dwordx2 s[48:49], s[0:1], 64
    s_getpc_b64 s[28:29]
L_pc:
    v_lshlrev_b32 v14, 7, v0
    v_cmp_gt_u32 vcc, 36, v0
    v_mov_b32 v15, 1073741824
    s_mov_b32 s30, L_codeend-L_pc
    s_mov_b32 s31, 0x20000
    s_lshr_b32 s80, s2, 3
    v_cndmask_b32 v14, v15, v14, vcc
    s_xor_b32 s81, s80, 16
    s_mul_i32 s81, s81, 4608
    v_lshrrev_b32 v17, 6, v0
    buffer_load_dword v53, v14, s[28:31], s81 offen
    v_readfirstlane_b32 s64, v17
    v_and_b32 v0, 63, v0
    s_and_b32 s83, s2, 3
    s_lshl_b32 s83, s83, 2
    s_and_b32 s65, s80, 3
    s_add_u32 s65, s65, s83
    s_bfe_u32 s83, s2, 0x20005
    s_and_b32 s66, s2, 4
    s_add_u32 s66, s66, s83
    s_mul_i32 s92, s66, 10
    s_lshr_b32 s92, s92, 3
    s_mul_i32 s85, s65, 10
    s_lshr_b32 s85, s85, 4
    s_add_u32 s92, s92, s85
    s_sub_u32 s85, s92, 10
    s_min_u32 s92, s92, s85
    s_cmp_ge_u32 s2, 128
    s_cbranch_scc1 L_h0
    v_lshrrev_b32 v17, 3, v0
    v_lshrrev_b32 v18, 4, v0
    v_and_b32 v19, 7, v0
    s_lshl_b32 s85, s65, 2
    s_add_u32 s85, s85, s64
    v_xor_b32 v20, v19, v18
    v_lshlrev_b32 v20, 4, v20
    s_movk_i32 s86, 1280
    v_mad_u32_u24 v32, v17, s86, v20
    s_lshl_b32 s70, s92, 7
    v_xor_b32 v33, 64, v32
    v_add_u32 v34, 18432, v32
    v_add_u32 v35, 27648, v33
    v_add_u32 v33, 9216, v33
    s_lshl_b32 s71, s64, 12
    s_add_u32 s71, s71, 98304
    s_mov_b32 s6, 2621440
    s_mov_b32 s7, 0x20000
    s_waitcnt lgkmcnt(0)
    s_mov_b32 s4, s32
    s_mov_b32 s5, s33
    s_mul_i32 s0, s85, 40960
    s_add_u32 m0, s71, 0
    s_add_u32 s1, s70, s0
    buffer_load_dwordx4 v32, s[4:7], s1 offen offset:0 lds
    buffer_load_dwordx4 v33, s[4:7], s1 offen offset:1024 lds
    buffer_load_dwordx4 v34, s[4:7], s1 offen offset:2048 lds
    buffer_load_dwordx4 v35, s[4:7], s1 offen offset:3072 lds
    s_branch L_attn
L_h0:
    v_lshrrev_b32 v14, 4, v0
    v_lshlrev_b32 v17, 2, v14
    v_and_b32 v18, 15, v0
    v_xor_b32 v17, v17, v18
    v_lshlrev_b32 v17, 4, v17
    s_lshl_b32 s83, s64, 4
    v_add_u32 v14, s83, v14
    s_movk_i32 s89, 3456
    v_mad_u32_u24 v8, v14, s89, v17
    v_add_u32 v9, 12800, v8
    v_add_u32 v10, 25600, v8
    v_add_u32 v11, 38400, v8
    s_mul_i32 s50, s92, 221184
    s_lshl_b32 s72, s66, 8
    s_add_u32 s72, s72, s50
    s_lshl_b32 s73, s64, 12
    s_and_b32 s83, s66, 3
    s_lshl_b32 s84, s65, 2
    s_add_u32 s83, s83, s84
    s_lshl_b32 s83, s83, 2
    s_add_u32 s83, s83, s64
    s_mul_i32 s83, s83, 25
    v_add_u32 v14, s83, v0
    v_mul_u32_u24 v17, 6554, v14
    v_lshrrev_b32 v17, 16, v17
    v_mul_u32_u24 v18, 10, v17
    v_sub_u32 v14, v14, v18
    v_cmp_le_u32 vcc, 5, v14
    v_add_u32 v18, 5, v14
    s_nop 0
    v_cndmask_b32 v14, v14, v18, vcc
    v_mul_u32_u24 v17, 3840, v17
    v_lshl_add_u32 v14, v14, 7, v17
    v_cmp_gt_u32 vcc, 25, v0
    s_lshr_b32 s83, s66, 2
    s_mul_i32 s83, s83, 640
    s_add_u32 s83, s83, 1280
    v_cndmask_b32 v54, v15, v14, vcc
    s_waitcnt lgkmcnt(0)
    s_mov_b32 s24, s34
    s_mov_b32 s25, s35
    s_mov_b32 s26, 2457600
    s_mov_b32 s27, 0x20000
    buffer_load_dword v52, v54, s[24:27], s83 offen
    s_mov_b32 s8, s40
    s_mov_b32 s9, s41
    s_mov_b32 s10, 2211840
    s_mov_b32 s11, 0x20000
    s_add_u32 m0, s73, 0
    s_nop 0
    buffer_load_dwordx4 v8, s[8:11], s72 offen offset:0 lds
    buffer_load_dwordx4 v9, s[8:11], s72 offen offset:1024 lds
    buffer_load_dwordx4 v10, s[8:11], s72 offen offset:2048 lds
    buffer_load_dwordx4 v11, s[8:11], s72 offen offset:3072 lds
    s_branch L_h
.p2align 12
L_h:
    v_cmp_eq_u32 vcc, 0, v0
    v_lshlrev_b32 v1, 4, v0
    v_mov_b32 v30, 1073741824
    v_cndmask_b32 v30, v30, v0, vcc
    s_mov_b32 s12, s48
    s_mov_b32 s13, s49
    s_mov_b32 s14, 14680064
    s_mov_b32 s15, 0x20000
    s_cmp_ge_u32 s2, 144
    s_cbranch_scc1 L_noinit
    v_mov_b32 v22, 0
    v_mov_b32 v23, 0
    v_mov_b32 v24, 0
    v_mov_b32 v25, 0
    s_sub_u32 s3, s2, 128
    s_lshl_b32 s3, s3, 2
    s_add_u32 s3, s3, s64
    s_mul_i32 s81, s3, 3072
    s_add_u32 s81, s81, 13631488
    s_lshl_b32 s3, s3, 2
    buffer_store_dwordx4 v[22:25], v1, s[12:15], s81 offen offset:0 sc1
    buffer_store_dwordx4 v[22:25], v1, s[12:15], s81 offen offset:1024 sc1
    buffer_store_dwordx4 v[22:25], v1, s[12:15], s81 offen offset:2048 sc1
    s_nop 1
L_noinit:
    v_lshrrev_b32 v17, 3, v0
    v_lshrrev_b32 v18, 4, v0
    v_and_b32 v19, 7, v0
    s_lshl_b32 s85, s65, 2
    s_add_u32 s85, s85, s64
    v_xor_b32 v20, v19, v18
    v_lshlrev_b32 v20, 4, v20
    s_movk_i32 s86, 1280
    v_mad_u32_u24 v32, v17, s86, v20
    s_lshl_b32 s70, s92, 7
    v_xor_b32 v33, 64, v32
    v_add_u32 v34, 18432, v32
    v_add_u32 v35, 27648, v33
    v_add_u32 v33, 9216, v33
    s_lshl_b32 s71, s64, 12
    s_add_u32 s71, s71, 98304
    s_mov_b32 s6, 2621440
    s_mov_b32 s7, 0x20000
    s_mov_b32 s4, s32
    s_mov_b32 s5, s33
    s_mul_i32 s0, s85, 40960
    s_mov_b32 s74, 0x3f803f80
    v_mov_b32 v44, 0
    v_mov_b32 v45, 0
    v_mov_b32 v46, 0
    v_mov_b32 v47, 0
    v_and_b32 v17, 31, v0
    v_lshrrev_b32 v18, 5, v0
    v_bfe_u32 v19, v0, 1, 3
    v_xor_b32 v19, v19, v18
    v_lshlrev_b32 v19, 4, v19
    v_lshl_add_u32 v19, v17, 7, v19
    v_xor_b32 v40, 0, v19
    v_add_u32 v40, s71, v40
    v_xor_b32 v41, 32, v19
    v_add_u32 v41, s71, v41
    v_xor_b32 v42, 64, v19
    v_add_u32 v42, s71, v42
    v_xor_b32 v43, 96, v19
    v_add_u32 v43, s71, v43
    v_bfe_u32 v19, v0, 4, 1
    v_mul_u32_u24 v19, 76800, v19
    v_and_b32 v20, 15, v0
    v_lshl_add_u32 v19, v20, 4, v19
    v_lshl_add_u32 v13, v18, 8, v19
    s_mov_b32 s56, s48
    s_mov_b32 s57, s49
    s_mov_b32 s58, 14680064
    s_mov_b32 s59, 0x20000
    s_mov_b32 s20, s44
    s_mov_b32 s21, s45
    s_mov_b32 s22, 2621440
    s_mov_b32 s23, 0x20000
    s_mov_b32 s24, s46
    s_mov_b32 s25, s47
    s_mov_b32 s26, 256
    s_mov_b32 s27, 0x20000
    s_mov_b32 s75, 0xffff0000
    s_mov_b32 s76, 0x3fb8aa3b
    s_mov_b32 s77, 0x3f317218
    s_mov_b32 s78, 0x35c1a2a0
    s_and_b32 s67, s2, 7
    s_lshl_b32 s67, s67, 2
    s_bfe_u32 s81, s2, 0x20003
    s_add_u32 s67, s67, s81
    s_bfe_u32 s68, s2, 0x20005
    s_lshl_b32 s68, s68, 1
    s_and_b32 s81, s81, 1
    s_xor_b32 s81, s81, 1
    s_add_u32 s68, s68, s81
    s_lshl_b32 s80, s65, 3
    s_add_u32 s80, s80, s66
    s_mul_i32 s84, s80, 6
    s_add_u32 s84, s84, s64
    s_mul_i32 s86, s84, 863
    s_lshr_b32 s86, s86, 16
    s_mul_i32 s85, s86, 76
    s_sub_u32 s85, s84, s85
    s_mov_b32 s91, 819200
    s_sub_u32 s90, s85, 56
    s_cmp_lt_u32 s85, 56
    s_cselect_b32 s16, s42, s36
    s_cselect_b32 s17, s43, s37
    s_cselect_b32 s18, 2211840, s91
    s_cselect_b32 s90, s85, s90
    s_mov_b32 s19, 0x20000
    s_cmp_lt_u32 s84, 760
    s_cselect_b32 s18, s18, 0
    s_mul_i32 s90, s90, 40960
    s_lshl_b32 s91, s86, 7
    s_add_u32 s94, s90, s91
    s_mul_i32 s84, s80, 6
    s_add_u32 s84, s84, s64
    s_add_u32 s84, s84, 4
    s_cmp_lt_u32 s64, 2
    s_cselect_b32 s84, s84, 760
    s_mul_i32 s88, s84, 863
    s_lshr_b32 s88, s88, 16
    s_mul_i32 s87, s88, 76
    s_sub_u32 s87, s84, s87
    s_add_u32 m0, s71, 0
    s_add_u32 s1, s70, s0
    buffer_load_dwordx4 v32, s[4:7], s1 offen offset:0 lds
    buffer_load_dwordx4 v33, s[4:7], s1 offen offset:1024 lds
    buffer_load_dwordx4 v34, s[4:7], s1 offen offset:2048 lds
    buffer_load_dwordx4 v35, s[4:7], s1 offen offset:3072 lds
    s_mov_b32 s91, 819200
    s_sub_u32 s90, s87, 56
    s_cmp_lt_u32 s87, 56
    s_cselect_b32 s52, s42, s36
    s_cselect_b32 s53, s43, s37
    s_cselect_b32 s54, 2211840, s91
    s_cselect_b32 s90, s87, s90
    s_mov_b32 s55, 0x20000
    s_cmp_lt_u32 s84, 760
    s_cselect_b32 s54, s54, 0
    s_mul_i32 s90, s90, 40960
    s_lshl_b32 s91, s88, 7
    s_add_u32 s95, s90, s91
    s_lshl_b32 s83, s64, 4
    v_add_u32 v14, 0, v0
    v_mul_u32_u24 v15, 171, v14
    v_lshrrev_b32 v15, 11, v15
    v_mul_u32_u24 v17, 12, v15
    v_sub_u32 v14, v14, v17
    v_lshlrev_b32 v14, 4, v14
    v_add_u32 v15, s83, v15
    v_mad_u32_u24 v14, v15, s89, v14
    v_accvgpr_write_b32 a104, v14
    v_add_u32 v14, 64, v0
    v_mul_u32_u24 v15, 171, v14
    v_lshrrev_b32 v15, 11, v15
    v_mul_u32_u24 v17, 12, v15
    v_sub_u32 v14, v14, v17
    v_lshlrev_b32 v14, 4, v14
    v_add_u32 v15, s83, v15
    v_mad_u32_u24 v14, v15, s89, v14
    v_subrev_u32 v14, 1024, v14
    v_accvgpr_write_b32 a105, v14
    v_add_u32 v14, 128, v0
    v_mul_u32_u24 v15, 171, v14
    v_lshrrev_b32 v15, 11, v15
    v_mul_u32_u24 v17, 12, v15
    v_sub_u32 v14, v14, v17
    v_lshlrev_b32 v14, 4, v14
    v_add_u32 v15, s83, v15
    v_mad_u32_u24 v14, v15, s89, v14
    v_subrev_u32 v14, 2048, v14
    v_accvgpr_write_b32 a106, v14
    s_min_u32 s90, s86, 9
    s_lshl_b32 s90, s90, 4
    s_add_u32 s90, s90, L_tab-L_pc
    s_load_dwordx4 s[32:35], s[28:29], s90
    s_min_u32 s90, s88, 9
    s_lshl_b32 s90, s90, 4
    s_add_u32 s90, s90, L_tab-L_pc
    s_load_dwordx4 s[36:39], s[28:29], s90
    v_bfe_u32 v14, v0, 2, 3
    v_lshrrev_b32 v15, 1, v0
    v_and_b32 v15, 4, v15
    v_lshrrev_b32 v16, 3, v0
    v_and_or_b32 v15, v16, 2, v15
    v_and_or_b32 v15, v14, 1, v15
    v_lshrrev_b32 v16, 5, v0
    v_bfe_u32 v17, v0, 1, 1
    v_and_b32 v18, 1, v0
    s_cmp_lt_u32 s85, 56
    s_cselect_b64 vcc, -1, 0
    s_add_u32 s90, s71, 32768
    v_cndmask_b32 v19, v15, v14, vcc
    v_lshrrev_b32 v20, 1, v19
    v_xor_b32 v20, v20, v17
    v_lshl_add_u32 v19, v16, 4, v19
    v_lshlrev_b32 v19, 7, v19
    v_lshl_add_u32 v19, v20, 4, v19
    v_lshl_add_u32 v19, v18, 3, v19
    v_xor_b32 v22, 0, v19
    v_add_u32 v22, s90, v22
    v_xor_b32 v23, 32, v19
    v_add_u32 v23, s90, v23
    v_xor_b32 v24, 64, v19
    v_add_u32 v24, s90, v24
    v_xor_b32 v25, 96, v19
    v_add_u32 v25, s90, v25
    s_mul_i32 s85, s85, 5120
    s_cmp_lt_u32 s86, 10
    s_cselect_b32 s85, s85, 1073741824
    s_cmp_lt_u32 s87, 56
    s_cselect_b64 vcc, -1, 0
    s_add_u32 s90, s71, 49152
    v_cndmask_b32 v19, v15, v14, vcc
    v_lshrrev_b32 v20, 1, v19
    v_xor_b32 v20, v20, v17
    v_lshl_add_u32 v19, v16, 4, v19
    v_lshlrev_b32 v19, 7, v19
    v_lshl_add_u32 v19, v20, 4, v19
    v_lshl_add_u32 v19, v18, 3, v19
    v_xor_b32 v26, 0, v19
    v_add_u32 v26, s90, v26
    v_xor_b32 v27, 32, v19
    v_add_u32 v27, s90, v27
    v_xor_b32 v28, 64, v19
    v_add_u32 v28, s90, v28
    v_xor_b32 v29, 96, v19
    v_add_u32 v29, s90, v29
    s_mul_i32 s87, s87, 5120
    s_cmp_lt_u32 s88, 10
    s_cselect_b32 s87, s87, 1073741824
    s_lshl_b32 s47, s80, 5
    s_add_u32 s47, s47, s64
    s_lshl_b32 s47, s47, 2
    s_add_u32 s47, s47, 13729792
    s_mul_i32 s80, s66, 192
    s_add_u32 s50, s50, s80
    s_add_u32 s50, s50, 2048
    s_mul_i32 s51, s64, 3072
    s_lshl_b32 s80, s65, 2
    s_add_u32 s80, s80, s64
    s_mul_i32 s80, s80, 153600
    s_mul_i32 s42, s66, 4096
    s_add_u32 s42, s42, s80
    s_add_u32 s42, s42, 0
    s_mul_i32 s43, s66, 3072
    s_add_u32 s43, s43, s80
    s_add_u32 s43, s43, 32768
    s_lshl_b32 s80, s65, 2
    s_and_b32 s81, s64, 2
    s_add_u32 s80, s80, s81
    s_lshl_b32 s80, s80, 1
    s_lshr_b32 s81, s66, 1
    s_add_u32 s80, s80, s81
    s_lshl_b32 s80, s80, 7
    s_add_u32 s45, s80, 13762560
    s_mul_i32 s80, s68, 5
    s_lshr_b32 s80, s80, 2
    s_mul_i32 s80, s80, 76
    s_lshl_b32 s81, s64, 3
    s_add_u32 s80, s80, s81
    s_lshl_b32 s81, s64, 1
    s_sub_u32 s81, 24, s81
    s_sub_u32 s82, 18, s64
    v_lshrrev_b32 v14, 1, v0
    v_min_u32 v14, 18, v14
    v_mov_b32 v15, s81
    v_cmp_le_u32 vcc, 8, v14
    v_mov_b32 v16, s82
    s_nop 0
    v_cndmask_b32 v15, 0, v15, vcc
    v_cmp_le_u32 vcc, 14, v14
    v_add3_u32 v14, v14, v15, s80
    v_and_b32 v15, 1, v0
    v_cndmask_b32 v16, 0, v16, vcc
    v_mul_u32_u24 v15, 76, v15
    v_add3_u32 v14, v14, v15, v16
    v_mul_u32_u24 v15, 10923, v14
    v_lshrrev_b32 v15, 16, v15
    v_lshl_add_u32 v14, v15, 1, v14
    s_add_u32 m0, s71, 16384
    s_add_u32 s70, s70, 128
    s_sub_u32 s93, s70, 1280
    s_min_u32 s70, s70, s93
    s_add_u32 s1, s70, s0
    buffer_load_dwordx4 v32, s[4:7], s1 offen offset:0 lds
    buffer_load_dwordx4 v33, s[4:7], s1 offen offset:1024 lds
    buffer_load_dwordx4 v34, s[4:7], s1 offen offset:2048 lds
    buffer_load_dwordx4 v35, s[4:7], s1 offen offset:3072 lds
    s_add_u32 m0, s71, 32768
    s_add_u32 s70, s70, 128
    s_sub_u32 s93, s70, 1280
    s_min_u32 s70, s70, s93
    s_add_u32 s1, s70, s0
    buffer_load_dwordx4 v32, s[4:7], s1 offen offset:0 lds
    buffer_load_dwordx4 v33, s[4:7], s1 offen offset:1024 lds
    buffer_load_dwordx4 v34, s[4:7], s1 offen offset:2048 lds
    buffer_load_dwordx4 v35, s[4:7], s1 offen offset:3072 lds
    s_waitcnt vmcnt(8)
    ds_read_b128 v[96:99], v40 offset:0
    ds_read_b128 v[100:103], v41 offset:0
    ds_read_b128 v[104:107], v42 offset:0
    ds_read_b128 v[108:111], v43 offset:0
    v_and_b32 v14, 3, v14
    v_lshl_add_u32 v14, v15, 5, v14
    v_lshlrev_b32 v14, 2, v14
    v_add_u32 v14, 13729792, v14
    v_accvgpr_write_b32 a111, v14
    s_mul_i32 s49, s68, 389120
    s_mul_i32 s80, s64, 40960
    s_add_u32 s49, s49, s80
    s_add_u32 s49, s49, 10485760
    s_cmp_eq_u32 s66, 7
    s_cselect_b32 s44, 1073741824, s43
    v_lshrrev_b32 v14, 5, v0
    v_bfe_u32 v15, v0, 2, 2
    s_waitcnt lgkmcnt(0)
    v_dot2c_f32_bf16 v44, s74, v96
    v_dot2c_f32_bf16 v46, v96, v96
    v_dot2c_f32_bf16 v45, s74, v97
    v_dot2c_f32_bf16 v47, v97, v97
    v_dot2c_f32_bf16 v44, s74, v98
    v_dot2c_f32_bf16 v46, v98, v98
    v_dot2c_f32_bf16 v45, s74, v99
    v_dot2c_f32_bf16 v47, v99, v99
    v_dot2c_f32_bf16 v44, s74, v100
    v_dot2c_f32_bf16 v46, v100, v100
    v_dot2c_f32_bf16 v45, s74, v101
    v_dot2c_f32_bf16 v47, v101, v101
    v_dot2c_f32_bf16 v44, s74, v102
    v_dot2c_f32_bf16 v46, v102, v102
    v_dot2c_f32_bf16 v45, s74, v103
    v_dot2c_f32_bf16 v47, v103, v103
    v_dot2c_f32_bf16 v44, s74, v104
    v_dot2c_f32_bf16 v46, v104, v104
    v_dot2c_f32_bf16 v45, s74, v105
    v_dot2c_f32_bf16 v47, v105, v105
    v_dot2c_f32_bf16 v44, s74, v106
    v_dot2c_f32_bf16 v46, v106, v106
    v_dot2c_f32_bf16 v45, s74, v107
    v_dot2c_f32_bf16 v47, v107, v107
    v_dot2c_f32_bf16 v44, s74, v108
    v_dot2c_f32_bf16 v46, v108, v108
    v_dot2c_f32_bf16 v45, s74, v109
    v_dot2c_f32_bf16 v47, v109, v109
    v_dot2c_f32_bf16 v44, s74, v110
    v_dot2c_f32_bf16 v46, v110, v110
    v_dot2c_f32_bf16 v45, s74, v111
    v_dot2c_f32_bf16 v47, v111, v111
    s_add_u32 m0, s71, 49152
    s_add_u32 s70, s70, 128
    s_sub_u32 s93, s70, 1280
    s_min_u32 s70, s70, s93
    s_add_u32 s1, s70, s0
    buffer_load_dwordx4 v32, s[4:7], s1 offen offset:0 lds
    buffer_load_dwordx4 v33, s[4:7], s1 offen offset:1024 lds
    buffer_load_dwordx4 v34, s[4:7], s1 offen offset:2048 lds
    buffer_load_dwordx4 v35, s[4:7], s1 offen offset:3072 lds
    s_waitcnt vmcnt(8)
    ds_read_b128 v[112:115], v40 offset:16384
    ds_read_b128 v[116:119], v41 offset:16384
    ds_read_b128 v[120:123], v42 offset:16384
    ds_read_b128 v[124:127], v43 offset:16384
    v_mov_b32 v49, 1
    s_cmp_ge_u32 s2, 144
    s_cbranch_scc1 L_nomark
    buffer_store_dword v49, v30, s[24:27], s3 offen sc1
L_nomark:
    v_lshl_add_u32 v14, v14, 3, v15
    v_mul_u32_u24 v14, 192, v14
    v_bfe_u32 v16, v0, 4, 1
    v_lshl_add_u32 v14, v16, 5, v14
    v_and_b32 v16, 3, v0
    v_lshl_add_u32 v12, v16, 3, v14
    v_lshrrev_b32 v14, 5, v0
    v_bfe_u32 v15, v0, 2, 2
    v_lshl_add_u32 v14, v14, 3, v15
    v_mul_u32_u24 v14, 256, v14
    v_bfe_u32 v16, v0, 4, 1
    v_lshl_add_u32 v14, v16, 5, v14
    v_and_b32 v16, 3, v0
    s_waitcnt lgkmcnt(3)
    v_dot2c_f32_bf16 v44, s74, v112
    v_dot2c_f32_bf16 v46, v112, v112
    v_dot2c_f32_bf16 v45, s74, v113
    v_dot2c_f32_bf16 v47, v113, v113
    v_dot2c_f32_bf16 v44, s74, v114
    v_dot2c_f32_bf16 v46, v114, v114
    v_dot2c_f32_bf16 v45, s74, v115
    v_dot2c_f32_bf16 v47, v115, v115
    s_waitcnt lgkmcnt(2)
    v_dot2c_f32_bf16 v44, s74, v116
    v_dot2c_f32_bf16 v46, v116, v116
    v_dot2c_f32_bf16 v45, s74, v117
    v_dot2c_f32_bf16 v47, v117, v117
    v_dot2c_f32_bf16 v44, s74, v118
    v_dot2c_f32_bf16 v46, v118, v118
    v_dot2c_f32_bf16 v45, s74, v119
    v_dot2c_f32_bf16 v47, v119, v119
    s_waitcnt lgkmcnt(1)
    v_dot2c_f32_bf16 v44, s74, v120
    v_dot2c_f32_bf16 v46, v120, v120
    v_dot2c_f32_bf16 v45, s74, v121
    v_dot2c_f32_bf16 v47, v121, v121
    v_dot2c_f32_bf16 v44, s74, v122
    v_dot2c_f32_bf16 v46, v122, v122
    v_dot2c_f32_bf16 v45, s74, v123
    v_dot2c_f32_bf16 v47, v123, v123
    s_waitcnt lgkmcnt(0)
    v_dot2c_f32_bf16 v44, s74, v124
    v_dot2c_f32_bf16 v46, v124, v124
    v_dot2c_f32_bf16 v45, s74, v125
    v_dot2c_f32_bf16 v47, v125, v125
    v_dot2c_f32_bf16 v44, s74, v126
    v_dot2c_f32_bf16 v46, v126, v126
    v_dot2c_f32_bf16 v45, s74, v127
    v_dot2c_f32_bf16 v47, v127, v127
    s_add_u32 m0, s71, 0
    s_add_u32 s70, s70, 128
    s_sub_u32 s93, s70, 1280
    s_min_u32 s70, s70, s93
    s_add_u32 s1, s70, s0
    buffer_load_dwordx4 v32, s[4:7], s1 offen offset:0 lds
    buffer_load_dwordx4 v33, s[4:7], s1 offen offset:1024 lds
    buffer_load_dwordx4 v34, s[4:7], s1 offen offset:2048 lds
    buffer_load_dwordx4 v35, s[4:7], s1 offen offset:3072 lds
    s_waitcnt vmcnt(8)
    ds_read_b128 v[128:131], v40 offset:32768
    ds_read_b128 v[132:135], v41 offset:32768
    ds_read_b128 v[136:139], v42 offset:32768
    ds_read_b128 v[140:143], v43 offset:32768
    v_lshl_add_u32 v17, v16, 3, v14
    v_xor_b32 v16, 0, v15
    v_lshl_add_u32 v4, v16, 6, v17
    v_xor_b32 v16, 1, v15
    v_lshl_add_u32 v5, v16, 6, v17
    v_xor_b32 v16, 2, v15
    v_lshl_add_u32 v6, v16, 6, v17
    v_xor_b32 v16, 3, v15
    v_lshl_add_u32 v7, v16, 6, v17
    s_add_u32 s32, s32, s85
    s_add_u32 s33, s33, s85
    s_add_u32 s34, s34, s85
    s_add_u32 s35, s35, s85
    s_waitcnt lgkmcnt(3)
    v_dot2c_f32_bf16 v44, s74, v128
    v_dot2c_f32_bf16 v46, v128, v128
    v_dot2c_f32_bf16 v45, s74, v129
    v_dot2c_f32_bf16 v47, v129, v129
    v_dot2c_f32_bf16 v44, s74, v130
    v_dot2c_f32_bf16 v46, v130, v130
    v_dot2c_f32_bf16 v45, s74, v131
    v_dot2c_f32_bf16 v47, v131, v131
    s_waitcnt lgkmcnt(2)
    v_dot2c_f32_bf16 v44, s74, v132
    v_dot2c_f32_bf16 v46, v132, v132
    v_dot2c_f32_bf16 v45, s74, v133
    v_dot2c_f32_bf16 v47, v133, v133
    v_dot2c_f32_bf16 v44, s74, v134
    v_dot2c_f32_bf16 v46, v134, v134
    v_dot2c_f32_bf16 v45, s74, v135
    v_dot2c_f32_bf16 v47, v135, v135
    s_waitcnt lgkmcnt(1)
    v_dot2c_f32_bf16 v44, s74, v136
    v_dot2c_f32_bf16 v46, v136, v136
    v_dot2c_f32_bf16 v45, s74, v137
    v_dot2c_f32_bf16 v47, v137, v137
    v_dot2c_f32_bf16 v44, s74, v138
    v_dot2c_f32_bf16 v46, v138, v138
    v_dot2c_f32_bf16 v45, s74, v139
    v_dot2c_f32_bf16 v47, v139, v139
    s_waitcnt lgkmcnt(0)
    v_dot2c_f32_bf16 v44, s74, v140
    v_dot2c_f32_bf16 v46, v140, v140
    v_dot2c_f32_bf16 v45, s74, v141
    v_dot2c_f32_bf16 v47, v141, v141
    v_dot2c_f32_bf16 v44, s74, v142
    v_dot2c_f32_bf16 v46, v142, v142
    v_dot2c_f32_bf16 v45, s74, v143
    v_dot2c_f32_bf16 v47, v143, v143
    s_add_u32 m0, s71, 16384
    s_add_u32 s70, s70, 128
    s_sub_u32 s93, s70, 1280
    s_min_u32 s70, s70, s93
    s_add_u32 s1, s70, s0
    buffer_load_dwordx4 v32, s[4:7], s1 offen offset:0 lds
    buffer_load_dwordx4 v33, s[4:7], s1 offen offset:1024 lds
    buffer_load_dwordx4 v34, s[4:7], s1 offen offset:2048 lds
    buffer_load_dwordx4 v35, s[4:7], s1 offen offset:3072 lds
    s_waitcnt vmcnt(8)
    ds_read_b128 v[144:147], v40 offset:49152
    ds_read_b128 v[148:151], v41 offset:49152
    ds_read_b128 v[152:155], v42 offset:49152
    ds_read_b128 v[156:159], v43 offset:49152
    s_add_u32 s36, s36, s87
    s_add_u32 s37, s37, s87
    s_add_u32 s38, s38, s87
    s_add_u32 s39, s39, s87
    s_mul_i32 s80, s64, 8192
    s_mul_i32 s81, s64, 8192
    s_add_u32 s81, s81, 4096
    s_mul_i32 s82, s64, 8192
    s_add_u32 s82, s82, 2048
    s_mul_i32 s83, s64, 8192
    s_add_u32 s83, s83, 6144
    s_mul_i32 s84, s64, 6144
    s_waitcnt lgkmcnt(3)
    v_dot2c_f32_bf16 v44, s74, v144
    v_dot2c_f32_bf16 v46, v144, v144
    v_dot2c_f32_bf16 v45, s74, v145
    v_dot2c_f32_bf16 v47, v145, v145
    v_dot2c_f32_bf16 v44, s74, v146
    v_dot2c_f32_bf16 v46, v146, v146
    v_dot2c_f32_bf16 v45, s74, v147
    v_dot2c_f32_bf16 v47, v147, v147
    s_waitcnt lgkmcnt(2)
    v_dot2c_f32_bf16 v44, s74, v148
    v_dot2c_f32_bf16 v46, v148, v148
    v_dot2c_f32_bf16 v45, s74, v149
    v_dot2c_f32_bf16 v47, v149, v149
    v_dot2c_f32_bf16 v44, s74, v150
    v_dot2c_f32_bf16 v46, v150, v150
    v_dot2c_f32_bf16 v45, s74, v151
    v_dot2c_f32_bf16 v47, v151, v151
    s_waitcnt lgkmcnt(1)
    v_dot2c_f32_bf16 v44, s74, v152
    v_dot2c_f32_bf16 v46, v152, v152
    v_dot2c_f32_bf16 v45, s74, v153
    v_dot2c_f32_bf16 v47, v153, v153
    v_dot2c_f32_bf16 v44, s74, v154
    v_dot2c_f32_bf16 v46, v154, v154
    v_dot2c_f32_bf16 v45, s74, v155
    v_dot2c_f32_bf16 v47, v155, v155
    s_waitcnt lgkmcnt(0)
    v_dot2c_f32_bf16 v44, s74, v156
    v_dot2c_f32_bf16 v46, v156, v156
    v_dot2c_f32_bf16 v45, s74, v157
    v_dot2c_f32_bf16 v47, v157, v157
    v_dot2c_f32_bf16 v44, s74, v158
    v_dot2c_f32_bf16 v46, v158, v158
    v_dot2c_f32_bf16 v45, s74, v159
    v_dot2c_f32_bf16 v47, v159, v159
    s_add_u32 m0, s71, 32768
    s_add_u32 s70, s70, 128
    s_sub_u32 s93, s70, 1280
    s_min_u32 s70, s70, s93
    s_add_u32 s1, s70, s0
    buffer_load_dwordx4 v32, s[4:7], s1 offen offset:0 lds
    buffer_load_dwordx4 v33, s[4:7], s1 offen offset:1024 lds
    buffer_load_dwordx4 v34, s[4:7], s1 offen offset:2048 lds
    buffer_load_dwordx4 v35, s[4:7], s1 offen offset:3072 lds
    s_waitcnt vmcnt(8)
    ds_read_b128 v[160:163], v40 offset:0
    ds_read_b128 v[164:167], v41 offset:0
    ds_read_b128 v[168:171], v42 offset:0
    ds_read_b128 v[172:175], v43 offset:0
    s_add_u32 s84, s84, 32768
    s_mul_i32 s85, s64, 6144
    s_add_u32 s85, s85, 36864
    s_mul_i32 s86, s64, 5120
    s_add_u32 s86, s86, 55296
    s_mul_i32 s87, s64, 5120
    s_add_u32 s87, s87, 59392
    s_cmp_eq_u32 s64, 3
    s_cselect_b32 s85, 1073741824, s85
    s_cselect_b32 s58, 0, s14
    s_mul_i32 s28, s64, -10240
    s_add_u32 s28, s28, 122880
    s_waitcnt lgkmcnt(3)
    v_dot2c_f32_bf16 v44, s74, v160
    v_dot2c_f32_bf16 v46, v160, v160
    v_dot2c_f32_bf16 v45, s74, v161
    v_dot2c_f32_bf16 v47, v161, v161
    v_dot2c_f32_bf16 v44, s74, v162
    v_dot2c_f32_bf16 v46, v162, v162
    v_dot2c_f32_bf16 v45, s74, v163
    v_dot2c_f32_bf16 v47, v163, v163
    s_waitcnt lgkmcnt(2)
    v_dot2c_f32_bf16 v44, s74, v164
    v_dot2c_f32_bf16 v46, v164, v164
    v_dot2c_f32_bf16 v45, s74, v165
    v_dot2c_f32_bf16 v47, v165, v165
    v_dot2c_f32_bf16 v44, s74, v166
    v_dot2c_f32_bf16 v46, v166, v166
    v_dot2c_f32_bf16 v45, s74, v167
    v_dot2c_f32_bf16 v47, v167, v167
    s_waitcnt lgkmcnt(1)
    v_dot2c_f32_bf16 v44, s74, v168
    v_dot2c_f32_bf16 v46, v168, v168
    v_dot2c_f32_bf16 v45, s74, v169
    v_dot2c_f32_bf16 v47, v169, v169
    v_dot2c_f32_bf16 v44, s74, v170
    v_dot2c_f32_bf16 v46, v170, v170
    v_dot2c_f32_bf16 v45, s74, v171
    v_dot2c_f32_bf16 v47, v171, v171
    s_waitcnt lgkmcnt(0)
    v_dot2c_f32_bf16 v44, s74, v172
    v_dot2c_f32_bf16 v46, v172, v172
    v_dot2c_f32_bf16 v45, s74, v173
    v_dot2c_f32_bf16 v47, v173, v173
    v_dot2c_f32_bf16 v44, s74, v174
    v_dot2c_f32_bf16 v46, v174, v174
    v_dot2c_f32_bf16 v45, s74, v175
    v_dot2c_f32_bf16 v47, v175, v175
    s_add_u32 m0, s71, 49152
    s_add_u32 s70, s70, 128
    s_sub_u32 s93, s70, 1280
    s_min_u32 s70, s70, s93
    s_add_u32 s1, s70, s0
    buffer_load_dwordx4 v32, s[4:7], s1 offen offset:0 lds
    buffer_load_dwordx4 v33, s[4:7], s1 offen offset:1024 lds
    buffer_load_dwordx4 v34, s[4:7], s1 offen offset:2048 lds
    buffer_load_dwordx4 v35, s[4:7], s1 offen offset:3072 lds
    s_waitcnt vmcnt(8)
    ds_read_b128 v[176:179], v40 offset:16384
    ds_read_b128 v[180:183], v41 offset:16384
    ds_read_b128 v[184:187], v42 offset:16384
    ds_read_b128 v[188:191], v43 offset:16384
    s_mul_i32 s29, s64, -5120
    s_add_u32 s29, s29, 92160
    s_lshl_b32 s89, s67, 2
    s_add_u32 s89, s89, s64
    s_mul_i32 s89, s89, 20480
    s_mul_i32 s90, s68, 160
    s_add_u32 s89, s89, s90
    s_lshl_b32 s88, s67, 2
    s_add_u32 s88, s88, s64
    s_lshl_b32 s88, s88, 7
    s_add_u32 s88, s88, 13762560
    s_lshl_b32 s91, s67, 2
    s_waitcnt lgkmcnt(3)
    v_dot2c_f32_bf16 v44, s74, v176
    v_dot2c_f32_bf16 v46, v176, v176
    v_dot2c_f32_bf16 v45, s74, v177
    v_dot2c_f32_bf16 v47, v177, v177
    v_dot2c_f32_bf16 v44, s74, v178
    v_dot2c_f32_bf16 v46, v178, v178
    v_dot2c_f32_bf16 v45, s74, v179
    v_dot2c_f32_bf16 v47, v179, v179
    s_waitcnt lgkmcnt(2)
    v_dot2c_f32_bf16 v44, s74, v180
    v_dot2c_f32_bf16 v46, v180, v180
    v_dot2c_f32_bf16 v45, s74, v181
    v_dot2c_f32_bf16 v47, v181, v181
    v_dot2c_f32_bf16 v44, s74, v182
    v_dot2c_f32_bf16 v46, v182, v182
    v_dot2c_f32_bf16 v45, s74, v183
    v_dot2c_f32_bf16 v47, v183, v183
    s_waitcnt lgkmcnt(1)
    v_dot2c_f32_bf16 v44, s74, v184
    v_dot2c_f32_bf16 v46, v184, v184
    v_dot2c_f32_bf16 v45, s74, v185
    v_dot2c_f32_bf16 v47, v185, v185
    v_dot2c_f32_bf16 v44, s74, v186
    v_dot2c_f32_bf16 v46, v186, v186
    v_dot2c_f32_bf16 v45, s74, v187
    v_dot2c_f32_bf16 v47, v187, v187
    s_waitcnt lgkmcnt(0)
    v_dot2c_f32_bf16 v44, s74, v188
    v_dot2c_f32_bf16 v46, v188, v188
    v_dot2c_f32_bf16 v45, s74, v189
    v_dot2c_f32_bf16 v47, v189, v189
    v_dot2c_f32_bf16 v44, s74, v190
    v_dot2c_f32_bf16 v46, v190, v190
    v_dot2c_f32_bf16 v45, s74, v191
    v_dot2c_f32_bf16 v47, v191, v191
    s_add_u32 m0, s71, 0
    s_add_u32 s70, s70, 128
    s_sub_u32 s93, s70, 1280
    s_min_u32 s70, s70, s93
    s_add_u32 s1, s70, s0
    buffer_load_dwordx4 v32, s[4:7], s1 offen offset:0 lds
    buffer_load_dwordx4 v33, s[4:7], s1 offen offset:1024 lds
    buffer_load_dwordx4 v34, s[4:7], s1 offen offset:2048 lds
    buffer_load_dwordx4 v35, s[4:7], s1 offen offset:3072 lds
    s_waitcnt vmcnt(8)
    ds_read_b128 v[192:195], v40 offset:32768
    ds_read_b128 v[196:199], v41 offset:32768
    ds_read_b128 v[200:203], v42 offset:32768
    ds_read_b128 v[204:207], v43 offset:32768
    s_add_u32 s90, s64, 1
    s_and_b32 s90, s90, 3
    s_add_u32 s90, s90, s91
    s_mul_i32 s90, s90, 76800
    v_add_u32 v14, s90, v1
    v_accvgpr_write_b32 a248, v14
    s_add_u32 s90, s64, 2
    s_and_b32 s90, s90, 3
    s_add_u32 s90, s90, s91
    s_mul_i32 s90, s90, 76800
    v_add_u32 v14, s90, v1
    v_accvgpr_write_b32 a249, v14
    s_waitcnt lgkmcnt(3)
    v_dot2c_f32_bf16 v44, s74, v192
    v_dot2c_f32_bf16 v46, v192, v192
    v_dot2c_f32_bf16 v45, s74, v193
    v_dot2c_f32_bf16 v47, v193, v193
    v_dot2c_f32_bf16 v44, s74, v194
    v_dot2c_f32_bf16 v46, v194, v194
    v_dot2c_f32_bf16 v45, s74, v195
    v_dot2c_f32_bf16 v47, v195, v195
    s_waitcnt lgkmcnt(2)
    v_dot2c_f32_bf16 v44, s74, v196
    v_dot2c_f32_bf16 v46, v196, v196
    v_dot2c_f32_bf16 v45, s74, v197
    v_dot2c_f32_bf16 v47, v197, v197
    v_dot2c_f32_bf16 v44, s74, v198
    v_dot2c_f32_bf16 v46, v198, v198
    v_dot2c_f32_bf16 v45, s74, v199
    v_dot2c_f32_bf16 v47, v199, v199
    s_waitcnt lgkmcnt(1)
    v_dot2c_f32_bf16 v44, s74, v200
    v_dot2c_f32_bf16 v46, v200, v200
    v_dot2c_f32_bf16 v45, s74, v201
    v_dot2c_f32_bf16 v47, v201, v201
    v_dot2c_f32_bf16 v44, s74, v202
    v_dot2c_f32_bf16 v46, v202, v202
    v_dot2c_f32_bf16 v45, s74, v203
    v_dot2c_f32_bf16 v47, v203, v203
    s_waitcnt lgkmcnt(0)
    v_dot2c_f32_bf16 v44, s74, v204
    v_dot2c_f32_bf16 v46, v204, v204
    v_dot2c_f32_bf16 v45, s74, v205
    v_dot2c_f32_bf16 v47, v205, v205
    v_dot2c_f32_bf16 v44, s74, v206
    v_dot2c_f32_bf16 v46, v206, v206
    v_dot2c_f32_bf16 v45, s74, v207
    v_dot2c_f32_bf16 v47, v207, v207
    s_add_u32 m0, s71, 16384
    s_add_u32 s70, s70, 128
    s_sub_u32 s93, s70, 1280
    s_min_u32 s70, s70, s93
    s_add_u32 s1, s70, s0
    buffer_load_dwordx4 v32, s[4:7], s1 offen offset:0 lds
    buffer_load_dwordx4 v33, s[4:7], s1 offen offset:1024 lds
    buffer_load_dwordx4 v34, s[4:7], s1 offen offset:2048 lds
    buffer_load_dwordx4 v35, s[4:7], s1 offen offset:3072 lds
    s_waitcnt vmcnt(8)
    ds_read_b128 v[208:211], v40 offset:49152
    ds_read_b128 v[212:215], v41 offset:49152
    ds_read_b128 v[216:219], v42 offset:49152
    ds_read_b128 v[220:223], v43 offset:49152
    s_add_u32 s90, s64, 3
    s_and_b32 s90, s90, 3
    s_add_u32 s90, s90, s91
    s_mul_i32 s90, s90, 76800
    v_add_u32 v14, s90, v1
    v_accvgpr_write_b32 a250, v14
    s_add_u32 s90, s64, 4
    s_and_b32 s90, s90, 3
    s_add_u32 s90, s90, s91
    s_mul_i32 s90, s90, 76800
    v_add_u32 v14, s90, v1
    v_accvgpr_write_b32 a251, v14
    s_waitcnt lgkmcnt(3)
    v_dot2c_f32_bf16 v44, s74, v208
    v_dot2c_f32_bf16 v46, v208, v208
    v_dot2c_f32_bf16 v45, s74, v209
    v_dot2c_f32_bf16 v47, v209, v209
    v_dot2c_f32_bf16 v44, s74, v210
    v_dot2c_f32_bf16 v46, v210, v210
    v_dot2c_f32_bf16 v45, s74, v211
    v_dot2c_f32_bf16 v47, v211, v211
    s_waitcnt lgkmcnt(2)
    v_dot2c_f32_bf16 v44, s74, v212
    v_dot2c_f32_bf16 v46, v212, v212
    v_dot2c_f32_bf16 v45, s74, v213
    v_dot2c_f32_bf16 v47, v213, v213
    v_dot2c_f32_bf16 v44, s74, v214
    v_dot2c_f32_bf16 v46, v214, v214
    v_dot2c_f32_bf16 v45, s74, v215
    v_dot2c_f32_bf16 v47, v215, v215
    s_waitcnt lgkmcnt(1)
    v_dot2c_f32_bf16 v44, s74, v216
    v_dot2c_f32_bf16 v46, v216, v216
    v_dot2c_f32_bf16 v45, s74, v217
    v_dot2c_f32_bf16 v47, v217, v217
    v_dot2c_f32_bf16 v44, s74, v218
    v_dot2c_f32_bf16 v46, v218, v218
    v_dot2c_f32_bf16 v45, s74, v219
    v_dot2c_f32_bf16 v47, v219, v219
    s_waitcnt lgkmcnt(0)
    v_dot2c_f32_bf16 v44, s74, v220
    v_dot2c_f32_bf16 v46, v220, v220
    v_dot2c_f32_bf16 v45, s74, v221
    v_dot2c_f32_bf16 v47, v221, v221
    v_dot2c_f32_bf16 v44, s74, v222
    v_dot2c_f32_bf16 v46, v222, v222
    v_dot2c_f32_bf16 v45, s74, v223
    v_dot2c_f32_bf16 v47, v223, v223
    s_add_u32 s72, s72, 221184
    s_sub_u32 s93, s72, 2211840
    s_min_u32 s72, s72, s93
    s_add_u32 m0, s73, 16384
    s_nop 0
    buffer_load_dwordx4 v8, s[8:11], s72 offen offset:0 lds
    buffer_load_dwordx4 v9, s[8:11], s72 offen offset:1024 lds
    buffer_load_dwordx4 v10, s[8:11], s72 offen offset:2048 lds
    buffer_load_dwordx4 v11, s[8:11], s72 offen offset:3072 lds
    s_waitcnt vmcnt(8)
    ds_read_b128 v[224:227], v40 offset:0
    ds_read_b128 v[228:231], v41 offset:0
    ds_read_b128 v[232:235], v42 offset:0
    ds_read_b128 v[236:239], v43 offset:0
    s_waitcnt lgkmcnt(3)
    v_dot2c_f32_bf16 v44, s74, v224
    v_dot2c_f32_bf16 v46, v224, v224
    v_dot2c_f32_bf16 v45, s74, v225
    v_dot2c_f32_bf16 v47, v225, v225
    v_dot2c_f32_bf16 v44, s74, v226
    v_dot2c_f32_bf16 v46, v226, v226
    v_dot2c_f32_bf16 v45, s74, v227
    v_dot2c_f32_bf16 v47, v227, v227
    s_waitcnt lgkmcnt(2)
    v_dot2c_f32_bf16 v44, s74, v228
    v_dot2c_f32_bf16 v46, v228, v228
    v_dot2c_f32_bf16 v45, s74, v229
    v_dot2c_f32_bf16 v47, v229, v229
    v_dot2c_f32_bf16 v44, s74, v230
    v_dot2c_f32_bf16 v46, v230, v230
    v_dot2c_f32_bf16 v45, s74, v231
    v_dot2c_f32_bf16 v47, v231, v231
    s_waitcnt lgkmcnt(1)
    v_dot2c_f32_bf16 v44, s74, v232
    v_dot2c_f32_bf16 v46, v232, v232
    v_dot2c_f32_bf16 v45, s74, v233
    v_dot2c_f32_bf16 v47, v233, v233
    v_dot2c_f32_bf16 v44, s74, v234
    v_dot2c_f32_bf16 v46, v234, v234
    v_dot2c_f32_bf16 v45, s74, v235
    v_dot2c_f32_bf16 v47, v235, v235
    s_waitcnt lgkmcnt(0)
    v_dot2c_f32_bf16 v44, s74, v236
    v_dot2c_f32_bf16 v46, v236, v236
    v_dot2c_f32_bf16 v45, s74, v237
    v_dot2c_f32_bf16 v47, v237, v237
    v_dot2c_f32_bf16 v44, s74, v238
    v_dot2c_f32_bf16 v46, v238, v238
    v_dot2c_f32_bf16 v45, s74, v239
    v_dot2c_f32_bf16 v47, v239, v239
    s_add_u32 s72, s72, 221184
    s_sub_u32 s93, s72, 2211840
    s_min_u32 s72, s72, s93
    s_add_u32 m0, s73, 32768
    s_nop 0
    buffer_load_dwordx4 v8, s[8:11], s72 offen offset:0 lds
    buffer_load_dwordx4 v9, s[8:11], s72 offen offset:1024 lds
    buffer_load_dwordx4 v10, s[8:11], s72 offen offset:2048 lds
    buffer_load_dwordx4 v11, s[8:11], s72 offen offset:3072 lds
    s_waitcnt vmcnt(8)
    ds_read_b128 v[240:243], v40 offset:16384
    ds_read_b128 v[244:247], v41 offset:16384
    ds_read_b128 v[248:251], v42 offset:16384
    ds_read_b128 v[252:255], v43 offset:16384
    s_waitcnt lgkmcnt(3)
    v_dot2c_f32_bf16 v44, s74, v240
    v_dot2c_f32_bf16 v46, v240, v240
    v_dot2c_f32_bf16 v45, s74, v241
    v_dot2c_f32_bf16 v47, v241, v241
    v_dot2c_f32_bf16 v44, s74, v242
    v_dot2c_f32_bf16 v46, v242, v242
    v_dot2c_f32_bf16 v45, s74, v243
    v_dot2c_f32_bf16 v47, v243, v243
    s_waitcnt lgkmcnt(2)
    v_dot2c_f32_bf16 v44, s74, v244
    v_dot2c_f32_bf16 v46, v244, v244
    v_dot2c_f32_bf16 v45, s74, v245
    v_dot2c_f32_bf16 v47, v245, v245
    v_dot2c_f32_bf16 v44, s74, v246
    v_dot2c_f32_bf16 v46, v246, v246
    v_dot2c_f32_bf16 v45, s74, v247
    v_dot2c_f32_bf16 v47, v247, v247
    s_waitcnt lgkmcnt(1)
    v_dot2c_f32_bf16 v44, s74, v248
    v_dot2c_f32_bf16 v46, v248, v248
    v_dot2c_f32_bf16 v45, s74, v249
    v_dot2c_f32_bf16 v47, v249, v249
    v_dot2c_f32_bf16 v44, s74, v250
    v_dot2c_f32_bf16 v46, v250, v250
    v_dot2c_f32_bf16 v45, s74, v251
    v_dot2c_f32_bf16 v47, v251, v251
    s_waitcnt lgkmcnt(0)
    v_dot2c_f32_bf16 v44, s74, v252
    v_dot2c_f32_bf16 v46, v252, v252
    v_dot2c_f32_bf16 v45, s74, v253
    v_dot2c_f32_bf16 v47, v253, v253
    v_dot2c_f32_bf16 v44, s74, v254
    v_dot2c_f32_bf16 v46, v254, v254
    v_dot2c_f32_bf16 v45, s74, v255
    v_dot2c_f32_bf16 v47, v255, v255
    s_nop 1
    v_add_f32 v44, v44, v45
    v_add_f32 v46, v46, v47
    v_mov_b32 v45, v44
    v_mov_b32 v47, v46
    s_nop 0
    v_permlane32_swap_b32 v44, v45
    v_permlane32_swap_b32 v46, v47
    v_add_f32 v44, v44, v45
    v_add_f32 v46, v46, v47
    v_mul_f32 v44, 0x3acccccd, v44
    v_mul_f32 v46, 0x3acccccd, v46
    v_fma_f32 v46, -v44, v44, v46
    v_max_f32 v46, 0, v46
    v_add_f32 v46, 0x3727c5ac, v46
    v_rsq_f32 v2, v46
    s_nop 0
    v_mul_f32 v2, s76, v2
    v_mul_f32_e64 v3, -v44, v2
    v_lshlrev_b32 v14, 16, v96
    v_and_b32 v15, s75, v96
    v_lshlrev_b32 v16, 16, v97
    v_and_b32 v17, s75, v97
    v_pk_fma_f32 v[14:15], v[14:15], v[2:3], v[2:3] op_sel:[0,0,1] op_sel_hi:[1,0,1]
    v_pk_fma_f32 v[16:17], v[16:17], v[2:3], v[2:3] op_sel:[0,0,1] op_sel_hi:[1,0,1]
    v_cvt_pk_bf16_f32 v96, v14, v15
    v_cvt_pk_bf16_f32 v97, v16, v17
    v_lshlrev_b32 v14, 16, v98
    v_and_b32 v15, s75, v98
    v_lshlrev_b32 v16, 16, v99
    v_and_b32 v17, s75, v99
    v_pk_fma_f32 v[14:15], v[14:15], v[2:3], v[2:3] op_sel:[0,0,1] op_sel_hi:[1,0,1]
    v_pk_fma_f32 v[16:17], v[16:17], v[2:3], v[2:3] op_sel:[0,0,1] op_sel_hi:[1,0,1]
    v_cvt_pk_bf16_f32 v98, v14, v15
    v_cvt_pk_bf16_f32 v99, v16, v17
    v_lshlrev_b32 v14, 16, v100
    v_and_b32 v15, s75, v100
    v_lshlrev_b32 v16, 16, v101
    v_and_b32 v17, s75, v101
    v_pk_fma_f32 v[14:15], v[14:15], v[2:3], v[2:3] op_sel:[0,0,1] op_sel_hi:[1,0,1]
    v_pk_fma_f32 v[16:17], v[16:17], v[2:3], v[2:3] op_sel:[0,0,1] op_sel_hi:[1,0,1]
    v_cvt_pk_bf16_f32 v100, v14, v15
    v_cvt_pk_bf16_f32 v101, v16, v17
    v_lshlrev_b32 v14, 16, v102
    v_and_b32 v15, s75, v102
    v_lshlrev_b32 v16, 16, v103
    v_and_b32 v17, s75, v103
    v_pk_fma_f32 v[14:15], v[14:15], v[2:3], v[2:3] op_sel:[0,0,1] op_sel_hi:[1,0,1]
    v_pk_fma_f32 v[16:17], v[16:17], v[2:3], v[2:3] op_sel:[0,0,1] op_sel_hi:[1,0,1]
    v_cvt_pk_bf16_f32 v102, v14, v15
    v_cvt_pk_bf16_f32 v103, v16, v17
    v_lshlrev_b32 v14, 16, v104
    v_and_b32 v15, s75, v104
    v_lshlrev_b32 v16, 16, v105
    v_and_b32 v17, s75, v105
    v_pk_fma_f32 v[14:15], v[14:15], v[2:3], v[2:3] op_sel:[0,0,1] op_sel_hi:[1,0,1]
    v_pk_fma_f32 v[16:17], v[16:17], v[2:3], v[2:3] op_sel:[0,0,1] op_sel_hi:[1,0,1]
    v_cvt_pk_bf16_f32 v104, v14, v15
    v_cvt_pk_bf16_f32 v105, v16, v17
    v_lshlrev_b32 v14, 16, v106
    v_and_b32 v15, s75, v106
    v_lshlrev_b32 v16, 16, v107
    v_and_b32 v17, s75, v107
    v_pk_fma_f32 v[14:15], v[14:15], v[2:3], v[2:3] op_sel:[0,0,1] op_sel_hi:[1,0,1]
    v_pk_fma_f32 v[16:17], v[16:17], v[2:3], v[2:3] op_sel:[0,0,1] op_sel_hi:[1,0,1]
    v_cvt_pk_bf16_f32 v106, v14, v15
    v_cvt_pk_bf16_f32 v107, v16, v17
    v_lshlrev_b32 v14, 16, v108
    v_and_b32 v15, s75, v108
    v_lshlrev_b32 v16, 16, v109
    v_and_b32 v17, s75, v109
    v_pk_fma_f32 v[14:15], v[14:15], v[2:3], v[2:3] op_sel:[0,0,1] op_sel_hi:[1,0,1]
    v_pk_fma_f32 v[16:17], v[16:17], v[2:3], v[2:3] op_sel:[0,0,1] op_sel_hi:[1,0,1]
    v_cvt_pk_bf16_f32 v108, v14, v15
    v_cvt_pk_bf16_f32 v109, v16, v17
    v_lshlrev_b32 v14, 16, v110
    v_and_b32 v15, s75, v110
    v_lshlrev_b32 v16, 16, v111
    v_and_b32 v17, s75, v111
    v_pk_fma_f32 v[14:15], v[14:15], v[2:3], v[2:3] op_sel:[0,0,1] op_sel_hi:[1,0,1]
    v_pk_fma_f32 v[16:17], v[16:17], v[2:3], v[2:3] op_sel:[0,0,1] op_sel_hi:[1,0,1]
    v_cvt_pk_bf16_f32 v110, v14, v15
    v_cvt_pk_bf16_f32 v111, v16, v17
    v_lshlrev_b32 v14, 16, v112
    v_and_b32 v15, s75, v112
    v_lshlrev_b32 v16, 16, v113
    v_and_b32 v17, s75, v113
    v_pk_fma_f32 v[14:15], v[14:15], v[2:3], v[2:3] op_sel:[0,0,1] op_sel_hi:[1,0,1]
    v_pk_fma_f32 v[16:17], v[16:17], v[2:3], v[2:3] op_sel:[0,0,1] op_sel_hi:[1,0,1]
    v_cvt_pk_bf16_f32 v112, v14, v15
    v_cvt_pk_bf16_f32 v113, v16, v17
    v_lshlrev_b32 v14, 16, v114
    v_and_b32 v15, s75, v114
    v_lshlrev_b32 v16, 16, v115
    v_and_b32 v17, s75, v115
    v_pk_fma_f32 v[14:15], v[14:15], v[2:3], v[2:3] op_sel:[0,0,1] op_sel_hi:[1,0,1]
    v_pk_fma_f32 v[16:17], v[16:17], v[2:3], v[2:3] op_sel:[0,0,1] op_sel_hi:[1,0,1]
    v_cvt_pk_bf16_f32 v114, v14, v15
    v_cvt_pk_bf16_f32 v115, v16, v17
    v_lshlrev_b32 v14, 16, v116
    v_and_b32 v15, s75, v116
    v_lshlrev_b32 v16, 16, v117
    v_and_b32 v17, s75, v117
    v_pk_fma_f32 v[14:15], v[14:15], v[2:3], v[2:3] op_sel:[0,0,1] op_sel_hi:[1,0,1]
    v_pk_fma_f32 v[16:17], v[16:17], v[2:3], v[2:3] op_sel:[0,0,1] op_sel_hi:[1,0,1]
    v_cvt_pk_bf16_f32 v116, v14, v15
    v_cvt_pk_bf16_f32 v117, v16, v17
    v_lshlrev_b32 v14, 16, v118
    v_and_b32 v15, s75, v118
    v_lshlrev_b32 v16, 16, v119
    v_and_b32 v17, s75, v119
    v_pk_fma_f32 v[14:15], v[14:15], v[2:3], v[2:3] op_sel:[0,0,1] op_sel_hi:[1,0,1]
    v_pk_fma_f32 v[16:17], v[16:17], v[2:3], v[2:3] op_sel:[0,0,1] op_sel_hi:[1,0,1]
    v_cvt_pk_bf16_f32 v118, v14, v15
    v_cvt_pk_bf16_f32 v119, v16, v17
    v_lshlrev_b32 v14, 16, v120
    v_and_b32 v15, s75, v120
    v_lshlrev_b32 v16, 16, v121
    v_and_b32 v17, s75, v121
    v_pk_fma_f32 v[14:15], v[14:15], v[2:3], v[2:3] op_sel:[0,0,1] op_sel_hi:[1,0,1]
    v_pk_fma_f32 v[16:17], v[16:17], v[2:3], v[2:3] op_sel:[0,0,1] op_sel_hi:[1,0,1]
    v_cvt_pk_bf16_f32 v120, v14, v15
    v_cvt_pk_bf16_f32 v121, v16, v17
    v_lshlrev_b32 v14, 16, v122
    v_and_b32 v15, s75, v122
    v_lshlrev_b32 v16, 16, v123
    v_and_b32 v17, s75, v123
    v_pk_fma_f32 v[14:15], v[14:15], v[2:3], v[2:3] op_sel:[0,0,1] op_sel_hi:[1,0,1]
    v_pk_fma_f32 v[16:17], v[16:17], v[2:3], v[2:3] op_sel:[0,0,1] op_sel_hi:[1,0,1]
    v_cvt_pk_bf16_f32 v122, v14, v15
    v_cvt_pk_bf16_f32 v123, v16, v17
    v_lshlrev_b32 v14, 16, v124
    v_and_b32 v15, s75, v124
    v_lshlrev_b32 v16, 16, v125
    v_and_b32 v17, s75, v125
    v_pk_fma_f32 v[14:15], v[14:15], v[2:3], v[2:3] op_sel:[0,0,1] op_sel_hi:[1,0,1]
    v_pk_fma_f32 v[16:17], v[16:17], v[2:3], v[2:3] op_sel:[0,0,1] op_sel_hi:[1,0,1]
    v_cvt_pk_bf16_f32 v124, v14, v15
    v_cvt_pk_bf16_f32 v125, v16, v17
    v_lshlrev_b32 v14, 16, v126
    v_and_b32 v15, s75, v126
    v_lshlrev_b32 v16, 16, v127
    v_and_b32 v17, s75, v127
    v_pk_fma_f32 v[14:15], v[14:15], v[2:3], v[2:3] op_sel:[0,0,1] op_sel_hi:[1,0,1]
    v_pk_fma_f32 v[16:17], v[16:17], v[2:3], v[2:3] op_sel:[0,0,1] op_sel_hi:[1,0,1]
    v_cvt_pk_bf16_f32 v126, v14, v15
    v_cvt_pk_bf16_f32 v127, v16, v17
    v_lshlrev_b32 v14, 16, v128
    v_and_b32 v15, s75, v128
    v_lshlrev_b32 v16, 16, v129
    v_and_b32 v17, s75, v129
    v_pk_fma_f32 v[14:15], v[14:15], v[2:3], v[2:3] op_sel:[0,0,1] op_sel_hi:[1,0,1]
    v_pk_fma_f32 v[16:17], v[16:17], v[2:3], v[2:3] op_sel:[0,0,1] op_sel_hi:[1,0,1]
    v_cvt_pk_bf16_f32 v128, v14, v15
    v_cvt_pk_bf16_f32 v129, v16, v17
    v_lshlrev_b32 v14, 16, v130
    v_and_b32 v15, s75, v130
    v_lshlrev_b32 v16, 16, v131
    v_and_b32 v17, s75, v131
    v_pk_fma_f32 v[14:15], v[14:15], v[2:3], v[2:3] op_sel:[0,0,1] op_sel_hi:[1,0,1]
    v_pk_fma_f32 v[16:17], v[16:17], v[2:3], v[2:3] op_sel:[0,0,1] op_sel_hi:[1,0,1]
    v_cvt_pk_bf16_f32 v130, v14, v15
    v_cvt_pk_bf16_f32 v131, v16, v17
    v_lshlrev_b32 v14, 16, v132
    v_and_b32 v15, s75, v132
    v_lshlrev_b32 v16, 16, v133
    v_and_b32 v17, s75, v133
    v_pk_fma_f32 v[14:15], v[14:15], v[2:3], v[2:3] op_sel:[0,0,1] op_sel_hi:[1,0,1]
    v_pk_fma_f32 v[16:17], v[16:17], v[2:3], v[2:3] op_sel:[0,0,1] op_sel_hi:[1,0,1]
    v_cvt_pk_bf16_f32 v132, v14, v15
    v_cvt_pk_bf16_f32 v133, v16, v17
    v_lshlrev_b32 v14, 16, v134
    v_and_b32 v15, s75, v134
    v_lshlrev_b32 v16, 16, v135
    v_and_b32 v17, s75, v135
    v_pk_fma_f32 v[14:15], v[14:15], v[2:3], v[2:3] op_sel:[0,0,1] op_sel_hi:[1,0,1]
    v_pk_fma_f32 v[16:17], v[16:17], v[2:3], v[2:3] op_sel:[0,0,1] op_sel_hi:[1,0,1]
    v_cvt_pk_bf16_f32 v134, v14, v15
    v_cvt_pk_bf16_f32 v135, v16, v17
    v_lshlrev_b32 v14, 16, v136
    v_and_b32 v15, s75, v136
    v_lshlrev_b32 v16, 16, v137
    v_and_b32 v17, s75, v137
    v_pk_fma_f32 v[14:15], v[14:15], v[2:3], v[2:3] op_sel:[0,0,1] op_sel_hi:[1,0,1]
    v_pk_fma_f32 v[16:17], v[16:17], v[2:3], v[2:3] op_sel:[0,0,1] op_sel_hi:[1,0,1]
    v_cvt_pk_bf16_f32 v136, v14, v15
    v_cvt_pk_bf16_f32 v137, v16, v17
    v_lshlrev_b32 v14, 16, v138
    v_and_b32 v15, s75, v138
    v_lshlrev_b32 v16, 16, v139
    v_and_b32 v17, s75, v139
    v_pk_fma_f32 v[14:15], v[14:15], v[2:3], v[2:3] op_sel:[0,0,1] op_sel_hi:[1,0,1]
    v_pk_fma_f32 v[16:17], v[16:17], v[2:3], v[2:3] op_sel:[0,0,1] op_sel_hi:[1,0,1]
    v_cvt_pk_bf16_f32 v138, v14, v15
    v_cvt_pk_bf16_f32 v139, v16, v17
    v_lshlrev_b32 v14, 16, v140
    v_and_b32 v15, s75, v140
    v_lshlrev_b32 v16, 16, v141
    v_and_b32 v17, s75, v141
    v_pk_fma_f32 v[14:15], v[14:15], v[2:3], v[2:3] op_sel:[0,0,1] op_sel_hi:[1,0,1]
    v_pk_fma_f32 v[16:17], v[16:17], v[2:3], v[2:3] op_sel:[0,0,1] op_sel_hi:[1,0,1]
    v_cvt_pk_bf16_f32 v140, v14, v15
    v_cvt_pk_bf16_f32 v141, v16, v17
    v_lshlrev_b32 v14, 16, v142
    v_and_b32 v15, s75, v142
    v_lshlrev_b32 v16, 16, v143
    v_and_b32 v17, s75, v143
    v_pk_fma_f32 v[14:15], v[14:15], v[2:3], v[2:3] op_sel:[0,0,1] op_sel_hi:[1,0,1]
    v_pk_fma_f32 v[16:17], v[16:17], v[2:3], v[2:3] op_sel:[0,0,1] op_sel_hi:[1,0,1]
    v_cvt_pk_bf16_f32 v142, v14, v15
    v_cvt_pk_bf16_f32 v143, v16, v17
    v_lshlrev_b32 v14, 16, v144
    v_and_b32 v15, s75, v144
    v_lshlrev_b32 v16, 16, v145
    v_and_b32 v17, s75, v145
    v_pk_fma_f32 v[14:15], v[14:15], v[2:3], v[2:3] op_sel:[0,0,1] op_sel_hi:[1,0,1]
    v_pk_fma_f32 v[16:17], v[16:17], v[2:3], v[2:3] op_sel:[0,0,1] op_sel_hi:[1,0,1]
    v_cvt_pk_bf16_f32 v144, v14, v15
    v_cvt_pk_bf16_f32 v145, v16, v17
    v_lshlrev_b32 v14, 16, v146
    v_and_b32 v15, s75, v146
    v_lshlrev_b32 v16, 16, v147
    v_and_b32 v17, s75, v147
    v_pk_fma_f32 v[14:15], v[14:15], v[2:3], v[2:3] op_sel:[0,0,1] op_sel_hi:[1,0,1]
    v_pk_fma_f32 v[16:17], v[16:17], v[2:3], v[2:3] op_sel:[0,0,1] op_sel_hi:[1,0,1]
    v_cvt_pk_bf16_f32 v146, v14, v15
    v_cvt_pk_bf16_f32 v147, v16, v17
    v_lshlrev_b32 v14, 16, v148
    v_and_b32 v15, s75, v148
    v_lshlrev_b32 v16, 16, v149
    v_and_b32 v17, s75, v149
    v_pk_fma_f32 v[14:15], v[14:15], v[2:3], v[2:3] op_sel:[0,0,1] op_sel_hi:[1,0,1]
    v_pk_fma_f32 v[16:17], v[16:17], v[2:3], v[2:3] op_sel:[0,0,1] op_sel_hi:[1,0,1]
    v_cvt_pk_bf16_f32 v148, v14, v15
    v_cvt_pk_bf16_f32 v149, v16, v17
    v_lshlrev_b32 v14, 16, v150
    v_and_b32 v15, s75, v150
    v_lshlrev_b32 v16, 16, v151
    v_and_b32 v17, s75, v151
    v_pk_fma_f32 v[14:15], v[14:15], v[2:3], v[2:3] op_sel:[0,0,1] op_sel_hi:[1,0,1]
    v_pk_fma_f32 v[16:17], v[16:17], v[2:3], v[2:3] op_sel:[0,0,1] op_sel_hi:[1,0,1]
    v_cvt_pk_bf16_f32 v150, v14, v15
    v_cvt_pk_bf16_f32 v151, v16, v17
    v_lshlrev_b32 v14, 16, v152
    v_and_b32 v15, s75, v152
    v_lshlrev_b32 v16, 16, v153
    v_and_b32 v17, s75, v153
    v_pk_fma_f32 v[14:15], v[14:15], v[2:3], v[2:3] op_sel:[0,0,1] op_sel_hi:[1,0,1]
    v_pk_fma_f32 v[16:17], v[16:17], v[2:3], v[2:3] op_sel:[0,0,1] op_sel_hi:[1,0,1]
    v_cvt_pk_bf16_f32 v152, v14, v15
    v_cvt_pk_bf16_f32 v153, v16, v17
    v_lshlrev_b32 v14, 16, v154
    v_and_b32 v15, s75, v154
    v_lshlrev_b32 v16, 16, v155
    v_and_b32 v17, s75, v155
    v_pk_fma_f32 v[14:15], v[14:15], v[2:3], v[2:3] op_sel:[0,0,1] op_sel_hi:[1,0,1]
    v_pk_fma_f32 v[16:17], v[16:17], v[2:3], v[2:3] op_sel:[0,0,1] op_sel_hi:[1,0,1]
    v_cvt_pk_bf16_f32 v154, v14, v15
    v_cvt_pk_bf16_f32 v155, v16, v17
    v_lshlrev_b32 v14, 16, v156
    v_and_b32 v15, s75, v156
    v_lshlrev_b32 v16, 16, v157
    v_and_b32 v17, s75, v157
    v_pk_fma_f32 v[14:15], v[14:15], v[2:3], v[2:3] op_sel:[0,0,1] op_sel_hi:[1,0,1]
    v_pk_fma_f32 v[16:17], v[16:17], v[2:3], v[2:3] op_sel:[0,0,1] op_sel_hi:[1,0,1]
    v_cvt_pk_bf16_f32 v156, v14, v15
    v_cvt_pk_bf16_f32 v157, v16, v17
    v_lshlrev_b32 v14, 16, v158
    v_and_b32 v15, s75, v158
    v_lshlrev_b32 v16, 16, v159
    v_and_b32 v17, s75, v159
    v_pk_fma_f32 v[14:15], v[14:15], v[2:3], v[2:3] op_sel:[0,0,1] op_sel_hi:[1,0,1]
    v_pk_fma_f32 v[16:17], v[16:17], v[2:3], v[2:3] op_sel:[0,0,1] op_sel_hi:[1,0,1]
    v_cvt_pk_bf16_f32 v158, v14, v15
    v_cvt_pk_bf16_f32 v159, v16, v17
    v_lshlrev_b32 v14, 16, v160
    v_and_b32 v15, s75, v160
    v_lshlrev_b32 v16, 16, v161
    v_and_b32 v17, s75, v161
    v_pk_fma_f32 v[14:15], v[14:15], v[2:3], v[2:3] op_sel:[0,0,1] op_sel_hi:[1,0,1]
    v_pk_fma_f32 v[16:17], v[16:17], v[2:3], v[2:3] op_sel:[0,0,1] op_sel_hi:[1,0,1]
    v_cvt_pk_bf16_f32 v160, v14, v15
    v_cvt_pk_bf16_f32 v161, v16, v17
    v_lshlrev_b32 v14, 16, v162
    v_and_b32 v15, s75, v162
    v_lshlrev_b32 v16, 16, v163
    v_and_b32 v17, s75, v163
    v_pk_fma_f32 v[14:15], v[14:15], v[2:3], v[2:3] op_sel:[0,0,1] op_sel_hi:[1,0,1]
    v_pk_fma_f32 v[16:17], v[16:17], v[2:3], v[2:3] op_sel:[0,0,1] op_sel_hi:[1,0,1]
    v_cvt_pk_bf16_f32 v162, v14, v15
    v_cvt_pk_bf16_f32 v163, v16, v17
    v_lshlrev_b32 v14, 16, v164
    v_and_b32 v15, s75, v164
    v_lshlrev_b32 v16, 16, v165
    v_and_b32 v17, s75, v165
    v_pk_fma_f32 v[14:15], v[14:15], v[2:3], v[2:3] op_sel:[0,0,1] op_sel_hi:[1,0,1]
    v_pk_fma_f32 v[16:17], v[16:17], v[2:3], v[2:3] op_sel:[0,0,1] op_sel_hi:[1,0,1]
    v_cvt_pk_bf16_f32 v164, v14, v15
    v_cvt_pk_bf16_f32 v165, v16, v17
    v_lshlrev_b32 v14, 16, v166
    v_and_b32 v15, s75, v166
    v_lshlrev_b32 v16, 16, v167
    v_and_b32 v17, s75, v167
    v_pk_fma_f32 v[14:15], v[14:15], v[2:3], v[2:3] op_sel:[0,0,1] op_sel_hi:[1,0,1]
    v_pk_fma_f32 v[16:17], v[16:17], v[2:3], v[2:3] op_sel:[0,0,1] op_sel_hi:[1,0,1]
    v_cvt_pk_bf16_f32 v166, v14, v15
    v_cvt_pk_bf16_f32 v167, v16, v17
    v_lshlrev_b32 v14, 16, v168
    v_and_b32 v15, s75, v168
    v_lshlrev_b32 v16, 16, v169
    v_and_b32 v17, s75, v169
    v_pk_fma_f32 v[14:15], v[14:15], v[2:3], v[2:3] op_sel:[0,0,1] op_sel_hi:[1,0,1]
    v_pk_fma_f32 v[16:17], v[16:17], v[2:3], v[2:3] op_sel:[0,0,1] op_sel_hi:[1,0,1]
    v_cvt_pk_bf16_f32 v168, v14, v15
    v_cvt_pk_bf16_f32 v169, v16, v17
    v_lshlrev_b32 v14, 16, v170
    v_and_b32 v15, s75, v170
    v_lshlrev_b32 v16, 16, v171
    v_and_b32 v17, s75, v171
    v_pk_fma_f32 v[14:15], v[14:15], v[2:3], v[2:3] op_sel:[0,0,1] op_sel_hi:[1,0,1]
    v_pk_fma_f32 v[16:17], v[16:17], v[2:3], v[2:3] op_sel:[0,0,1] op_sel_hi:[1,0,1]
    v_cvt_pk_bf16_f32 v170, v14, v15
    v_cvt_pk_bf16_f32 v171, v16, v17
    s_add_u32 s72, s72, 221184
    s_sub_u32 s93, s72, 2211840
    s_min_u32 s72, s72, s93
    s_add_u32 m0, s73, 49152
    s_nop 0
    buffer_load_dwordx4 v8, s[8:11], s72 offen offset:0 lds
    buffer_load_dwordx4 v9, s[8:11], s72 offen offset:1024 lds
    buffer_load_dwordx4 v10, s[8:11], s72 offen offset:2048 lds
    buffer_load_dwordx4 v11, s[8:11], s72 offen offset:3072 lds
    v_lshlrev_b32 v14, 16, v172
    v_and_b32 v15, s75, v172
    v_lshlrev_b32 v16, 16, v173
    v_and_b32 v17, s75, v173
    v_pk_fma_f32 v[14:15], v[14:15], v[2:3], v[2:3] op_sel:[0,0,1] op_sel_hi:[1,0,1]
    v_pk_fma_f32 v[16:17], v[16:17], v[2:3], v[2:3] op_sel:[0,0,1] op_sel_hi:[1,0,1]
    v_cvt_pk_bf16_f32 v172, v14, v15
    v_cvt_pk_bf16_f32 v173, v16, v17
    v_lshlrev_b32 v14, 16, v174
    v_and_b32 v15, s75, v174
    v_lshlrev_b32 v16, 16, v175
    v_and_b32 v17, s75, v175
    v_pk_fma_f32 v[14:15], v[14:15], v[2:3], v[2:3] op_sel:[0,0,1] op_sel_hi:[1,0,1]
    v_pk_fma_f32 v[16:17], v[16:17], v[2:3], v[2:3] op_sel:[0,0,1] op_sel_hi:[1,0,1]
    v_cvt_pk_bf16_f32 v174, v14, v15
    v_cvt_pk_bf16_f32 v175, v16, v17
    s_add_u32 m0, s71, 32768
    s_nop 0
    buffer_load_dwordx4 v32, s[16:19], s94 offen offset:0 lds
    buffer_load_dwordx4 v33, s[16:19], s94 offen offset:1024 lds
    buffer_load_dwordx4 v34, s[16:19], s94 offen offset:2048 lds
    buffer_load_dwordx4 v35, s[16:19], s94 offen offset:3072 lds
    s_add_u32 m0, s71, 49152
    s_nop 0
    buffer_load_dwordx4 v32, s[52:55], s95 offen offset:0 lds
    buffer_load_dwordx4 v33, s[52:55], s95 offen offset:1024 lds
    buffer_load_dwordx4 v34, s[52:55], s95 offen offset:2048 lds
    buffer_load_dwordx4 v35, s[52:55], s95 offen offset:3072 lds
    s_mov_b64 exec, 0
    s_cmp_eq_u32 s64, 0
    s_cbranch_scc1 L_pg0_0
    s_cmp_eq_u32 s64, 1
    s_cbranch_scc1 L_pg0_1
    s_cmp_eq_u32 s64, 2
    s_cbranch_scc1 L_pg0_2
    s_branch L_pg0_3
L_pgret0:
    s_mov_b64 exec, -1
    s_waitcnt vmcnt(16)
    s_barrier
    ds_read_b64_tr_b16 a[0:1], v4 offset:0
    ds_read_b64_tr_b16 a[2:3], v4 offset:1024
    ds_read_b64_tr_b16 a[4:5], v5 offset:0
    ds_read_b64_tr_b16 a[6:7], v5 offset:1024
    ds_read_b64_tr_b16 a[8:9], v6 offset:0
    ds_read_b64_tr_b16 a[10:11], v6 offset:1024
    ds_read_b64_tr_b16 a[12:13], v7 offset:0
    ds_read_b64_tr_b16 a[14:15], v7 offset:1024
    ds_read_b64_tr_b16 a[16:17], v4 offset:4096
    ds_read_b64_tr_b16 a[18:19], v4 offset:5120
    ds_read_b64_tr_b16 a[20:21], v5 offset:4096
    ds_read_b64_tr_b16 a[22:23], v5 offset:5120
    ds_read_b64_tr_b16 a[24:25], v6 offset:4096
    ds_read_b64_tr_b16 a[26:27], v6 offset:5120
    s_waitcnt lgkmcnt(12)
    v_mfma_f32_32x32x16_bf16 v[32:47], a[0:3], v[96:99], 0
    ds_read_b64_tr_b16 a[28:29], v7 offset:4096
    ds_read_b64_tr_b16 a[30:31], v7 offset:5120
    v_lshlrev_b32 v18, 2, v0
    v_lshlrev_b32 v14, 16, v176
    v_and_b32 v15, s75, v176
    v_fma_f32 v14, v14, v2, v3
    s_waitcnt lgkmcnt(12)
    v_mfma_f32_32x32x16_bf16 v[48:63], a[4:7], v[96:99], 0
    ds_read_b64_tr_b16 a[32:33], v4 offset:8192
    ds_read_b64_tr_b16 a[34:35], v4 offset:9216
    buffer_load_dword v19, v18, s[24:27], 0 offen sc1
    v_fma_f32 v15, v15, v2, v3
    v_cvt_pk_bf16_f32 v176, v14, v15
    s_waitcnt lgkmcnt(12)
    v_mfma_f32_32x32x16_bf16 v[64:79], a[8:11], v[96:99], 0
    ds_read_b64_tr_b16 a[36:37], v5 offset:8192
    ds_read_b64_tr_b16 a[38:39], v5 offset:9216
    v_lshlrev_b32 v16, 16, v177
    v_and_b32 v17, s75, v177
    v_fma_f32 v16, v16, v2, v3
    v_fma_f32 v17, v17, v2, v3
    s_waitcnt lgkmcnt(12)
    v_mfma_f32_32x32x16_bf16 v[80:95], a[12:15], v[96:99], 0
    s_waitcnt lgkmcnt(4)
    ds_read_b64_tr_b16 a[0:1], v6 offset:8192
    ds_read_b64_tr_b16 a[2:3], v6 offset:9216
    v_cvt_pk_bf16_f32 v177, v16, v17
    v_lshlrev_b32 v14, 16, v178
    v_and_b32 v15, s75, v178
    v_fma_f32 v14, v14, v2, v3
    v_mfma_f32_32x32x16_bf16 v[32:47], a[16:19], v[100:103], v[32:47]
    ds_read_b64_tr_b16 a[4:5], v7 offset:8192
    ds_read_b64_tr_b16 a[6:7], v7 offset:9216
    v_fma_f32 v15, v15, v2, v3
    v_cvt_pk_bf16_f32 v178, v14, v15
    v_lshlrev_b32 v16, 16, v179
    v_and_b32 v17, s75, v179
    v_mfma_f32_32x32x16_bf16 v[48:63], a[20:23], v[100:103], v[48:63]
    ds_read_b64_tr_b16 a[8:9], v4 offset:12288
    ds_read_b64_tr_b16 a[10:11], v4 offset:13312
    v_fma_f32 v16, v16, v2, v3
    v_fma_f32 v17, v17, v2, v3
    v_cvt_pk_bf16_f32 v179, v16, v17
    v_lshlrev_b32 v14, 16, v180
    v_and_b32 v15, s75, v180
    v_mfma_f32_32x32x16_bf16 v[64:79], a[24:27], v[100:103], v[64:79]
    ds_read_b64_tr_b16 a[12:13], v5 offset:12288
    ds_read_b64_tr_b16 a[14:15], v5 offset:13312
    v_fma_f32 v14, v14, v2, v3
    v_fma_f32 v15, v15, v2, v3
    v_cvt_pk_bf16_f32 v180, v14, v15
    v_lshlrev_b32 v16, 16, v181
    v_mfma_f32_32x32x16_bf16 v[80:95], a[28:31], v[100:103], v[80:95]
    s_waitcnt lgkmcnt(4)
    ds_read_b64_tr_b16 a[16:17], v6 offset:12288
    ds_read_b64_tr_b16 a[18:19], v6 offset:13312
    v_and_b32 v17, s75, v181
    v_fma_f32 v16, v16, v2, v3
    v_fma_f32 v17, v17, v2, v3
    v_cvt_pk_bf16_f32 v181, v16, v17
    v_mfma_f32_32x32x16_bf16 v[32:47], a[32:35], v[104:107], v[32:47]
    ds_read_b64_tr_b16 a[20:21], v7 offset:12288
    ds_read_b64_tr_b16 a[22:23], v7 offset:13312
    v_lshlrev_b32 v14, 16, v182
    v_and_b32 v15, s75, v182
    v_fma_f32 v14, v14, v2, v3
    v_fma_f32 v15, v15, v2, v3
    v_mfma_f32_32x32x16_bf16 v[48:63], a[36:39], v[104:107], v[48:63]
    ds_read_b64_tr_b16 a[24:25], v4 offset:16384
    ds_read_b64_tr_b16 a[26:27], v4 offset:17408
    v_cvt_pk_bf16_f32 v182, v14, v15
    v_lshlrev_b32 v16, 16, v183
    v_and_b32 v17, s75, v183
    v_fma_f32 v16, v16, v2, v3
    v_mfma_f32_32x32x16_bf16 v[64:79], a[0:3], v[104:107], v[64:79]
    ds_read_b64_tr_b16 a[28:29], v5 offset:16384
    ds_read_b64_tr_b16 a[30:31], v5 offset:17408
    v_fma_f32 v17, v17, v2, v3
    v_cvt_pk_bf16_f32 v183, v16, v17
    v_lshlrev_b32 v14, 16, v184
    v_and_b32 v15, s75, v184
    v_mfma_f32_32x32x16_bf16 v[80:95], a[4:7], v[104:107], v[80:95]
    s_waitcnt lgkmcnt(4)
    ds_read_b64_tr_b16 a[32:33], v6 offset:16384
    ds_read_b64_tr_b16 a[34:35], v6 offset:17408
    v_fma_f32 v14, v14, v2, v3
    v_fma_f32 v15, v15, v2, v3
    v_cvt_pk_bf16_f32 v184, v14, v15
    v_lshlrev_b32 v16, 16, v185
    v_mfma_f32_32x32x16_bf16 v[32:47], a[8:11], v[108:111], v[32:47]
    ds_read_b64_tr_b16 a[36:37], v7 offset:16384
    ds_read_b64_tr_b16 a[38:39], v7 offset:17408
    v_and_b32 v17, s75, v185
    v_fma_f32 v16, v16, v2, v3
    v_fma_f32 v17, v17, v2, v3
    v_cvt_pk_bf16_f32 v185, v16, v17
    v_mfma_f32_32x32x16_bf16 v[48:63], a[12:15], v[108:111], v[48:63]
    ds_read_b64_tr_b16 a[0:1], v4 offset:20480
    ds_read_b64_tr_b16 a[2:3], v4 offset:21504
    v_lshlrev_b32 v14, 16, v186
    v_and_b32 v15, s75, v186
    v_fma_f32 v14, v14, v2, v3
    v_fma_f32 v15, v15, v2, v3
    v_mfma_f32_32x32x16_bf16 v[64:79], a[16:19], v[108:111], v[64:79]
    ds_read_b64_tr_b16 a[4:5], v5 offset:20480
    ds_read_b64_tr_b16 a[6:7], v5 offset:21504
    v_cvt_pk_bf16_f32 v186, v14, v15
    v_lshlrev_b32 v16, 16, v187
    v_and_b32 v17, s75, v187
    v_fma_f32 v16, v16, v2, v3
    v_mfma_f32_32x32x16_bf16 v[80:95], a[20:23], v[108:111], v[80:95]
    s_waitcnt lgkmcnt(4)
    ds_read_b64_tr_b16 a[8:9], v6 offset:20480
    ds_read_b64_tr_b16 a[10:11], v6 offset:21504
    v_fma_f32 v17, v17, v2, v3
    v_cvt_pk_bf16_f32 v187, v16, v17
    v_lshlrev_b32 v14, 16, v188
    v_and_b32 v15, s75, v188
    v_fma_f32 v14, v14, v2, v3
    v_mfma_f32_32x32x16_bf16 v[32:47], a[24:27], v[112:115], v[32:47]
    ds_read_b64_tr_b16 a[12:13], v7 offset:20480
    ds_read_b64_tr_b16 a[14:15], v7 offset:21504
    v_fma_f32 v15, v15, v2, v3
    v_cvt_pk_bf16_f32 v188, v14, v15
    v_lshlrev_b32 v16, 16, v189
    v_and_b32 v17, s75, v189
    v_mfma_f32_32x32x16_bf16 v[48:63], a[28:31], v[112:115], v[48:63]
    ds_read_b64_tr_b16 a[16:17], v4 offset:24576
    ds_read_b64_tr_b16 a[18:19], v4 offset:25600
    v_fma_f32 v16, v16, v2, v3
    v_fma_f32 v17, v17, v2, v3
    v_cvt_pk_bf16_f32 v189, v16, v17
    v_lshlrev_b32 v14, 16, v190
    v_mfma_f32_32x32x16_bf16 v[64:79], a[32:35], v[112:115], v[64:79]
    ds_read_b64_tr_b16 a[20:21], v5 offset:24576
    ds_read_b64_tr_b16 a[22:23], v5 offset:25600
    v_and_b32 v15, s75, v190
    v_fma_f32 v14, v14, v2, v3
    v_fma_f32 v15, v15, v2, v3
    v_cvt_pk_bf16_f32 v190, v14, v15
    v_mfma_f32_32x32x16_bf16 v[80:95], a[36:39], v[112:115], v[80:95]
    s_waitcnt lgkmcnt(4)
    ds_read_b64_tr_b16 a[24:25], v6 offset:24576
    ds_read_b64_tr_b16 a[26:27], v6 offset:25600
    v_lshlrev_b32 v16, 16, v191
    v_and_b32 v17, s75, v191
    v_fma_f32 v16, v16, v2, v3
    v_fma_f32 v17, v17, v2, v3
    v_mfma_f32_32x32x16_bf16 v[32:47], a[0:3], v[116:119], v[32:47]
    s_add_u32 s72, s72, 221184
    ds_read_b64_tr_b16 a[28:29], v7 offset:24576
    ds_read_b64_tr_b16 a[30:31], v7 offset:25600
    v_cvt_pk_bf16_f32 v191, v16, v17
    v_lshlrev_b32 v14, 16, v192
    v_and_b32 v15, s75, v192
    v_fma_f32 v14, v14, v2, v3
    v_mfma_f32_32x32x16_bf16 v[48:63], a[4:7], v[116:119], v[48:63]
    s_sub_u32 s93, s72, 2211840
    ds_read_b64_tr_b16 a[32:33], v4 offset:28672
    ds_read_b64_tr_b16 a[34:35], v4 offset:29696
    v_fma_f32 v15, v15, v2, v3
    v_cvt_pk_bf16_f32 v192, v14, v15
    v_lshlrev_b32 v16, 16, v193
    v_and_b32 v17, s75, v193
    v_mfma_f32_32x32x16_bf16 v[64:79], a[8:11], v[116:119], v[64:79]
    s_min_u32 s72, s72, s93
    ds_read_b64_tr_b16 a[36:37], v5 offset:28672
    ds_read_b64_tr_b16 a[38:39], v5 offset:29696
    v_fma_f32 v16, v16, v2, v3
    v_fma_f32 v17, v17, v2, v3
    v_cvt_pk_bf16_f32 v193, v16, v17
    v_lshlrev_b32 v14, 16, v194
    v_mfma_f32_32x32x16_bf16 v[80:95], a[12:15], v[116:119], v[80:95]
    s_waitcnt lgkmcnt(4)
    ds_read_b64_tr_b16 a[0:1], v6 offset:28672
L_pg0_0:
    s_cbranch_execz L_pg0_4
    ds_read_b64_tr_b16 a[2:3], v6 offset:29696
    v_and_b32 v15, s75, v194
    v_fma_f32 v14, v14, v2, v3
    v_fma_f32 v15, v15, v2, v3
    v_cvt_pk_bf16_f32 v194, v14, v15
    v_mfma_f32_32x32x16_bf16 v[32:47], a[16:19], v[120:123], v[32:47]
    s_add_u32 m0, s73, 65536
    ds_read_b64_tr_b16 a[4:5], v7 offset:28672
    ds_read_b64_tr_b16 a[6:7], v7 offset:29696
    buffer_load_dwordx4 v8, s[8:11], s72 offen offset:0 lds
    v_lshlrev_b32 v16, 16, v195
    v_and_b32 v17, s75, v195
    v_mfma_f32_32x32x16_bf16 v[48:63], a[20:23], v[120:123], v[48:63]
    s_waitcnt vmcnt(10)
    s_barrier
    ds_read_b64_tr_b16 a[8:9], v4 offset:32768
    ds_read_b64_tr_b16 a[10:11], v4 offset:33792
    buffer_load_dwordx4 v9, s[8:11], s72 offen offset:1024 lds
    v_fma_f32 v16, v16, v2, v3
    v_fma_f32 v17, v17, v2, v3
    v_mfma_f32_32x32x16_bf16 v[64:79], a[24:27], v[120:123], v[64:79]
    ds_read_b64_tr_b16 a[12:13], v5 offset:32768
    ds_read_b64_tr_b16 a[14:15], v5 offset:33792
    buffer_load_dwordx4 v10, s[8:11], s72 offen offset:2048 lds
    v_cvt_pk_bf16_f32 v195, v16, v17
    v_lshlrev_b32 v14, 16, v196
    v_mfma_f32_32x32x16_bf16 v[80:95], a[28:31], v[120:123], v[80:95]
    s_waitcnt lgkmcnt(4)
    ds_read_b64_tr_b16 a[16:17], v6 offset:32768
    ds_read_b64_tr_b16 a[18:19], v6 offset:33792
    buffer_load_dwordx4 v11, s[8:11], s72 offen offset:3072 lds
    v_and_b32 v15, s75, v196
    v_fma_f32 v14, v14, v2, v3
    v_mfma_f32_32x32x16_bf16 v[32:47], a[32:35], v[124:127], v[32:47]
    s_add_u32 s72, s72, 221184
    ds_read_b64_tr_b16 a[20:21], v7 offset:32768
    ds_read_b64_tr_b16 a[22:23], v7 offset:33792
    v_fma_f32 v15, v15, v2, v3
    v_cvt_pk_bf16_f32 v196, v14, v15
    v_lshlrev_b32 v16, 16, v197
    v_and_b32 v17, s75, v197
    v_mfma_f32_32x32x16_bf16 v[48:63], a[36:39], v[124:127], v[48:63]
    s_sub_u32 s93, s72, 2211840
    ds_read_b64_tr_b16 a[24:25], v4 offset:36864
    ds_read_b64_tr_b16 a[26:27], v4 offset:37888
    v_fma_f32 v16, v16, v2, v3
    v_fma_f32 v17, v17, v2, v3
    v_cvt_pk_bf16_f32 v197, v16, v17
    v_lshlrev_b32 v14, 16, v198
    v_mfma_f32_32x32x16_bf16 v[64:79], a[0:3], v[124:127], v[64:79]
    s_min_u32 s72, s72, s93
    ds_read_b64_tr_b16 a[28:29], v5 offset:36864
    ds_read_b64_tr_b16 a[30:31], v5 offset:37888
    v_and_b32 v15, s75, v198
    v_fma_f32 v14, v14, v2, v3
    v_fma_f32 v15, v15, v2, v3
    v_cvt_pk_bf16_f32 v198, v14, v15
    v_mfma_f32_32x32x16_bf16 v[80:95], a[4:7], v[124:127], v[80:95]
    s_waitcnt lgkmcnt(4)
    ds_read_b64_tr_b16 a[32:33], v6 offset:36864
    ds_read_b64_tr_b16 a[34:35], v6 offset:37888
    v_lshlrev_b32 v16, 16, v199
    v_and_b32 v17, s75, v199
    v_fma_f32 v16, v16, v2, v3
    v_fma_f32 v17, v17, v2, v3
    v_mfma_f32_32x32x16_bf16 v[32:47], a[8:11], v[128:131], v[32:47]
    s_add_u32 m0, s73, 81920
    ds_read_b64_tr_b16 a[36:37], v7 offset:36864
    ds_read_b64_tr_b16 a[38:39], v7 offset:37888
    buffer_load_dwordx4 v8, s[8:11], s72 offen offset:0 lds
    v_cvt_pk_bf16_f32 v199, v16, v17
    v_lshlrev_b32 v14, 16, v200
    v_mfma_f32_32x32x16_bf16 v[48:63], a[12:15], v[128:131], v[48:63]
    s_waitcnt vmcnt(5)
    v_cmp_ne_u32 vcc, 1, v19
    s_cbranch_vccnz L_spin0
L_back0:
    ds_read_b64_tr_b16 a[0:1], v4 offset:40960
    ds_read_b64_tr_b16 a[2:3], v4 offset:41984
    buffer_load_dwordx4 v9, s[8:11], s72 offen offset:1024 lds
    ds_read_b64_tr_b16 a[128:129], v22 offset:0
    ds_read_b64_tr_b16 a[130:131], v24 offset:1024
    v_mfma_f32_32x32x16_bf16 v[64:79], a[16:19], v[128:131], v[64:79]
    ds_read_b64_tr_b16 a[4:5], v5 offset:40960
    ds_read_b64_tr_b16 a[6:7], v5 offset:41984
    buffer_load_dwordx4 v10, s[8:11], s72 offen offset:2048 lds
    ds_read_b64_tr_b16 a[132:133], v23 offset:0
    ds_read_b64_tr_b16 a[134:135], v25 offset:1024
    v_mfma_f32_32x32x16_bf16 v[80:95], a[20:23], v[128:131], v[80:95]
    s_waitcnt lgkmcnt(8)
    ds_read_b64_tr_b16 a[8:9], v6 offset:40960
    ds_read_b64_tr_b16 a[10:11], v6 offset:41984
    buffer_load_dwordx4 v11, s[8:11], s72 offen offset:3072 lds
    v_and_b32 v15, s75, v200
    v_fma_f32 v14, v14, v2, v3
    v_fma_f32 v15, v15, v2, v3
    v_mfma_f32_32x32x16_bf16 v[32:47], a[24:27], v[132:135], v[32:47]
    s_add_u32 s72, s72, 221184
    ds_read_b64_tr_b16 a[12:13], v7 offset:40960
    ds_read_b64_tr_b16 a[14:15], v7 offset:41984
    v_cvt_pk_bf16_f32 v200, v14, v15
    v_lshlrev_b32 v16, 16, v201
    v_and_b32 v17, s75, v201
    v_fma_f32 v16, v16, v2, v3
    v_mfma_f32_32x32x16_bf16 v[48:63], a[28:31], v[132:135], v[48:63]
    s_sub_u32 s93, s72, 2211840
    ds_read_b64_tr_b16 a[16:17], v4 offset:45056
    ds_read_b64_tr_b16 a[18:19], v4 offset:46080
    s_waitcnt lgkmcnt(10)
    buffer_store_dwordx4 a[128:131], v1, s[12:15], s32 offen sc1
    ds_read_b64_tr_b16 a[136:137], v24 offset:0
    ds_read_b64_tr_b16 a[138:139], v22 offset:1024
    v_mfma_f32_32x32x16_bf16 v[64:79], a[32:35], v[132:135], v[64:79]
    s_min_u32 s72, s72, s93
    ds_read_b64_tr_b16 a[20:21], v5 offset:45056
    ds_read_b64_tr_b16 a[22:23], v5 offset:46080
    v_fma_f32 v17, v17, v2, v3
    v_cvt_pk_bf16_f32 v201, v16, v17
    v_lshlrev_b32 v14, 16, v202
    v_and_b32 v15, s75, v202
    v_mfma_f32_32x32x16_bf16 v[80:95], a[36:39], v[132:135], v[80:95]
    s_waitcnt lgkmcnt(6)
    ds_read_b64_tr_b16 a[24:25], v6 offset:45056
    ds_read_b64_tr_b16 a[26:27], v6 offset:46080
    v_fma_f32 v14, v14, v2, v3
    v_fma_f32 v15, v15, v2, v3
    v_cvt_pk_bf16_f32 v202, v14, v15
    v_lshlrev_b32 v16, 16, v203
    v_mfma_f32_32x32x16_bf16 v[32:47], a[0:3], v[136:139], v[32:47]
    s_add_u32 m0, s73, 98304
    ds_read_b64_tr_b16 a[28:29], v7 offset:45056
    ds_read_b64_tr_b16 a[30:31], v7 offset:46080
    buffer_load_dwordx4 v8, s[8:11], s72 offen offset:0 lds
    v_and_b32 v17, s75, v203
    v_fma_f32 v16, v16, v2, v3
    v_mfma_f32_32x32x16_bf16 v[48:63], a[4:7], v[136:139], v[48:63]
    ds_read_b64_tr_b16 a[32:33], v4 offset:49152
    ds_read_b64_tr_b16 a[34:35], v4 offset:50176
    buffer_load_dwordx4 v9, s[8:11], s72 offen offset:1024 lds
    v_fma_f32 v17, v17, v2, v3
    v_cvt_pk_bf16_f32 v203, v16, v17
    v_mfma_f32_32x32x16_bf16 v[64:79], a[8:11], v[136:139], v[64:79]
    ds_read_b64_tr_b16 a[36:37], v5 offset:49152
    ds_read_b64_tr_b16 a[38:39], v5 offset:50176
    buffer_store_dwordx4 a[132:135], v1, s[12:15], s33 offen sc1
    ds_read_b64_tr_b16 a[140:141], v25 offset:0
    ds_read_b64_tr_b16 a[142:143], v23 offset:1024
    v_mfma_f32_32x32x16_bf16 v[80:95], a[12:15], v[136:139], v[80:95]
    s_waitcnt lgkmcnt(6)
    ds_read_b64_tr_b16 a[0:1], v6 offset:49152
    ds_read_b64_tr_b16 a[2:3], v6 offset:50176
    v_lshlrev_b32 v14, 16, v204
    v_and_b32 v15, s75, v204
    v_fma_f32 v14, v14, v2, v3
    v_fma_f32 v15, v15, v2, v3
    v_mfma_f32_32x32x16_bf16 v[32:47], a[16:19], v[140:143], v[32:47]
    ds_read_b64_tr_b16 a[4:5], v7 offset:49152
    ds_read_b64_tr_b16 a[6:7], v7 offset:50176
    v_cvt_pk_bf16_f32 v204, v14, v15
    v_lshlrev_b32 v16, 16, v205
    v_and_b32 v17, s75, v205
    v_fma_f32 v16, v16, v2, v3
    v_mfma_f32_32x32x16_bf16 v[48:63], a[20:23], v[140:143], v[48:63]
    ds_read_b64_tr_b16 a[8:9], v4 offset:53248
    ds_read_b64_tr_b16 a[10:11], v4 offset:54272
    buffer_load_dwordx4 v10, s[8:11], s72 offen offset:2048 lds
    v_fma_f32 v17, v17, v2, v3
    v_cvt_pk_bf16_f32 v205, v16, v17
    v_lshlrev_b32 v14, 16, v206
    v_mfma_f32_32x32x16_bf16 v[64:79], a[24:27], v[140:143], v[64:79]
    ds_read_b64_tr_b16 a[12:13], v5 offset:53248
    ds_read_b64_tr_b16 a[14:15], v5 offset:54272
    buffer_store_dwordx4 a[136:139], v1, s[12:15], s34 offen sc1
    ds_read_b64_tr_b16 a[144:145], v26 offset:0
    ds_read_b64_tr_b16 a[146:147], v28 offset:1024
    v_mfma_f32_32x32x16_bf16 v[80:95], a[28:31], v[140:143], v[80:95]
    s_waitcnt lgkmcnt(6)
    ds_read_b64_tr_b16 a[16:17], v6 offset:53248
    ds_read_b64_tr_b16 a[18:19], v6 offset:54272
    v_and_b32 v15, s75, v206
    v_fma_f32 v14, v14, v2, v3
    v_fma_f32 v15, v15, v2, v3
    v_cvt_pk_bf16_f32 v206, v14, v15
    v_mfma_f32_32x32x16_bf16 v[32:47], a[32:35], v[144:147], v[32:47]
    ds_read_b64_tr_b16 a[20:21], v7 offset:53248
    ds_read_b64_tr_b16 a[22:23], v7 offset:54272
    v_lshlrev_b32 v16, 16, v207
    v_and_b32 v17, s75, v207
    v_fma_f32 v16, v16, v2, v3
    v_fma_f32 v17, v17, v2, v3
    v_mfma_f32_32x32x16_bf16 v[48:63], a[36:39], v[144:147], v[48:63]
    ds_read_b64_tr_b16 a[24:25], v4 offset:57344
    ds_read_b64_tr_b16 a[26:27], v4 offset:58368
    buffer_load_dwordx4 v11, s[8:11], s72 offen offset:3072 lds
    v_cvt_pk_bf16_f32 v207, v16, v17
    v_lshlrev_b32 v14, 16, v208
    v_mfma_f32_32x32x16_bf16 v[64:79], a[0:3], v[144:147], v[64:79]
    s_add_u32 s72, s72, 221184
    ds_read_b64_tr_b16 a[28:29], v5 offset:57344
    ds_read_b64_tr_b16 a[30:31], v5 offset:58368
    buffer_store_dwordx4 a[140:143], v1, s[12:15], s35 offen sc1
    ds_read_b64_tr_b16 a[148:149], v27 offset:0
    ds_read_b64_tr_b16 a[150:151], v29 offset:1024
    v_mfma_f32_32x32x16_bf16 v[80:95], a[4:7], v[144:147], v[80:95]
    s_waitcnt lgkmcnt(6)
    ds_read_b64_tr_b16 a[32:33], v6 offset:57344
    ds_read_b64_tr_b16 a[34:35], v6 offset:58368
    v_and_b32 v15, s75, v208
    v_fma_f32 v14, v14, v2, v3
    v_fma_f32 v15, v15, v2, v3
    v_cvt_pk_bf16_f32 v208, v14, v15
    v_mfma_f32_32x32x16_bf16 v[32:47], a[8:11], v[148:151], v[32:47]
    s_sub_u32 s93, s72, 2211840
    ds_read_b64_tr_b16 a[36:37], v7 offset:57344
    ds_read_b64_tr_b16 a[38:39], v7 offset:58368
    v_lshlrev_b32 v16, 16, v209
    v_and_b32 v17, s75, v209
    v_fma_f32 v16, v16, v2, v3
    v_fma_f32 v17, v17, v2, v3
    v_mfma_f32_32x32x16_bf16 v[48:63], a[12:15], v[148:151], v[48:63]
    s_min_u32 s72, s72, s93
    ds_read_b64_tr_b16 a[0:1], v4 offset:61440
    ds_read_b64_tr_b16 a[2:3], v4 offset:62464
    buffer_store_dwordx4 a[144:147], v1, s[12:15], s36 offen sc1
    ds_read_b64_tr_b16 a[152:153], v28 offset:0
    ds_read_b64_tr_b16 a[154:155], v26 offset:1024
    v_mfma_f32_32x32x16_bf16 v[64:79], a[16:19], v[148:151], v[64:79]
    s_add_u32 m0, s73, 114688
    ds_read_b64_tr_b16 a[4:5], v5 offset:61440
    ds_read_b64_tr_b16 a[6:7], v5 offset:62464
    v_cvt_pk_bf16_f32 v209, v16, v17
    v_lshlrev_b32 v14, 16, v210
    v_and_b32 v15, s75, v210
    v_fma_f32 v14, v14, v2, v3
    v_mfma_f32_32x32x16_bf16 v[80:95], a[20:23], v[148:151], v[80:95]
    s_waitcnt lgkmcnt(6)
    ds_read_b64_tr_b16 a[8:9], v6 offset:61440
    ds_read_b64_tr_b16 a[10:11], v6 offset:62464
    buffer_load_dwordx4 v8, s[8:11], s72 offen offset:0 lds
    v_fma_f32 v15, v15, v2, v3
    v_cvt_pk_bf16_f32 v210, v14, v15
    v_lshlrev_b32 v16, 16, v211
    v_mfma_f32_32x32x16_bf16 v[32:47], a[24:27], v[152:155], v[32:47]
    ds_read_b64_tr_b16 a[12:13], v7 offset:61440
    ds_read_b64_tr_b16 a[14:15], v7 offset:62464
    buffer_store_dwordx4 a[148:151], v1, s[12:15], s37 offen sc1
    ds_read_b64_tr_b16 a[156:157], v29 offset:0
    ds_read_b64_tr_b16 a[158:159], v27 offset:1024
    v_add_u32 v4, 65536, v4
    v_mfma_f32_32x32x16_bf16 v[48:63], a[28:31], v[152:155], v[48:63]
    s_waitcnt vmcnt(15)
    s_barrier
    ds_read_b64_tr_b16 a[16:17], v4 offset:0
    ds_read_b64_tr_b16 a[18:19], v4 offset:1024
    v_add_u32 v5, 65536, v5
    v_and_b32 v17, s75, v211
    v_fma_f32 v16, v16, v2, v3
    v_mfma_f32_32x32x16_bf16 v[64:79], a[32:35], v[152:155], v[64:79]
    ds_read_b64_tr_b16 a[20:21], v5 offset:0
    ds_read_b64_tr_b16 a[22:23], v5 offset:1024
    v_add_u32 v6, 65536, v6
    v_fma_f32 v17, v17, v2, v3
    v_cvt_pk_bf16_f32 v211, v16, v17
    v_lshlrev_b32 v14, 16, v212
    v_mfma_f32_32x32x16_bf16 v[80:95], a[36:39], v[152:155], v[80:95]
    s_waitcnt lgkmcnt(6)
    ds_read_b64_tr_b16 a[24:25], v6 offset:0
    ds_read_b64_tr_b16 a[26:27], v6 offset:1024
    buffer_load_dwordx4 v9, s[8:11], s72 offen offset:1024 lds
    v_add_u32 v7, 65536, v7
    v_and_b32 v15, s75, v212
    v_mfma_f32_32x32x16_bf16 v[32:47], a[0:3], v[156:159], v[32:47]
    ds_read_b64_tr_b16 a[28:29], v7 offset:0
    ds_read_b64_tr_b16 a[30:31], v7 offset:1024
    buffer_store_dwordx4 a[152:155], v1, s[12:15], s38 offen sc1
    v_fma_f32 v14, v14, v2, v3
    v_fma_f32 v15, v15, v2, v3
    v_mfma_f32_32x32x16_bf16 v[48:63], a[4:7], v[156:159], v[48:63]
    ds_read_b64_tr_b16 a[32:33], v4 offset:4096
    ds_read_b64_tr_b16 a[34:35], v4 offset:5120
    v_cvt_pk_bf16_f32 v212, v14, v15
    v_lshlrev_b32 v16, 16, v213
    v_and_b32 v17, s75, v213
    v_fma_f32 v16, v16, v2, v3
    v_mfma_f32_32x32x16_bf16 v[64:79], a[8:11], v[156:159], v[64:79]
    ds_read_b64_tr_b16 a[36:37], v5 offset:4096
    ds_read_b64_tr_b16 a[38:39], v5 offset:5120
    v_fma_f32 v17, v17, v2, v3
    v_cvt_pk_bf16_f32 v213, v16, v17
    v_lshlrev_b32 v14, 16, v214
    v_and_b32 v15, s75, v214
    v_mfma_f32_32x32x16_bf16 v[80:95], a[12:15], v[156:159], v[80:95]
    s_waitcnt lgkmcnt(4)
    ds_read_b64_tr_b16 a[0:1], v6 offset:4096
    ds_read_b64_tr_b16 a[2:3], v6 offset:5120
    buffer_load_dwordx4 v10, s[8:11], s72 offen offset:2048 lds
    v_fma_f32 v14, v14, v2, v3
    v_fma_f32 v15, v15, v2, v3
    v_mfma_f32_32x32x16_bf16 v[32:47], a[16:19], v[160:163], v[32:47]
    ds_read_b64_tr_b16 a[4:5], v7 offset:4096
    ds_read_b64_tr_b16 a[6:7], v7 offset:5120
    buffer_store_dwordx4 a[156:159], v1, s[12:15], s39 offen sc1
    v_cvt_pk_bf16_f32 v214, v14, v15
    v_lshlrev_b32 v16, 16, v215
    v_mfma_f32_32x32x16_bf16 v[48:63], a[20:23], v[160:163], v[48:63]
    ds_read_b64_tr_b16 a[8:9], v4 offset:8192
    ds_read_b64_tr_b16 a[10:11], v4 offset:9216
    v_and_b32 v17, s75, v215
    v_fma_f32 v16, v16, v2, v3
    v_fma_f32 v17, v17, v2, v3
    v_cvt_pk_bf16_f32 v215, v16, v17
    v_mfma_f32_32x32x16_bf16 v[64:79], a[24:27], v[160:163], v[64:79]
    ds_read_b64_tr_b16 a[12:13], v5 offset:8192
    ds_read_b64_tr_b16 a[14:15], v5 offset:9216
    v_lshlrev_b32 v14, 16, v216
    v_and_b32 v15, s75, v216
    v_fma_f32 v14, v14, v2, v3
    v_fma_f32 v15, v15, v2, v3
    v_mfma_f32_32x32x16_bf16 v[80:95], a[28:31], v[160:163], v[80:95]
    s_waitcnt lgkmcnt(4)
    ds_read_b64_tr_b16 a[16:17], v6 offset:8192
    ds_read_b64_tr_b16 a[18:19], v6 offset:9216
    buffer_load_dwordx4 v11, s[8:11], s72 offen offset:3072 lds
    v_cvt_pk_bf16_f32 v216, v14, v15
    v_lshlrev_b32 v16, 16, v217
    v_mfma_f32_32x32x16_bf16 v[32:47], a[32:35], v[164:167], v[32:47]
    s_add_u32 s72, s72, 221184
    ds_read_b64_tr_b16 a[20:21], v7 offset:8192
    ds_read_b64_tr_b16 a[22:23], v7 offset:9216
    v_and_b32 v17, s75, v217
    v_fma_f32 v16, v16, v2, v3
    v_fma_f32 v17, v17, v2, v3
    v_cvt_pk_bf16_f32 v217, v16, v17
    v_mfma_f32_32x32x16_bf16 v[48:63], a[36:39], v[164:167], v[48:63]
    s_sub_u32 s93, s72, 2211840
    ds_read_b64_tr_b16 a[24:25], v4 offset:12288
    ds_read_b64_tr_b16 a[26:27], v4 offset:13312
    v_lshlrev_b32 v14, 16, v218
    v_and_b32 v15, s75, v218
    v_fma_f32 v14, v14, v2, v3
    v_fma_f32 v15, v15, v2, v3
    v_mfma_f32_32x32x16_bf16 v[64:79], a[0:3], v[164:167], v[64:79]
    s_min_u32 s72, s72, s93
    ds_read_b64_tr_b16 a[28:29], v5 offset:12288
    ds_read_b64_tr_b16 a[30:31], v5 offset:13312
    v_cvt_pk_bf16_f32 v218, v14, v15
    v_lshlrev_b32 v16, 16, v219
    v_and_b32 v17, s75, v219
    v_fma_f32 v16, v16, v2, v3
    v_mfma_f32_32x32x16_bf16 v[80:95], a[4:7], v[164:167], v[80:95]
    s_waitcnt lgkmcnt(4)
    ds_read_b64_tr_b16 a[32:33], v6 offset:12288
    ds_read_b64_tr_b16 a[34:35], v6 offset:13312
    v_fma_f32 v17, v17, v2, v3
    v_cvt_pk_bf16_f32 v219, v16, v17
    v_lshlrev_b32 v14, 16, v220
    v_and_b32 v15, s75, v220
    v_mfma_f32_32x32x16_bf16 v[32:47], a[8:11], v[168:171], v[32:47]
    s_add_u32 m0, s73, 0
    ds_read_b64_tr_b16 a[36:37], v7 offset:12288
    ds_read_b64_tr_b16 a[38:39], v7 offset:13312
    buffer_load_dwordx4 v8, s[8:11], s72 offen offset:0 lds
    v_fma_f32 v14, v14, v2, v3
    v_fma_f32 v15, v15, v2, v3
    v_mfma_f32_32x32x16_bf16 v[48:63], a[12:15], v[168:171], v[48:63]
    s_waitcnt vmcnt(17)
    s_barrier
    ds_read_b64_tr_b16 a[0:1], v4 offset:16384
    ds_read_b64_tr_b16 a[2:3], v4 offset:17408
    buffer_load_dwordx4 v9, s[8:11], s72 offen offset:1024 lds
    v_cvt_pk_bf16_f32 v220, v14, v15
    v_mfma_f32_32x32x16_bf16 v[64:79], a[16:19], v[168:171], v[64:79]
    ds_read_b64_tr_b16 a[4:5], v5 offset:16384
    ds_read_b64_tr_b16 a[6:7], v5 offset:17408
    buffer_load_dwordx4 v10, s[8:11], s72 offen offset:2048 lds
    v_lshlrev_b32 v16, 16, v221
    v_and_b32 v17, s75, v221
    v_mfma_f32_32x32x16_bf16 v[80:95], a[20:23], v[168:171], v[80:95]
    s_waitcnt lgkmcnt(4)
    ds_read_b64_tr_b16 a[8:9], v6 offset:16384
    ds_read_b64_tr_b16 a[10:11], v6 offset:17408
    buffer_load_dwordx4 v11, s[8:11], s72 offen offset:3072 lds
    v_fma_f32 v16, v16, v2, v3
    v_fma_f32 v17, v17, v2, v3
    v_cvt_pk_bf16_f32 v221, v16, v17
    v_mfma_f32_32x32x16_bf16 v[32:47], a[24:27], v[172:175], v[32:47]
    s_add_u32 s72, s72, 221184
    ds_read_b64_tr_b16 a[12:13], v7 offset:16384
    ds_read_b64_tr_b16 a[14:15], v7 offset:17408
    v_lshlrev_b32 v14, 16, v222
    v_and_b32 v15, s75, v222
    v_fma_f32 v14, v14, v2, v3
    v_fma_f32 v15, v15, v2, v3
    v_mfma_f32_32x32x16_bf16 v[48:63], a[28:31], v[172:175], v[48:63]
    s_sub_u32 s93, s72, 2211840
    ds_read_b64_tr_b16 a[16:17], v4 offset:20480
    ds_read_b64_tr_b16 a[18:19], v4 offset:21504
    v_cvt_pk_bf16_f32 v222, v14, v15
    v_lshlrev_b32 v16, 16, v223
    v_and_b32 v17, s75, v223
    v_fma_f32 v16, v16, v2, v3
    v_mfma_f32_32x32x16_bf16 v[64:79], a[32:35], v[172:175], v[64:79]
    s_min_u32 s72, s72, s93
    ds_read_b64_tr_b16 a[20:21], v5 offset:20480
    ds_read_b64_tr_b16 a[22:23], v5 offset:21504
    v_fma_f32 v17, v17, v2, v3
    v_cvt_pk_bf16_f32 v223, v16, v17
    v_lshlrev_b32 v14, 16, v224
    v_and_b32 v15, s75, v224
    v_mfma_f32_32x32x16_bf16 v[80:95], a[36:39], v[172:175], v[80:95]
    s_waitcnt lgkmcnt(4)
    ds_read_b64_tr_b16 a[24:25], v6 offset:20480
    ds_read_b64_tr_b16 a[26:27], v6 offset:21504
    v_fma_f32 v14, v14, v2, v3
    v_fma_f32 v15, v15, v2, v3
    v_cvt_pk_bf16_f32 v224, v14, v15
    v_lshlrev_b32 v16, 16, v225
    v_mfma_f32_32x32x16_bf16 v[32:47], a[0:3], v[176:179], v[32:47]
    s_add_u32 m0, s73, 16384
    ds_read_b64_tr_b16 a[28:29], v7 offset:20480
    ds_read_b64_tr_b16 a[30:31], v7 offset:21504
    buffer_load_dwordx4 v8, s[8:11], s72 offen offset:0 lds
    v_accvgpr_read_b32 v8, a104
    v_and_b32 v17, s75, v225
    v_mfma_f32_32x32x16_bf16 v[48:63], a[4:7], v[176:179], v[48:63]
    ds_read_b64_tr_b16 a[32:33], v4 offset:24576
    ds_read_b64_tr_b16 a[34:35], v4 offset:25600
    buffer_load_dwordx4 v9, s[8:11], s72 offen offset:1024 lds
    v_accvgpr_read_b32 v9, a105
    v_fma_f32 v16, v16, v2, v3
    v_mfma_f32_32x32x16_bf16 v[64:79], a[8:11], v[176:179], v[64:79]
    s_waitcnt vmcnt(7)
    ds_read_b64_tr_b16 a[36:37], v5 offset:24576
    ds_read_b64_tr_b16 a[38:39], v5 offset:25600
    buffer_load_dwordx4 v10, s[8:11], s72 offen offset:2048 lds
    v_accvgpr_read_b32 v10, a106
    v_mov_b32 v20, 1
    v_mfma_f32_32x32x16_bf16 v[80:95], a[12:15], v[176:179], v[80:95]
    s_waitcnt lgkmcnt(4)
    ds_read_b64_tr_b16 a[0:1], v6 offset:24576
    ds_read_b64_tr_b16 a[2:3], v6 offset:25600
    buffer_load_dwordx4 v11, s[8:11], s72 offen offset:3072 lds
    v_fma_f32 v17, v17, v2, v3
    v_cvt_pk_bf16_f32 v225, v16, v17
    v_mfma_f32_32x32x16_bf16 v[32:47], a[16:19], v[180:183], v[32:47]
    s_mov_b32 s72, s50
    ds_read_b64_tr_b16 a[4:5], v7 offset:24576
    ds_read_b64_tr_b16 a[6:7], v7 offset:25600
    buffer_store_dword v20, v30, s[12:15], s47 offen sc1
    v_lshlrev_b32 v14, 16, v226
    v_and_b32 v15, s75, v226
    v_mfma_f32_32x32x16_bf16 v[48:63], a[20:23], v[180:183], v[48:63]
    s_mov_b32 s73, s51
    ds_read_b64_tr_b16 a[8:9], v4 offset:28672
    ds_read_b64_tr_b16 a[10:11], v4 offset:29696
    v_fma_f32 v14, v14, v2, v3
    v_fma_f32 v15, v15, v2, v3
    v_cvt_pk_bf16_f32 v226, v14, v15
    v_lshlrev_b32 v16, 16, v227
    v_and_b32 v17, s75, v227
    v_mfma_f32_32x32x16_bf16 v[64:79], a[24:27], v[180:183], v[64:79]
    s_add_u32 m0, s73, 32768
    ds_read_b64_tr_b16 a[12:13], v5 offset:28672
    ds_read_b64_tr_b16 a[14:15], v5 offset:29696
    buffer_load_dwordx4 v8, s[8:11], s72 offen offset:0 lds
    v_fma_f32 v16, v16, v2, v3
    v_fma_f32 v17, v17, v2, v3
    v_mfma_f32_32x32x16_bf16 v[80:95], a[28:31], v[180:183], v[80:95]
    s_waitcnt lgkmcnt(4)
    ds_read_b64_tr_b16 a[16:17], v6 offset:28672
    ds_read_b64_tr_b16 a[18:19], v6 offset:29696
    v_cvt_pk_bf16_f32 v227, v16, v17
    v_lshlrev_b32 v14, 16, v228
    v_and_b32 v15, s75, v228
    v_fma_f32 v14, v14, v2, v3
    v_mfma_f32_32x32x16_bf16 v[32:47], a[32:35], v[184:187], v[32:47]
    ds_read_b64_tr_b16 a[20:21], v7 offset:28672
    ds_read_b64_tr_b16 a[22:23], v7 offset:29696
    buffer_load_dwordx4 v9, s[8:11], s72 offen offset:1024 lds
    v_fma_f32 v15, v15, v2, v3
    v_cvt_pk_bf16_f32 v228, v14, v15
    v_mfma_f32_32x32x16_bf16 v[48:63], a[36:39], v[184:187], v[48:63]
    s_waitcnt vmcnt(11)
    s_barrier
    ds_read_b64_tr_b16 a[24:25], v4 offset:32768
    ds_read_b64_tr_b16 a[26:27], v4 offset:33792
    v_lshlrev_b32 v16, 16, v229
    v_and_b32 v17, s75, v229
    v_fma_f32 v16, v16, v2, v3
    v_mfma_f32_32x32x16_bf16 v[64:79], a[0:3], v[184:187], v[64:79]
    ds_read_b64_tr_b16 a[28:29], v5 offset:32768
    ds_read_b64_tr_b16 a[30:31], v5 offset:33792
    v_fma_f32 v17, v17, v2, v3
    v_cvt_pk_bf16_f32 v229, v16, v17
    v_lshlrev_b32 v14, 16, v230
    v_and_b32 v15, s75, v230
    v_mfma_f32_32x32x16_bf16 v[80:95], a[4:7], v[184:187], v[80:95]
    s_waitcnt lgkmcnt(4)
    ds_read_b64_tr_b16 a[32:33], v6 offset:32768
    ds_read_b64_tr_b16 a[34:35], v6 offset:33792
    buffer_load_dwordx4 v10, s[8:11], s72 offen offset:2048 lds
    v_fma_f32 v14, v14, v2, v3
    v_fma_f32 v15, v15, v2, v3
    v_mfma_f32_32x32x16_bf16 v[32:47], a[8:11], v[188:191], v[32:47]
    s_add_u32 s72, s72, 221184
    ds_read_b64_tr_b16 a[36:37], v7 offset:32768
    ds_read_b64_tr_b16 a[38:39], v7 offset:33792
    v_cvt_pk_bf16_f32 v230, v14, v15
    v_lshlrev_b32 v16, 16, v231
    v_and_b32 v17, s75, v231
    v_fma_f32 v16, v16, v2, v3
    v_mfma_f32_32x32x16_bf16 v[48:63], a[12:15], v[188:191], v[48:63]
    s_sub_u32 s93, s72, 2211840
    ds_read_b64_tr_b16 a[0:1], v4 offset:36864
    ds_read_b64_tr_b16 a[2:3], v4 offset:37888
    v_fma_f32 v17, v17, v2, v3
    v_cvt_pk_bf16_f32 v231, v16, v17
    v_lshlrev_b32 v14, 16, v232
    v_and_b32 v15, s75, v232
    v_mfma_f32_32x32x16_bf16 v[64:79], a[16:19], v[188:191], v[64:79]
    s_min_u32 s72, s72, s93
    ds_read_b64_tr_b16 a[4:5], v5 offset:36864
    ds_read_b64_tr_b16 a[6:7], v5 offset:37888
    v_fma_f32 v14, v14, v2, v3
    v_fma_f32 v15, v15, v2, v3
    v_cvt_pk_bf16_f32 v232, v14, v15
    v_lshlrev_b32 v16, 16, v233
    v_mfma_f32_32x32x16_bf16 v[80:95], a[20:23], v[188:191], v[80:95]
    s_waitcnt lgkmcnt(4)
    ds_read_b64_tr_b16 a[8:9], v6 offset:36864
    ds_read_b64_tr_b16 a[10:11], v6 offset:37888
    v_and_b32 v17, s75, v233
    v_fma_f32 v16, v16, v2, v3
    v_fma_f32 v17, v17, v2, v3
    v_cvt_pk_bf16_f32 v233, v16, v17
    v_lshlrev_b32 v14, 16, v234
    v_mfma_f32_32x32x16_bf16 v[32:47], a[24:27], v[192:195], v[32:47]
    s_add_u32 m0, s73, 45056
    ds_read_b64_tr_b16 a[12:13], v7 offset:36864
    ds_read_b64_tr_b16 a[14:15], v7 offset:37888
    buffer_load_dwordx4 v8, s[8:11], s72 offen offset:0 lds
    v_and_b32 v15, s75, v234
    v_fma_f32 v14, v14, v2, v3
    v_mfma_f32_32x32x16_bf16 v[48:63], a[28:31], v[192:195], v[48:63]
    ds_read_b64_tr_b16 a[16:17], v4 offset:40960
    ds_read_b64_tr_b16 a[18:19], v4 offset:41984
    buffer_load_dwordx4 v9, s[8:11], s72 offen offset:1024 lds
    v_fma_f32 v15, v15, v2, v3
    v_cvt_pk_bf16_f32 v234, v14, v15
    v_mfma_f32_32x32x16_bf16 v[64:79], a[32:35], v[192:195], v[64:79]
    ds_read_b64_tr_b16 a[20:21], v5 offset:40960
    ds_read_b64_tr_b16 a[22:23], v5 offset:41984
    v_lshlrev_b32 v16, 16, v235
    v_and_b32 v17, s75, v235
    v_fma_f32 v16, v16, v2, v3
    v_fma_f32 v17, v17, v2, v3
    v_mfma_f32_32x32x16_bf16 v[80:95], a[36:39], v[192:195], v[80:95]
    s_waitcnt lgkmcnt(4)
    ds_read_b64_tr_b16 a[24:25], v6 offset:40960
    ds_read_b64_tr_b16 a[26:27], v6 offset:41984
    buffer_load_dwordx4 v10, s[8:11], s72 offen offset:2048 lds
    v_cvt_pk_bf16_f32 v235, v16, v17
    v_lshlrev_b32 v14, 16, v236
    v_mfma_f32_32x32x16_bf16 v[32:47], a[0:3], v[196:199], v[32:47]
    s_add_u32 s72, s72, 221184
    ds_read_b64_tr_b16 a[28:29], v7 offset:40960
    ds_read_b64_tr_b16 a[30:31], v7 offset:41984
    v_and_b32 v15, s75, v236
    v_fma_f32 v14, v14, v2, v3
    v_fma_f32 v15, v15, v2, v3
    v_cvt_pk_bf16_f32 v236, v14, v15
    v_mfma_f32_32x32x16_bf16 v[48:63], a[4:7], v[196:199], v[48:63]
    s_sub_u32 s93, s72, 2211840
    ds_read_b64_tr_b16 a[32:33], v4 offset:45056
    ds_read_b64_tr_b16 a[34:35], v4 offset:46080
    v_lshlrev_b32 v16, 16, v237
    v_and_b32 v17, s75, v237
L_pg0_1:
    s_cbranch_execz L_pgret0
    v_fma_f32 v16, v16, v2, v3
    v_fma_f32 v17, v17, v2, v3
    v_mfma_f32_32x32x16_bf16 v[64:79], a[8:11], v[196:199], v[64:79]
    s_min_u32 s72, s72, s93
    ds_read_b64_tr_b16 a[36:37], v5 offset:45056
    ds_read_b64_tr_b16 a[38:39], v5 offset:46080
    v_cvt_pk_bf16_f32 v237, v16, v17
    v_lshlrev_b32 v14, 16, v238
    v_and_b32 v15, s75, v238
    v_fma_f32 v14, v14, v2, v3
    v_mfma_f32_32x32x16_bf16 v[80:95], a[12:15], v[196:199], v[80:95]
    s_waitcnt lgkmcnt(4)
    ds_read_b64_tr_b16 a[0:1], v6 offset:45056
    ds_read_b64_tr_b16 a[2:3], v6 offset:46080
    v_fma_f32 v15, v15, v2, v3
    v_cvt_pk_bf16_f32 v238, v14, v15
    v_lshlrev_b32 v16, 16, v239
    v_and_b32 v17, s75, v239
    v_mfma_f32_32x32x16_bf16 v[32:47], a[16:19], v[200:203], v[32:47]
    s_add_u32 m0, s73, 57344
    ds_read_b64_tr_b16 a[4:5], v7 offset:45056
    ds_read_b64_tr_b16 a[6:7], v7 offset:46080
    buffer_load_dwordx4 v8, s[8:11], s72 offen offset:0 lds
    v_fma_f32 v16, v16, v2, v3
    v_fma_f32 v17, v17, v2, v3
    v_mfma_f32_32x32x16_bf16 v[48:63], a[20:23], v[200:203], v[48:63]
    ds_read_b64_tr_b16 a[8:9], v4 offset:49152
    ds_read_b64_tr_b16 a[10:11], v4 offset:50176
    buffer_load_dwordx4 v9, s[8:11], s72 offen offset:1024 lds
    v_cvt_pk_bf16_f32 v239, v16, v17
    v_lshlrev_b32 v14, 16, v240
    v_and_b32 v15, s75, v240
    v_mfma_f32_32x32x16_bf16 v[64:79], a[24:27], v[200:203], v[64:79]
    ds_read_b64_tr_b16 a[12:13], v5 offset:49152
    ds_read_b64_tr_b16 a[14:15], v5 offset:50176
    v_fma_f32 v14, v14, v2, v3
    v_fma_f32 v15, v15, v2, v3
    v_cvt_pk_bf16_f32 v240, v14, v15
    v_lshlrev_b32 v16, 16, v241
    v_mfma_f32_32x32x16_bf16 v[80:95], a[28:31], v[200:203], v[80:95]
    s_waitcnt lgkmcnt(4)
    ds_read_b64_tr_b16 a[16:17], v6 offset:49152
    ds_read_b64_tr_b16 a[18:19], v6 offset:50176
    buffer_load_dwordx4 v10, s[8:11], s72 offen offset:2048 lds
    v_and_b32 v17, s75, v241
    v_fma_f32 v16, v16, v2, v3
    v_mfma_f32_32x32x16_bf16 v[32:47], a[32:35], v[204:207], v[32:47]
    s_add_u32 s72, s72, 221184
    ds_read_b64_tr_b16 a[20:21], v7 offset:49152
    ds_read_b64_tr_b16 a[22:23], v7 offset:50176
    v_fma_f32 v17, v17, v2, v3
    v_cvt_pk_bf16_f32 v241, v16, v17
    v_lshlrev_b32 v14, 16, v242
    v_and_b32 v15, s75, v242
    v_mfma_f32_32x32x16_bf16 v[48:63], a[36:39], v[204:207], v[48:63]
    s_sub_u32 s93, s72, 2211840
    ds_read_b64_tr_b16 a[24:25], v4 offset:53248
    ds_read_b64_tr_b16 a[26:27], v4 offset:54272
    v_fma_f32 v14, v14, v2, v3
    v_fma_f32 v15, v15, v2, v3
    v_cvt_pk_bf16_f32 v242, v14, v15
    v_lshlrev_b32 v16, 16, v243
    v_mfma_f32_32x32x16_bf16 v[64:79], a[0:3], v[204:207], v[64:79]
    s_min_u32 s72, s72, s93
    ds_read_b64_tr_b16 a[28:29], v5 offset:53248
    ds_read_b64_tr_b16 a[30:31], v5 offset:54272
    v_and_b32 v17, s75, v243
    v_fma_f32 v16, v16, v2, v3
    v_fma_f32 v17, v17, v2, v3
    v_cvt_pk_bf16_f32 v243, v16, v17
    v_mfma_f32_32x32x16_bf16 v[80:95], a[4:7], v[204:207], v[80:95]
    s_waitcnt lgkmcnt(4)
    ds_read_b64_tr_b16 a[32:33], v6 offset:53248
    ds_read_b64_tr_b16 a[34:35], v6 offset:54272
    v_lshlrev_b32 v14, 16, v244
    v_and_b32 v15, s75, v244
    v_fma_f32 v14, v14, v2, v3
    v_fma_f32 v15, v15, v2, v3
    v_mfma_f32_32x32x16_bf16 v[32:47], a[8:11], v[208:211], v[32:47]
    s_add_u32 m0, s73, 69632
    ds_read_b64_tr_b16 a[36:37], v7 offset:53248
    ds_read_b64_tr_b16 a[38:39], v7 offset:54272
    buffer_load_dwordx4 v8, s[8:11], s72 offen offset:0 lds
    v_cvt_pk_bf16_f32 v244, v14, v15
    v_lshlrev_b32 v16, 16, v245
    v_mfma_f32_32x32x16_bf16 v[48:63], a[12:15], v[208:211], v[48:63]
    ds_read_b64_tr_b16 a[0:1], v4 offset:57344
    ds_read_b64_tr_b16 a[2:3], v4 offset:58368
    buffer_load_dwordx4 v9, s[8:11], s72 offen offset:1024 lds
    v_and_b32 v17, s75, v245
    v_fma_f32 v16, v16, v2, v3
    v_mfma_f32_32x32x16_bf16 v[64:79], a[16:19], v[208:211], v[64:79]
    ds_read_b64_tr_b16 a[4:5], v5 offset:57344
    ds_read_b64_tr_b16 a[6:7], v5 offset:58368
    v_fma_f32 v17, v17, v2, v3
    v_cvt_pk_bf16_f32 v245, v16, v17
    v_lshlrev_b32 v14, 16, v246
    v_and_b32 v15, s75, v246
    v_mfma_f32_32x32x16_bf16 v[80:95], a[20:23], v[208:211], v[80:95]
    s_waitcnt lgkmcnt(4)
    ds_read_b64_tr_b16 a[8:9], v6 offset:57344
    ds_read_b64_tr_b16 a[10:11], v6 offset:58368
    buffer_load_dwordx4 v10, s[8:11], s72 offen offset:2048 lds
    v_fma_f32 v14, v14, v2, v3
    v_fma_f32 v15, v15, v2, v3
    v_cvt_pk_bf16_f32 v246, v14, v15
    v_mfma_f32_32x32x16_bf16 v[32:47], a[24:27], v[212:215], v[32:47]
    s_add_u32 s72, s72, 221184
    ds_read_b64_tr_b16 a[12:13], v7 offset:57344
    ds_read_b64_tr_b16 a[14:15], v7 offset:58368
    v_lshlrev_b32 v16, 16, v247
    v_and_b32 v17, s75, v247
    v_fma_f32 v16, v16, v2, v3
    v_fma_f32 v17, v17, v2, v3
    v_mfma_f32_32x32x16_bf16 v[48:63], a[28:31], v[212:215], v[48:63]
    s_sub_u32 s93, s72, 2211840
    ds_read_b64_tr_b16 a[16:17], v4 offset:61440
    ds_read_b64_tr_b16 a[18:19], v4 offset:62464
    v_cvt_pk_bf16_f32 v247, v16, v17
    v_lshlrev_b32 v14, 16, v248
    v_and_b32 v15, s75, v248
    v_fma_f32 v14, v14, v2, v3
    v_mfma_f32_32x32x16_bf16 v[64:79], a[32:35], v[212:215], v[64:79]
    s_min_u32 s72, s72, s93
    ds_read_b64_tr_b16 a[20:21], v5 offset:61440
    ds_read_b64_tr_b16 a[22:23], v5 offset:62464
    v_fma_f32 v15, v15, v2, v3
    v_cvt_pk_bf16_f32 v248, v14, v15
    v_lshlrev_b32 v16, 16, v249
    v_and_b32 v17, s75, v249
    v_mfma_f32_32x32x16_bf16 v[80:95], a[36:39], v[212:215], v[80:95]
    s_waitcnt lgkmcnt(4)
    ds_read_b64_tr_b16 a[24:25], v6 offset:61440
    ds_read_b64_tr_b16 a[26:27], v6 offset:62464
    v_fma_f32 v16, v16, v2, v3
    v_fma_f32 v17, v17, v2, v3
    v_cvt_pk_bf16_f32 v249, v16, v17
    v_lshlrev_b32 v14, 16, v250
    v_mfma_f32_32x32x16_bf16 v[32:47], a[0:3], v[216:219], v[32:47]
    s_add_u32 m0, s73, 81920
    ds_read_b64_tr_b16 a[28:29], v7 offset:61440
    ds_read_b64_tr_b16 a[30:31], v7 offset:62464
    v_add_u32 v4, 4294901760, v4
    v_and_b32 v15, s75, v250
    v_fma_f32 v14, v14, v2, v3
    v_fma_f32 v15, v15, v2, v3
    v_mfma_f32_32x32x16_bf16 v[48:63], a[4:7], v[216:219], v[48:63]
    s_waitcnt vmcnt(13)
    s_barrier
    ds_read_b64_tr_b16 a[32:33], v4 offset:0
    ds_read_b64_tr_b16 a[34:35], v4 offset:1024
    buffer_load_dwordx4 v8, s[8:11], s72 offen offset:0 lds
    v_add_u32 v5, 4294901760, v5
    v_mfma_f32_32x32x16_bf16 v[64:79], a[8:11], v[216:219], v[64:79]
    ds_read_b64_tr_b16 a[36:37], v5 offset:0
    ds_read_b64_tr_b16 a[38:39], v5 offset:1024
    buffer_load_dwordx4 v9, s[8:11], s72 offen offset:1024 lds
    v_add_u32 v6, 4294901760, v6
    v_cvt_pk_bf16_f32 v250, v14, v15
    v_mfma_f32_32x32x16_bf16 v[80:95], a[12:15], v[216:219], v[80:95]
    s_waitcnt lgkmcnt(4)
    ds_read_b64_tr_b16 a[0:1], v6 offset:0
    ds_read_b64_tr_b16 a[2:3], v6 offset:1024
    buffer_load_dwordx4 v10, s[8:11], s72 offen offset:2048 lds
    v_add_u32 v7, 4294901760, v7
    v_lshlrev_b32 v16, 16, v251
    v_mfma_f32_32x32x16_bf16 v[32:47], a[16:19], v[220:223], v[32:47]
    s_add_u32 s72, s72, 221184
    ds_read_b64_tr_b16 a[4:5], v7 offset:0
    ds_read_b64_tr_b16 a[6:7], v7 offset:1024
    v_and_b32 v17, s75, v251
    v_fma_f32 v16, v16, v2, v3
    v_fma_f32 v17, v17, v2, v3
    v_cvt_pk_bf16_f32 v251, v16, v17
    v_mfma_f32_32x32x16_bf16 v[48:63], a[20:23], v[220:223], v[48:63]
    s_sub_u32 s93, s72, 2211840
    ds_read_b64_tr_b16 a[8:9], v4 offset:4096
    ds_read_b64_tr_b16 a[10:11], v4 offset:5120
    v_lshlrev_b32 v14, 16, v252
    v_and_b32 v15, s75, v252
    v_fma_f32 v14, v14, v2, v3
    v_fma_f32 v15, v15, v2, v3
    v_cvt_pk_bf16_f32 v252, v14, v15
    v_mfma_f32_32x32x16_bf16 v[64:79], a[24:27], v[220:223], v[64:79]
    s_min_u32 s72, s72, s93
    ds_read_b64_tr_b16 a[12:13], v5 offset:4096
    ds_read_b64_tr_b16 a[14:15], v5 offset:5120
    v_lshlrev_b32 v16, 16, v253
    v_and_b32 v17, s75, v253
    v_fma_f32 v16, v16, v2, v3
    v_fma_f32 v17, v17, v2, v3
    v_mfma_f32_32x32x16_bf16 v[80:95], a[28:31], v[220:223], v[80:95]
    s_waitcnt lgkmcnt(4)
    ds_read_b64_tr_b16 a[16:17], v6 offset:4096
    ds_read_b64_tr_b16 a[18:19], v6 offset:5120
    v_cvt_pk_bf16_f32 v253, v16, v17
    v_lshlrev_b32 v14, 16, v254
    v_and_b32 v15, s75, v254
    v_fma_f32 v14, v14, v2, v3
    v_mfma_f32_32x32x16_bf16 v[32:47], a[32:35], v[224:227], v[32:47]
    s_add_u32 m0, s73, 94208
    ds_read_b64_tr_b16 a[20:21], v7 offset:4096
    ds_read_b64_tr_b16 a[22:23], v7 offset:5120
    buffer_load_dwordx4 v8, s[8:11], s72 offen offset:0 lds
    v_fma_f32 v15, v15, v2, v3
    v_cvt_pk_bf16_f32 v254, v14, v15
    v_mfma_f32_32x32x16_bf16 v[48:63], a[36:39], v[224:227], v[48:63]
    ds_read_b64_tr_b16 a[24:25], v4 offset:8192
    ds_read_b64_tr_b16 a[26:27], v4 offset:9216
    buffer_load_dwordx4 v9, s[8:11], s72 offen offset:1024 lds
    v_lshlrev_b32 v16, 16, v255
    v_and_b32 v17, s75, v255
    v_mfma_f32_32x32x16_bf16 v[64:79], a[0:3], v[224:227], v[64:79]
    ds_read_b64_tr_b16 a[28:29], v5 offset:8192
    ds_read_b64_tr_b16 a[30:31], v5 offset:9216
    v_fma_f32 v16, v16, v2, v3
    v_fma_f32 v17, v17, v2, v3
    v_cvt_pk_bf16_f32 v255, v16, v17
    v_mfma_f32_32x32x16_bf16 v[80:95], a[4:7], v[224:227], v[80:95]
    s_waitcnt lgkmcnt(4)
    ds_read_b64_tr_b16 a[32:33], v6 offset:8192
    ds_read_b64_tr_b16 a[34:35], v6 offset:9216
    v_mfma_f32_32x32x16_bf16 v[32:47], a[8:11], v[228:231], v[32:47]
    ds_read_b64_tr_b16 a[36:37], v7 offset:8192
    ds_read_b64_tr_b16 a[38:39], v7 offset:9216
    buffer_load_dwordx4 v10, s[8:11], s72 offen offset:2048 lds
    v_mfma_f32_32x32x16_bf16 v[48:63], a[12:15], v[228:231], v[48:63]
    s_add_u32 s72, s72, 221184
    ds_read_b64_tr_b16 a[0:1], v4 offset:12288
    ds_read_b64_tr_b16 a[2:3], v4 offset:13312
    v_mfma_f32_32x32x16_bf16 v[64:79], a[16:19], v[228:231], v[64:79]
    s_sub_u32 s93, s72, 2211840
    ds_read_b64_tr_b16 a[4:5], v5 offset:12288
    ds_read_b64_tr_b16 a[6:7], v5 offset:13312
    v_mfma_f32_32x32x16_bf16 v[80:95], a[20:23], v[228:231], v[80:95]
    s_waitcnt lgkmcnt(4)
    ds_read_b64_tr_b16 a[8:9], v6 offset:12288
    ds_read_b64_tr_b16 a[10:11], v6 offset:13312
    v_mfma_f32_32x32x16_bf16 v[32:47], a[24:27], v[232:235], v[32:47]
    s_min_u32 s72, s72, s93
    ds_read_b64_tr_b16 a[12:13], v7 offset:12288
    ds_read_b64_tr_b16 a[14:15], v7 offset:13312
    v_mfma_f32_32x32x16_bf16 v[48:63], a[28:31], v[232:235], v[48:63]
    s_add_u32 m0, s73, 106496
    ds_read_b64_tr_b16 a[16:17], v4 offset:16384
    ds_read_b64_tr_b16 a[18:19], v4 offset:17408
    v_mfma_f32_32x32x16_bf16 v[64:79], a[32:35], v[232:235], v[64:79]
    ds_read_b64_tr_b16 a[20:21], v5 offset:16384
    ds_read_b64_tr_b16 a[22:23], v5 offset:17408
    v_mfma_f32_32x32x16_bf16 v[80:95], a[36:39], v[232:235], v[80:95]
    s_waitcnt lgkmcnt(4)
    ds_read_b64_tr_b16 a[24:25], v6 offset:16384
    ds_read_b64_tr_b16 a[26:27], v6 offset:17408
    v_mfma_f32_32x32x16_bf16 v[32:47], a[0:3], v[236:239], v[32:47]
    ds_read_b64_tr_b16 a[28:29], v7 offset:16384
    ds_read_b64_tr_b16 a[30:31], v7 offset:17408
    v_mfma_f32_32x32x16_bf16 v[48:63], a[4:7], v[236:239], v[48:63]
    ds_read_b64_tr_b16 a[32:33], v4 offset:20480
    ds_read_b64_tr_b16 a[34:35], v4 offset:21504
    v_mfma_f32_32x32x16_bf16 v[64:79], a[8:11], v[236:239], v[64:79]
    ds_read_b64_tr_b16 a[36:37], v5 offset:20480
    ds_read_b64_tr_b16 a[38:39], v5 offset:21504
    v_mfma_f32_32x32x16_bf16 v[80:95], a[12:15], v[236:239], v[80:95]
    s_waitcnt lgkmcnt(4)
    ds_read_b64_tr_b16 a[0:1], v6 offset:20480
    ds_read_b64_tr_b16 a[2:3], v6 offset:21504
    v_mfma_f32_32x32x16_bf16 v[32:47], a[16:19], v[240:243], v[32:47]
    ds_read_b64_tr_b16 a[4:5], v7 offset:20480
    ds_read_b64_tr_b16 a[6:7], v7 offset:21504
    v_mfma_f32_32x32x16_bf16 v[48:63], a[20:23], v[240:243], v[48:63]
    ds_read_b64_tr_b16 a[8:9], v4 offset:24576
    ds_read_b64_tr_b16 a[10:11], v4 offset:25600
    v_mfma_f32_32x32x16_bf16 v[64:79], a[24:27], v[240:243], v[64:79]
    ds_read_b64_tr_b16 a[12:13], v5 offset:24576
    ds_read_b64_tr_b16 a[14:15], v5 offset:25600
    v_mfma_f32_32x32x16_bf16 v[80:95], a[28:31], v[240:243], v[80:95]
    s_waitcnt lgkmcnt(4)
    ds_read_b64_tr_b16 a[16:17], v6 offset:24576
    ds_read_b64_tr_b16 a[18:19], v6 offset:25600
    v_mfma_f32_32x32x16_bf16 v[32:47], a[32:35], v[244:247], v[32:47]
    ds_read_b64_tr_b16 a[20:21], v7 offset:24576
    ds_read_b64_tr_b16 a[22:23], v7 offset:25600
    v_mfma_f32_32x32x16_bf16 v[48:63], a[36:39], v[244:247], v[48:63]
    ds_read_b64_tr_b16 a[24:25], v4 offset:28672
    ds_read_b64_tr_b16 a[26:27], v4 offset:29696
    v_mfma_f32_32x32x16_bf16 v[64:79], a[0:3], v[244:247], v[64:79]
    ds_read_b64_tr_b16 a[28:29], v5 offset:28672
    ds_read_b64_tr_b16 a[30:31], v5 offset:29696
    v_accvgpr_read_b32 v23, a111
    v_mfma_f32_32x32x16_bf16 v[80:95], a[4:7], v[244:247], v[80:95]
    s_waitcnt lgkmcnt(4)
    ds_read_b64_tr_b16 a[32:33], v6 offset:28672
    ds_read_b64_tr_b16 a[34:35], v6 offset:29696
    buffer_load_dword v22, v23, s[12:15], 0 offen sc1
    v_mfma_f32_32x32x16_bf16 v[32:47], a[8:11], v[248:251], v[32:47]
    ds_read_b64_tr_b16 a[36:37], v7 offset:28672
    ds_read_b64_tr_b16 a[38:39], v7 offset:29696
    v_mfma_f32_32x32x16_bf16 v[48:63], a[12:15], v[248:251], v[48:63]
    s_waitcnt vmcnt(13)
    s_barrier
    ds_read_b64_tr_b16 a[0:1], v12 offset:32768
    ds_read_b64_tr_b16 a[2:3], v12 offset:33536
    buffer_load_dwordx4 v8, s[8:11], s72 offen offset:0 lds
    v_mfma_f32_32x32x16_bf16 v[64:79], a[16:19], v[248:251], v[64:79]
    ds_read_b64_tr_b16 a[4:5], v12 offset:32832
    ds_read_b64_tr_b16 a[6:7], v12 offset:33600
    buffer_load_dwordx4 v9, s[8:11], s72 offen offset:1024 lds
    v_mfma_f32_32x32x16_bf16 v[80:95], a[20:23], v[248:251], v[80:95]
    s_waitcnt lgkmcnt(4)
    ds_read_b64_tr_b16 a[8:9], v12 offset:32896
    ds_read_b64_tr_b16 a[10:11], v12 offset:33664
    buffer_load_dwordx4 v10, s[8:11], s72 offen offset:2048 lds
    v_mfma_f32_32x32x16_bf16 v[32:47], a[24:27], v[252:255], v[32:47]
    s_add_u32 s72, s72, 221184
    ds_read_b64_tr_b16 a[12:13], v12 offset:35840
    ds_read_b64_tr_b16 a[14:15], v12 offset:36608
    v_mfma_f32_32x32x16_bf16 v[48:63], a[28:31], v[252:255], v[48:63]
    s_sub_u32 s93, s72, 2211840
    ds_read_b64_tr_b16 a[16:17], v12 offset:35904
    ds_read_b64_tr_b16 a[18:19], v12 offset:36672
    v_mfma_f32_32x32x16_bf16 v[64:79], a[32:35], v[252:255], v[64:79]
    s_min_u32 s72, s72, s93
    ds_read_b64_tr_b16 a[20:21], v12 offset:35968
    ds_read_b64_tr_b16 a[22:23], v12 offset:36736
    v_mfma_f32_32x32x16_bf16 v[80:95], a[36:39], v[252:255], v[80:95]
    s_waitcnt lgkmcnt(6)
    ds_read_b64_tr_b16 a[24:25], v12 offset:38912
    ds_read_b64_tr_b16 a[26:27], v12 offset:39680
    v_mfma_f32_32x32x16_bf16 a[40:55], a[0:3], v[96:99], 0
    s_add_u32 m0, s73, 118784
    ds_read_b64_tr_b16 a[28:29], v12 offset:38976
    ds_read_b64_tr_b16 a[30:31], v12 offset:39744
    buffer_load_dwordx4 v8, s[8:11], s72 offen offset:0 lds
    v_exp_f32_e64 v14, -v32
    v_exp_f32_e64 v15, -v33
    v_mfma_f32_32x32x16_bf16 a[56:71], a[4:7], v[96:99], 0
    ds_read_b64_tr_b16 a[32:33], v12 offset:39040
    ds_read_b64_tr_b16 a[34:35], v12 offset:39808
    buffer_load_dwordx4 v9, s[8:11], s72 offen offset:1024 lds
    v_exp_f32_e64 v16, -v34
    v_exp_f32_e64 v17, -v35
    v_fma_f32 v14, v14, s76, s76
    v_mfma_f32_32x32x16_bf16 a[72:87], a[8:11], v[96:99], 0
    s_waitcnt lgkmcnt(6)
    ds_read_b64_tr_b16 a[36:37], v12 offset:41984
    ds_read_b64_tr_b16 a[38:39], v12 offset:42752
    buffer_load_dwordx4 v10, s[8:11], s72 offen offset:2048 lds
    v_fma_f32 v15, v15, s76, s76
    v_fma_f32 v16, v16, s76, s76
    v_fma_f32 v17, v17, s76, s76
    v_rcp_f32 v14, v14
    v_mfma_f32_32x32x16_bf16 a[40:55], a[12:15], v[100:103], a[40:55]
    s_add_u32 s72, s72, 221184
    ds_read_b64_tr_b16 a[0:1], v12 offset:42048
    ds_read_b64_tr_b16 a[2:3], v12 offset:42816
    v_rcp_f32 v15, v15
    v_rcp_f32 v16, v16
    v_rcp_f32 v17, v17
    v_mfma_f32_32x32x16_bf16 a[56:71], a[16:19], v[100:103], a[56:71]
    s_sub_u32 s93, s72, 2211840
    ds_read_b64_tr_b16 a[4:5], v12 offset:42112
    ds_read_b64_tr_b16 a[6:7], v12 offset:42880
    v_mul_f32 v32, v32, v14
    v_mul_f32 v33, v33, v15
    v_mul_f32 v34, v34, v16
    v_mul_f32 v35, v35, v17
    v_exp_f32_e64 v14, -v36
    v_mfma_f32_32x32x16_bf16 a[72:87], a[20:23], v[100:103], a[72:87]
    s_waitcnt lgkmcnt(6)
    ds_read_b64_tr_b16 a[8:9], v12 offset:45056
    ds_read_b64_tr_b16 a[10:11], v12 offset:45824
    v_exp_f32_e64 v15, -v37
    v_exp_f32_e64 v16, -v38
    v_exp_f32_e64 v17, -v39
    v_fma_f32 v14, v14, s76, s76
    v_mfma_f32_32x32x16_bf16 a[40:55], a[24:27], v[104:107], a[40:55]
    s_min_u32 s72, s72, s93
    ds_read_b64_tr_b16 a[12:13], v12 offset:45120
    ds_read_b64_tr_b16 a[14:15], v12 offset:45888
    v_fma_f32 v15, v15, s76, s76
    v_fma_f32 v16, v16, s76, s76
    v_fma_f32 v17, v17, s76, s76
    v_rcp_f32 v14, v14
    v_rcp_f32 v15, v15
    v_mfma_f32_32x32x16_bf16 a[56:71], a[28:31], v[104:107], a[56:71]
    s_add_u32 m0, s73, 131072
    ds_read_b64_tr_b16 a[16:17], v12 offset:45184
    ds_read_b64_tr_b16 a[18:19], v12 offset:45952
    buffer_load_dwordx4 v8, s[8:11], s72 offen offset:0 lds
    v_rcp_f32 v16, v16
    v_rcp_f32 v17, v17
    v_mfma_f32_32x32x16_bf16 a[72:87], a[32:35], v[104:107], a[72:87]
    s_waitcnt lgkmcnt(6)
    ds_read_b64_tr_b16 a[20:21], v12 offset:48128
    ds_read_b64_tr_b16 a[22:23], v12 offset:48896
    buffer_load_dwordx4 v9, s[8:11], s72 offen offset:1024 lds
    v_mul_f32 v36, v36, v14
    v_mul_f32 v37, v37, v15
    v_mul_f32 v38, v38, v16
    v_mul_f32 v39, v39, v17
    v_cvt_pk_bf16_f32 v32, v32, v33
    v_mfma_f32_32x32x16_bf16 a[40:55], a[36:39], v[108:111], a[40:55]
    s_waitcnt vmcnt(8)
    v_cmp_ne_u32 vcc, 1, v22
    s_cbranch_vccnz L_spin1
L_back1:
    ds_read_b64_tr_b16 a[24:25], v12 offset:48192
    ds_read_b64_tr_b16 a[26:27], v12 offset:48960
    buffer_load_dwordx4 v10, s[8:11], s72 offen offset:2048 lds
    v_cvt_pk_bf16_f32 v33, v34, v35
    v_cvt_pk_bf16_f32 v34, v36, v37
    v_cvt_pk_bf16_f32 v35, v38, v39
    v_mfma_f32_32x32x16_bf16 a[56:71], a[0:3], v[108:111], a[56:71]
    s_add_u32 s72, s72, 221184
    ds_read_b64_tr_b16 a[28:29], v12 offset:48256
    ds_read_b64_tr_b16 a[30:31], v12 offset:49024
    buffer_store_dwordx4 v[32:35], v13, s[12:15], s42 offen offset:0 sc1
    v_exp_f32_e64 v14, -v40
    v_exp_f32_e64 v15, -v41
    v_exp_f32_e64 v16, -v42
    v_mfma_f32_32x32x16_bf16 a[72:87], a[4:7], v[108:111], a[72:87]
    s_waitcnt lgkmcnt(6)
    ds_read_b64_tr_b16 a[32:33], v12 offset:51200
    ds_read_b64_tr_b16 a[34:35], v12 offset:51968
    v_exp_f32_e64 v17, -v43
    v_fma_f32 v14, v14, s76, s76
    v_fma_f32 v15, v15, s76, s76
    v_fma_f32 v16, v16, s76, s76
    v_fma_f32 v17, v17, s76, s76
    v_mfma_f32_32x32x16_bf16 a[40:55], a[8:11], v[112:115], a[40:55]
    s_sub_u32 s93, s72, 2211840
    ds_read_b64_tr_b16 a[36:37], v12 offset:51264
    ds_read_b64_tr_b16 a[38:39], v12 offset:52032
    buffer_load_dwordx4 a[128:131], v1, s[12:15], s49 offen offset:0 sc1
    v_rcp_f32 v14, v14
    v_rcp_f32 v15, v15
    v_mfma_f32_32x32x16_bf16 a[56:71], a[12:15], v[112:115], a[56:71]
    s_min_u32 s72, s72, s93
    ds_read_b64_tr_b16 a[0:1], v12 offset:51328
    ds_read_b64_tr_b16 a[2:3], v12 offset:52096
    v_rcp_f32 v16, v16
    v_rcp_f32 v17, v17
    v_mul_f32 v40, v40, v14
    v_mul_f32 v41, v41, v15
    v_mul_f32 v42, v42, v16
    v_mfma_f32_32x32x16_bf16 a[72:87], a[16:19], v[112:115], a[72:87]
    s_waitcnt lgkmcnt(6)
    ds_read_b64_tr_b16 a[4:5], v12 offset:54272
    ds_read_b64_tr_b16 a[6:7], v12 offset:55040
    buffer_load_dwordx4 a[132:135], v1, s[12:15], s49 offen offset:1024 sc1
    v_mul_f32 v43, v43, v17
    v_exp_f32_e64 v14, -v44
    v_exp_f32_e64 v15, -v45
    v_mfma_f32_32x32x16_bf16 a[40:55], a[20:23], v[116:119], a[40:55]
    s_add_u32 m0, s73, 143360
    ds_read_b64_tr_b16 a[8:9], v12 offset:54336
    ds_read_b64_tr_b16 a[10:11], v12 offset:55104
    v_exp_f32_e64 v16, -v46
    v_exp_f32_e64 v17, -v47
    v_fma_f32 v14, v14, s76, s76
    v_fma_f32 v15, v15, s76, s76
    v_mfma_f32_32x32x16_bf16 a[56:71], a[24:27], v[116:119], a[56:71]
    ds_read_b64_tr_b16 a[12:13], v12 offset:54400
    ds_read_b64_tr_b16 a[14:15], v12 offset:55168
    buffer_load_dwordx4 v8, s[8:11], s72 offen offset:0 lds
    v_fma_f32 v16, v16, s76, s76
    v_fma_f32 v17, v17, s76, s76
    v_rcp_f32 v14, v14
    v_mfma_f32_32x32x16_bf16 a[72:87], a[28:31], v[116:119], a[72:87]
    s_waitcnt lgkmcnt(6)
    s_barrier
    ds_read_b64_tr_b16 a[16:17], v12 offset:57344
    ds_read_b64_tr_b16 a[18:19], v12 offset:58112
    v_rcp_f32 v15, v15
    v_rcp_f32 v16, v16
    v_rcp_f32 v17, v17
    v_mfma_f32_32x32x16_bf16 a[40:55], a[32:35], v[120:123], a[40:55]
    ds_read_b64_tr_b16 a[20:21], v12 offset:57408
    ds_read_b64_tr_b16 a[22:23], v12 offset:58176
    buffer_load_dwordx4 v9, s[8:11], s72 offen offset:1024 lds
    v_mul_f32 v44, v44, v14
    v_mul_f32 v45, v45, v15
    v_mul_f32 v46, v46, v16
    v_mul_f32 v47, v47, v17
    v_cvt_pk_bf16_f32 v40, v40, v41
    v_mfma_f32_32x32x16_bf16 a[56:71], a[36:39], v[120:123], a[56:71]
    ds_read_b64_tr_b16 a[24:25], v12 offset:57472
    ds_read_b64_tr_b16 a[26:27], v12 offset:58240
    v_cvt_pk_bf16_f32 v41, v42, v43
    v_cvt_pk_bf16_f32 v42, v44, v45
    v_cvt_pk_bf16_f32 v43, v46, v47
    v_exp_f32_e64 v14, -v48
    v_mfma_f32_32x32x16_bf16 a[72:87], a[0:3], v[120:123], a[72:87]
    s_waitcnt lgkmcnt(6)
    ds_read_b64_tr_b16 a[28:29], v12 offset:60416
    ds_read_b64_tr_b16 a[30:31], v12 offset:61184
    buffer_load_dwordx4 v10, s[8:11], s72 offen offset:2048 lds
    v_exp_f32_e64 v15, -v49
    v_exp_f32_e64 v16, -v50
    v_exp_f32_e64 v17, -v51
    v_mfma_f32_32x32x16_bf16 a[40:55], a[4:7], v[124:127], a[40:55]
    ds_read_b64_tr_b16 a[32:33], v12 offset:60480
    ds_read_b64_tr_b16 a[34:35], v12 offset:61248
    buffer_store_dwordx4 v[40:43], v13, s[12:15], s42 offen offset:512 sc1
    v_fma_f32 v14, v14, s76, s76
    v_fma_f32 v15, v15, s76, s76
    v_fma_f32 v16, v16, s76, s76
    v_fma_f32 v17, v17, s76, s76
    v_mfma_f32_32x32x16_bf16 a[56:71], a[8:11], v[124:127], a[56:71]
    ds_read_b64_tr_b16 a[36:37], v12 offset:60544
    ds_read_b64_tr_b16 a[38:39], v12 offset:61312
    v_rcp_f32 v14, v14
    v_rcp_f32 v15, v15
    v_rcp_f32 v16, v16
    v_mfma_f32_32x32x16_bf16 a[72:87], a[12:15], v[124:127], a[72:87]
    s_waitcnt lgkmcnt(6)
    ds_read_b64_tr_b16 a[0:1], v12 offset:63488
    ds_read_b64_tr_b16 a[2:3], v12 offset:64256
    v_rcp_f32 v17, v17
    v_mul_f32 v48, v48, v14
    v_mul_f32 v49, v49, v15
    v_mul_f32 v50, v50, v16
    v_mul_f32 v51, v51, v17
    v_mfma_f32_32x32x16_bf16 a[40:55], a[16:19], v[128:131], a[40:55]
    ds_read_b64_tr_b16 a[4:5], v12 offset:63552
    ds_read_b64_tr_b16 a[6:7], v12 offset:64320
    buffer_load_dwordx4 a[136:139], v1, s[12:15], s49 offen offset:2048 sc1
    v_exp_f32_e64 v14, -v52
    v_exp_f32_e64 v15, -v53
    v_exp_f32_e64 v16, -v54
    v_mfma_f32_32x32x16_bf16 a[56:71], a[20:23], v[128:131], a[56:71]
    ds_read_b64_tr_b16 a[8:9], v12 offset:63616
    ds_read_b64_tr_b16 a[10:11], v12 offset:64384
    buffer_load_dwordx4 a[140:143], v1, s[12:15], s49 offen offset:3072 sc1
    v_add_u32 v12, 66560, v12
    v_exp_f32_e64 v17, -v55
    v_fma_f32 v14, v14, s76, s76
    v_mfma_f32_32x32x16_bf16 a[72:87], a[24:27], v[128:131], a[72:87]
    s_waitcnt lgkmcnt(6)
    ds_read_b64_tr_b16 a[12:13], v12 offset:0
    ds_read_b64_tr_b16 a[14:15], v12 offset:768
    v_fma_f32 v15, v15, s76, s76
    v_fma_f32 v16, v16, s76, s76
    v_fma_f32 v17, v17, s76, s76
    v_rcp_f32 v14, v14
    v_rcp_f32 v15, v15
    v_mfma_f32_32x32x16_bf16 a[40:55], a[28:31], v[132:135], a[40:55]
    s_add_u32 s49, s49, 4096
    ds_read_b64_tr_b16 a[16:17], v12 offset:64
    ds_read_b64_tr_b16 a[18:19], v12 offset:832
    buffer_load_dwordx4 a[144:147], v1, s[12:15], s49 offen offset:0 sc1
    v_rcp_f32 v16, v16
    v_rcp_f32 v17, v17
    v_mfma_f32_32x32x16_bf16 a[56:71], a[32:35], v[132:135], a[56:71]
    ds_read_b64_tr_b16 a[20:21], v12 offset:128
    ds_read_b64_tr_b16 a[22:23], v12 offset:896
    buffer_load_dwordx4 a[148:151], v1, s[12:15], s49 offen offset:1024 sc1
    v_mul_f32 v52, v52, v14
    v_mul_f32 v53, v53, v15
    v_mul_f32 v54, v54, v16
    v_mul_f32 v55, v55, v17
    v_cvt_pk_bf16_f32 v48, v48, v49
    v_mfma_f32_32x32x16_bf16 a[72:87], a[36:39], v[132:135], a[72:87]
    s_waitcnt lgkmcnt(6)
    ds_read_b64_tr_b16 a[24:25], v12 offset:3072
    ds_read_b64_tr_b16 a[26:27], v12 offset:3840
    v_cvt_pk_bf16_f32 v49, v50, v51
    v_cvt_pk_bf16_f32 v50, v52, v53
    v_cvt_pk_bf16_f32 v51, v54, v55
    v_exp_f32_e64 v14, -v56
    v_mfma_f32_32x32x16_bf16 a[40:55], a[0:3], v[136:139], a[40:55]
    ds_read_b64_tr_b16 a[28:29], v12 offset:3136
    ds_read_b64_tr_b16 a[30:31], v12 offset:3904
    buffer_store_dwordx4 v[48:51], v13, s[12:15], s42 offen offset:1024 sc1
    v_exp_f32_e64 v15, -v57
L_pg0_2:
    s_cbranch_execz L_pgret0
    v_exp_f32_e64 v16, -v58
    v_exp_f32_e64 v17, -v59
    v_mfma_f32_32x32x16_bf16 a[56:71], a[4:7], v[136:139], a[56:71]
    ds_read_b64_tr_b16 a[32:33], v12 offset:3200
    ds_read_b64_tr_b16 a[34:35], v12 offset:3968
    buffer_load_dwordx4 a[152:155], v1, s[12:15], s49 offen offset:2048 sc1
    v_fma_f32 v14, v14, s76, s76
    v_fma_f32 v15, v15, s76, s76
    v_fma_f32 v16, v16, s76, s76
    v_fma_f32 v17, v17, s76, s76
    v_mfma_f32_32x32x16_bf16 a[72:87], a[8:11], v[136:139], a[72:87]
    s_waitcnt lgkmcnt(6)
    ds_read_b64_tr_b16 a[36:37], v12 offset:6144
    ds_read_b64_tr_b16 a[38:39], v12 offset:6912
    v_rcp_f32 v14, v14
    v_rcp_f32 v15, v15
    v_rcp_f32 v16, v16
    v_mfma_f32_32x32x16_bf16 a[40:55], a[12:15], v[140:143], a[40:55]
    ds_read_b64_tr_b16 a[0:1], v12 offset:6208
    ds_read_b64_tr_b16 a[2:3], v12 offset:6976
    buffer_load_dwordx4 a[156:159], v1, s[12:15], s49 offen offset:3072 sc1
    v_rcp_f32 v17, v17
    v_mul_f32 v56, v56, v14
    v_mul_f32 v57, v57, v15
    v_mul_f32 v58, v58, v16
    v_mfma_f32_32x32x16_bf16 a[56:71], a[16:19], v[140:143], a[56:71]
    s_add_u32 s49, s49, 4096
    ds_read_b64_tr_b16 a[4:5], v12 offset:6272
    ds_read_b64_tr_b16 a[6:7], v12 offset:7040
    buffer_load_dwordx4 a[160:163], v1, s[12:15], s49 offen offset:0 sc1
    v_mul_f32 v59, v59, v17
    v_exp_f32_e64 v14, -v60
    v_exp_f32_e64 v15, -v61
    v_mfma_f32_32x32x16_bf16 a[72:87], a[20:23], v[140:143], a[72:87]
    s_waitcnt lgkmcnt(6)
    ds_read_b64_tr_b16 a[8:9], v12 offset:9216
    ds_read_b64_tr_b16 a[10:11], v12 offset:9984
    v_exp_f32_e64 v16, -v62
    v_exp_f32_e64 v17, -v63
    v_fma_f32 v14, v14, s76, s76
    v_fma_f32 v15, v15, s76, s76
    v_mfma_f32_32x32x16_bf16 a[40:55], a[24:27], v[144:147], a[40:55]
    ds_read_b64_tr_b16 a[12:13], v12 offset:9280
    ds_read_b64_tr_b16 a[14:15], v12 offset:10048
    buffer_load_dwordx4 a[164:167], v1, s[12:15], s49 offen offset:1024 sc1
    v_fma_f32 v16, v16, s76, s76
    v_fma_f32 v17, v17, s76, s76
    v_rcp_f32 v14, v14
    v_mfma_f32_32x32x16_bf16 a[56:71], a[28:31], v[144:147], a[56:71]
    s_add_u32 s49, s49, 12288
    ds_read_b64_tr_b16 a[16:17], v12 offset:9344
    ds_read_b64_tr_b16 a[18:19], v12 offset:10112
    v_rcp_f32 v15, v15
    v_rcp_f32 v16, v16
    v_rcp_f32 v17, v17
    v_mul_f32 v60, v60, v14
    v_mfma_f32_32x32x16_bf16 a[72:87], a[32:35], v[144:147], a[72:87]
    s_waitcnt lgkmcnt(6)
    ds_read_b64_tr_b16 a[20:21], v12 offset:12288
    ds_read_b64_tr_b16 a[22:23], v12 offset:13056
    buffer_load_dwordx4 a[168:171], v1, s[12:15], s49 offen offset:0 sc1
    v_mul_f32 v61, v61, v15
    v_mul_f32 v62, v62, v16
    v_mul_f32 v63, v63, v17
    v_cvt_pk_bf16_f32 v56, v56, v57
    v_cvt_pk_bf16_f32 v57, v58, v59
    v_mfma_f32_32x32x16_bf16 a[40:55], a[36:39], v[148:151], a[40:55]
    ds_read_b64_tr_b16 a[24:25], v12 offset:12352
    ds_read_b64_tr_b16 a[26:27], v12 offset:13120
    buffer_load_dwordx4 a[172:175], v1, s[12:15], s49 offen offset:1024 sc1
    v_cvt_pk_bf16_f32 v58, v60, v61
    v_cvt_pk_bf16_f32 v59, v62, v63
    v_exp_f32_e64 v14, -v64
    v_mfma_f32_32x32x16_bf16 a[56:71], a[0:3], v[148:151], a[56:71]
    ds_read_b64_tr_b16 a[28:29], v12 offset:12416
    ds_read_b64_tr_b16 a[30:31], v12 offset:13184
    buffer_store_dwordx4 v[56:59], v13, s[12:15], s42 offen offset:1536 sc1
    v_exp_f32_e64 v15, -v65
    v_exp_f32_e64 v16, -v66
    v_mfma_f32_32x32x16_bf16 a[72:87], a[4:7], v[148:151], a[72:87]
    s_waitcnt lgkmcnt(6)
    ds_read_b64_tr_b16 a[32:33], v12 offset:15360
    ds_read_b64_tr_b16 a[34:35], v12 offset:16128
    v_exp_f32_e64 v17, -v67
    v_fma_f32 v14, v14, s76, s76
    v_fma_f32 v15, v15, s76, s76
    v_fma_f32 v16, v16, s76, s76
    v_fma_f32 v17, v17, s76, s76
    v_mfma_f32_32x32x16_bf16 a[40:55], a[8:11], v[152:155], a[40:55]
    ds_read_b64_tr_b16 a[36:37], v12 offset:15424
    ds_read_b64_tr_b16 a[38:39], v12 offset:16192
    buffer_load_dwordx4 a[176:179], v1, s[12:15], s49 offen offset:2048 sc1
    v_rcp_f32 v14, v14
    v_rcp_f32 v15, v15
    v_rcp_f32 v16, v16
    v_mfma_f32_32x32x16_bf16 a[56:71], a[12:15], v[152:155], a[56:71]
    ds_read_b64_tr_b16 a[0:1], v12 offset:15488
    ds_read_b64_tr_b16 a[2:3], v12 offset:16256
    v_rcp_f32 v17, v17
    v_mul_f32 v64, v64, v14
    v_mul_f32 v65, v65, v15
    v_mul_f32 v66, v66, v16
    v_mul_f32 v67, v67, v17
    v_mfma_f32_32x32x16_bf16 a[72:87], a[16:19], v[152:155], a[72:87]
    s_waitcnt lgkmcnt(6)
    ds_read_b64_tr_b16 a[4:5], v12 offset:18432
    ds_read_b64_tr_b16 a[6:7], v12 offset:19200
    buffer_load_dwordx4 a[180:183], v1, s[12:15], s49 offen offset:3072 sc1
    v_exp_f32_e64 v14, -v68
    v_exp_f32_e64 v15, -v69
    v_mfma_f32_32x32x16_bf16 a[40:55], a[20:23], v[156:159], a[40:55]
    s_add_u32 s49, s49, 4096
    ds_read_b64_tr_b16 a[8:9], v12 offset:18496
    ds_read_b64_tr_b16 a[10:11], v12 offset:19264
    buffer_load_dwordx4 a[184:187], v1, s[12:15], s49 offen offset:0 sc1
    v_exp_f32_e64 v16, -v70
    v_exp_f32_e64 v17, -v71
    v_fma_f32 v14, v14, s76, s76
    v_mfma_f32_32x32x16_bf16 a[56:71], a[24:27], v[156:159], a[56:71]
    ds_read_b64_tr_b16 a[12:13], v12 offset:18560
    ds_read_b64_tr_b16 a[14:15], v12 offset:19328
    v_fma_f32 v15, v15, s76, s76
    v_fma_f32 v16, v16, s76, s76
    v_fma_f32 v17, v17, s76, s76
    v_rcp_f32 v14, v14
    v_rcp_f32 v15, v15
    v_mfma_f32_32x32x16_bf16 a[72:87], a[28:31], v[156:159], a[72:87]
    s_waitcnt lgkmcnt(6)
    ds_read_b64_tr_b16 a[16:17], v12 offset:21504
    ds_read_b64_tr_b16 a[18:19], v12 offset:22272
    buffer_load_dwordx4 a[188:191], v1, s[12:15], s49 offen offset:1024 sc1
    v_rcp_f32 v16, v16
    v_rcp_f32 v17, v17
    v_mfma_f32_32x32x16_bf16 a[40:55], a[32:35], v[160:163], a[40:55]
    ds_read_b64_tr_b16 a[20:21], v12 offset:21568
    ds_read_b64_tr_b16 a[22:23], v12 offset:22336
    v_mul_f32 v68, v68, v14
    v_mul_f32 v69, v69, v15
    v_mul_f32 v70, v70, v16
    v_mul_f32 v71, v71, v17
    v_cvt_pk_bf16_f32 v64, v64, v65
    v_cvt_pk_bf16_f32 v65, v66, v67
    v_cvt_pk_bf16_f32 v66, v68, v69
    v_mfma_f32_32x32x16_bf16 a[56:71], a[36:39], v[160:163], a[56:71]
    ds_read_b64_tr_b16 a[24:25], v12 offset:21632
    ds_read_b64_tr_b16 a[26:27], v12 offset:22400
    buffer_load_dwordx4 a[192:195], v1, s[12:15], s49 offen offset:2048 sc1
    v_cvt_pk_bf16_f32 v67, v70, v71
    v_exp_f32_e64 v14, -v72
    v_mfma_f32_32x32x16_bf16 a[72:87], a[0:3], v[160:163], a[72:87]
    s_waitcnt lgkmcnt(6)
    ds_read_b64_tr_b16 a[28:29], v12 offset:24576
    ds_read_b64_tr_b16 a[30:31], v12 offset:25344
    buffer_store_dwordx4 v[64:67], v13, s[12:15], s42 offen offset:2048 sc1
    v_exp_f32_e64 v15, -v73
    v_exp_f32_e64 v16, -v74
    v_exp_f32_e64 v17, -v75
    v_mfma_f32_32x32x16_bf16 a[40:55], a[4:7], v[164:167], a[40:55]
    ds_read_b64_tr_b16 a[32:33], v12 offset:24640
    ds_read_b64_tr_b16 a[34:35], v12 offset:25408
    v_fma_f32 v14, v14, s76, s76
    v_fma_f32 v15, v15, s76, s76
    v_fma_f32 v16, v16, s76, s76
    v_fma_f32 v17, v17, s76, s76
    v_rcp_f32 v14, v14
    v_mfma_f32_32x32x16_bf16 a[56:71], a[8:11], v[164:167], a[56:71]
    ds_read_b64_tr_b16 a[36:37], v12 offset:24704
    ds_read_b64_tr_b16 a[38:39], v12 offset:25472
    buffer_load_dwordx4 a[196:199], v1, s[12:15], s49 offen offset:3072 sc1
    v_rcp_f32 v15, v15
    v_rcp_f32 v16, v16
    v_mfma_f32_32x32x16_bf16 a[72:87], a[12:15], v[164:167], a[72:87]
    s_waitcnt vmcnt(20) lgkmcnt(6)
    s_barrier
    ds_read_b64_tr_b16 a[0:1], v12 offset:27648
    ds_read_b64_tr_b16 a[2:3], v12 offset:28416
    v_rcp_f32 v17, v17
    v_mul_f32 v72, v72, v14
    v_mul_f32 v73, v73, v15
    v_mul_f32 v74, v74, v16
    v_mul_f32 v75, v75, v17
    v_mfma_f32_32x32x16_bf16 a[40:55], a[16:19], v[168:171], a[40:55]
    s_add_u32 s49, s49, 4096
    ds_read_b64_tr_b16 a[4:5], v12 offset:27712
    ds_read_b64_tr_b16 a[6:7], v12 offset:28480
    buffer_load_dwordx4 a[200:203], v1, s[12:15], s49 offen offset:0 sc1
    v_exp_f32_e64 v14, -v76
    v_exp_f32_e64 v15, -v77
    v_mfma_f32_32x32x16_bf16 a[56:71], a[20:23], v[168:171], a[56:71]
    ds_read_b64_tr_b16 a[8:9], v12 offset:27776
    ds_read_b64_tr_b16 a[10:11], v12 offset:28544
    buffer_load_dwordx4 a[204:207], v1, s[12:15], s49 offen offset:1024 sc1
    v_exp_f32_e64 v16, -v78
    v_exp_f32_e64 v17, -v79
    v_fma_f32 v14, v14, s76, s76
    v_mfma_f32_32x32x16_bf16 a[72:87], a[24:27], v[168:171], a[72:87]
    s_waitcnt lgkmcnt(6)
    ds_read_b64_tr_b16 a[12:13], v12 offset:30720
    ds_read_b64_tr_b16 a[14:15], v12 offset:31488
    v_fma_f32 v15, v15, s76, s76
    v_fma_f32 v16, v16, s76, s76
    v_fma_f32 v17, v17, s76, s76
    v_rcp_f32 v14, v14
    v_rcp_f32 v15, v15
    v_mfma_f32_32x32x16_bf16 a[40:55], a[28:31], v[172:175], a[40:55]
    s_add_u32 s49, s49, 4294948864
    ds_read_b64_tr_b16 a[16:17], v12 offset:30784
    ds_read_b64_tr_b16 a[18:19], v12 offset:31552
    buffer_load_dwordx4 a[208:211], v1, s[12:15], s49 offen offset:0 sc1
    v_rcp_f32 v16, v16
    v_rcp_f32 v17, v17
    v_mfma_f32_32x32x16_bf16 a[56:71], a[32:35], v[172:175], a[56:71]
    ds_read_b64_tr_b16 a[20:21], v12 offset:30848
    ds_read_b64_tr_b16 a[22:23], v12 offset:31616
    buffer_load_dwordx4 a[212:215], v1, s[12:15], s49 offen offset:1024 sc1
    v_mul_f32 v76, v76, v14
    v_mul_f32 v77, v77, v15
    v_mul_f32 v78, v78, v16
    v_mul_f32 v79, v79, v17
    v_cvt_pk_bf16_f32 v72, v72, v73
    v_mfma_f32_32x32x16_bf16 a[72:87], a[36:39], v[172:175], a[72:87]
    s_waitcnt lgkmcnt(6)
    ds_read_b64_tr_b16 a[24:25], v12 offset:33792
    ds_read_b64_tr_b16 a[26:27], v12 offset:34560
    buffer_load_dwordx4 a[216:219], v1, s[12:15], s49 offen offset:2048 sc1
    v_cvt_pk_bf16_f32 v73, v74, v75
    v_cvt_pk_bf16_f32 v74, v76, v77
    v_cvt_pk_bf16_f32 v75, v78, v79
    v_mfma_f32_32x32x16_bf16 a[40:55], a[0:3], v[176:179], a[40:55]
    s_waitcnt vmcnt(12)
    ds_read_b64_tr_b16 a[28:29], v12 offset:33856
    ds_read_b64_tr_b16 a[30:31], v12 offset:34624
    buffer_store_dwordx4 v[72:75], v13, s[12:15], s42 offen offset:2560 sc1
    v_mov_b32 v20, 1
    v_exp_f32_e64 v14, -v80
    v_exp_f32_e64 v15, -v81
    v_mfma_f32_32x32x16_bf16 a[56:71], a[4:7], v[176:179], a[56:71]
    ds_read_b64_tr_b16 a[32:33], v12 offset:33920
    ds_read_b64_tr_b16 a[34:35], v12 offset:34688
    buffer_atomic_add v20, v30, s[12:15], s45 offen sc1
    v_exp_f32_e64 v16, -v82
    v_exp_f32_e64 v17, -v83
    v_fma_f32 v14, v14, s76, s76
    v_mfma_f32_32x32x16_bf16 a[72:87], a[8:11], v[176:179], a[72:87]
    s_waitcnt lgkmcnt(6)
    ds_read_b64_tr_b16 a[36:37], v12 offset:36864
    ds_read_b64_tr_b16 a[38:39], v12 offset:37632
    v_fma_f32 v15, v15, s76, s76
    v_fma_f32 v16, v16, s76, s76
    v_fma_f32 v17, v17, s76, s76
    v_rcp_f32 v14, v14
    v_rcp_f32 v15, v15
    v_mfma_f32_32x32x16_bf16 a[40:55], a[12:15], v[180:183], a[40:55]
    s_add_u32 s45, s45, 16384
    ds_read_b64_tr_b16 a[0:1], v12 offset:36928
    ds_read_b64_tr_b16 a[2:3], v12 offset:37696
    buffer_load_dwordx4 a[220:223], v1, s[12:15], s49 offen offset:3072 sc1
    v_rcp_f32 v16, v16
    v_rcp_f32 v17, v17
    v_mfma_f32_32x32x16_bf16 a[56:71], a[16:19], v[180:183], a[56:71]
    s_add_u32 s49, s49, 4096
    ds_read_b64_tr_b16 a[4:5], v12 offset:36992
    ds_read_b64_tr_b16 a[6:7], v12 offset:37760
    buffer_load_dwordx4 a[224:227], v1, s[12:15], s49 offen offset:0 sc1
    v_mul_f32 v80, v80, v14
    v_mul_f32 v81, v81, v15
    v_mul_f32 v82, v82, v16
    v_mul_f32 v83, v83, v17
    v_mfma_f32_32x32x16_bf16 a[72:87], a[20:23], v[180:183], a[72:87]
    s_waitcnt lgkmcnt(6)
    ds_read_b64_tr_b16 a[8:9], v12 offset:39936
    ds_read_b64_tr_b16 a[10:11], v12 offset:40704
    v_exp_f32_e64 v14, -v84
    v_exp_f32_e64 v15, -v85
    v_exp_f32_e64 v16, -v86
    v_mfma_f32_32x32x16_bf16 a[40:55], a[24:27], v[184:187], a[40:55]
    ds_read_b64_tr_b16 a[12:13], v12 offset:40000
    ds_read_b64_tr_b16 a[14:15], v12 offset:40768
    buffer_load_dwordx4 a[228:231], v1, s[12:15], s49 offen offset:1024 sc1
    v_exp_f32_e64 v17, -v87
    v_fma_f32 v14, v14, s76, s76
    v_fma_f32 v15, v15, s76, s76
    v_fma_f32 v16, v16, s76, s76
    v_fma_f32 v17, v17, s76, s76
    v_mfma_f32_32x32x16_bf16 a[56:71], a[28:31], v[184:187], a[56:71]
    ds_read_b64_tr_b16 a[16:17], v12 offset:40064
    ds_read_b64_tr_b16 a[18:19], v12 offset:40832
    buffer_load_dwordx4 a[232:235], v1, s[12:15], s49 offen offset:2048 sc1
    v_rcp_f32 v14, v14
    v_rcp_f32 v15, v15
    v_mfma_f32_32x32x16_bf16 a[72:87], a[32:35], v[184:187], a[72:87]
    s_waitcnt lgkmcnt(6)
    ds_read_b64_tr_b16 a[20:21], v12 offset:43008
    ds_read_b64_tr_b16 a[22:23], v12 offset:43776
    v_rcp_f32 v16, v16
    v_rcp_f32 v17, v17
    v_mul_f32 v84, v84, v14
    v_mul_f32 v85, v85, v15
    v_mul_f32 v86, v86, v16
    v_mfma_f32_32x32x16_bf16 a[40:55], a[36:39], v[188:191], a[40:55]
    ds_read_b64_tr_b16 a[24:25], v12 offset:43072
    ds_read_b64_tr_b16 a[26:27], v12 offset:43840
    buffer_load_dwordx4 a[236:239], v1, s[12:15], s49 offen offset:3072 sc1
    v_mul_f32 v87, v87, v17
    v_cvt_pk_bf16_f32 v80, v80, v81
    v_cvt_pk_bf16_f32 v81, v82, v83
    v_cvt_pk_bf16_f32 v82, v84, v85
    v_mfma_f32_32x32x16_bf16 a[56:71], a[0:3], v[188:191], a[56:71]
    s_add_u32 s49, s49, 4096
    ds_read_b64_tr_b16 a[28:29], v12 offset:43136
    ds_read_b64_tr_b16 a[30:31], v12 offset:43904
    buffer_load_dwordx4 a[240:243], v1, s[12:15], s49 offen offset:0 sc1
    v_cvt_pk_bf16_f32 v83, v86, v87
    v_exp_f32_e64 v14, -v88
    v_exp_f32_e64 v15, -v89
    v_mfma_f32_32x32x16_bf16 a[72:87], a[4:7], v[188:191], a[72:87]
    s_waitcnt lgkmcnt(6)
    ds_read_b64_tr_b16 a[32:33], v12 offset:46080
    ds_read_b64_tr_b16 a[34:35], v12 offset:46848
    buffer_store_dwordx4 v[80:83], v13, s[12:15], s42 offen offset:3072 sc1
    v_exp_f32_e64 v16, -v90
    v_exp_f32_e64 v17, -v91
    v_mfma_f32_32x32x16_bf16 a[40:55], a[8:11], v[192:195], a[40:55]
    ds_read_b64_tr_b16 a[36:37], v12 offset:46144
    ds_read_b64_tr_b16 a[38:39], v12 offset:46912
    v_fma_f32 v14, v14, s76, s76
    v_fma_f32 v15, v15, s76, s76
    v_fma_f32 v16, v16, s76, s76
    v_fma_f32 v17, v17, s76, s76
    v_rcp_f32 v14, v14
    v_mfma_f32_32x32x16_bf16 a[56:71], a[12:15], v[192:195], a[56:71]
    ds_read_b64_tr_b16 a[0:1], v12 offset:46208
    ds_read_b64_tr_b16 a[2:3], v12 offset:46976
    v_rcp_f32 v15, v15
    v_rcp_f32 v16, v16
    v_rcp_f32 v17, v17
    v_mul_f32 v88, v88, v14
    v_mfma_f32_32x32x16_bf16 a[72:87], a[16:19], v[192:195], a[72:87]
    s_waitcnt lgkmcnt(6)
    ds_read_b64_tr_b16 a[4:5], v12 offset:49152
    ds_read_b64_tr_b16 a[6:7], v12 offset:49920
    buffer_load_dwordx4 a[244:247], v1, s[12:15], s49 offen offset:1024 sc1
    v_mul_f32 v89, v89, v15
    v_mul_f32 v90, v90, v16
    v_mul_f32 v91, v91, v17
    v_exp_f32_e64 v14, -v92
    v_mfma_f32_32x32x16_bf16 a[40:55], a[20:23], v[196:199], a[40:55]
    s_add_u32 s49, s49, 12288
    ds_read_b64_tr_b16 a[8:9], v12 offset:49216
    ds_read_b64_tr_b16 a[10:11], v12 offset:49984
    buffer_load_dwordx4 v[96:99], v1, s[12:15], s49 offen offset:0 sc1
    v_exp_f32_e64 v15, -v93
    v_exp_f32_e64 v16, -v94
    v_mfma_f32_32x32x16_bf16 a[56:71], a[24:27], v[196:199], a[56:71]
    ds_read_b64_tr_b16 a[12:13], v12 offset:49280
    ds_read_b64_tr_b16 a[14:15], v12 offset:50048
    v_exp_f32_e64 v17, -v95
    v_fma_f32 v14, v14, s76, s76
    v_fma_f32 v15, v15, s76, s76
    v_fma_f32 v16, v16, s76, s76
    v_fma_f32 v17, v17, s76, s76
    v_mfma_f32_32x32x16_bf16 a[72:87], a[28:31], v[196:199], a[72:87]
    s_waitcnt lgkmcnt(6)
    ds_read_b64_tr_b16 a[16:17], v12 offset:52224
    ds_read_b64_tr_b16 a[18:19], v12 offset:52992
    buffer_load_dwordx4 v[100:103], v1, s[12:15], s49 offen offset:1024 sc1
    v_rcp_f32 v14, v14
    v_rcp_f32 v15, v15
    v_mfma_f32_32x32x16_bf16 a[40:55], a[32:35], v[200:203], a[40:55]
    ds_read_b64_tr_b16 a[20:21], v12 offset:52288
    ds_read_b64_tr_b16 a[22:23], v12 offset:53056
    buffer_load_dwordx4 v[104:107], v1, s[12:15], s49 offen offset:2048 sc1
    v_rcp_f32 v16, v16
    v_rcp_f32 v17, v17
    v_mul_f32 v92, v92, v14
    v_mul_f32 v93, v93, v15
    v_mfma_f32_32x32x16_bf16 a[56:71], a[36:39], v[200:203], a[56:71]
    ds_read_b64_tr_b16 a[24:25], v12 offset:52352
    ds_read_b64_tr_b16 a[26:27], v12 offset:53120
    v_mul_f32 v94, v94, v16
    v_mul_f32 v95, v95, v17
    v_cvt_pk_bf16_f32 v88, v88, v89
    v_cvt_pk_bf16_f32 v89, v90, v91
    v_cvt_pk_bf16_f32 v90, v92, v93
    v_cvt_pk_bf16_f32 v91, v94, v95
    v_mfma_f32_32x32x16_bf16 a[72:87], a[0:3], v[200:203], a[72:87]
    s_waitcnt lgkmcnt(6)
    ds_read_b64_tr_b16 a[28:29], v12 offset:55296
    ds_read_b64_tr_b16 a[30:31], v12 offset:56064
    buffer_store_dwordx4 v[88:91], v13, s[12:15], s42 offen offset:3584 sc1
    v_mfma_f32_32x32x16_bf16 a[40:55], a[4:7], v[204:207], a[40:55]
    ds_read_b64_tr_b16 a[32:33], v12 offset:55360
    ds_read_b64_tr_b16 a[34:35], v12 offset:56128
    v_mfma_f32_32x32x16_bf16 a[56:71], a[8:11], v[204:207], a[56:71]
    ds_read_b64_tr_b16 a[36:37], v12 offset:55424
    ds_read_b64_tr_b16 a[38:39], v12 offset:56192
    buffer_load_dwordx4 v[108:111], v1, s[12:15], s49 offen offset:3072 sc1
    v_mfma_f32_32x32x16_bf16 a[72:87], a[12:15], v[204:207], a[72:87]
    s_waitcnt lgkmcnt(6)
    ds_read_b64_tr_b16 a[0:1], v12 offset:58368
    ds_read_b64_tr_b16 a[2:3], v12 offset:59136
    v_mfma_f32_32x32x16_bf16 a[40:55], a[16:19], v[208:211], a[40:55]
    s_add_u32 s49, s49, 4096
    ds_read_b64_tr_b16 a[4:5], v12 offset:58432
    ds_read_b64_tr_b16 a[6:7], v12 offset:59200
    buffer_load_dwordx4 v[112:115], v1, s[12:15], s49 offen offset:0 sc1
    v_mfma_f32_32x32x16_bf16 a[56:71], a[20:23], v[208:211], a[56:71]
    ds_read_b64_tr_b16 a[8:9], v12 offset:58496
    ds_read_b64_tr_b16 a[10:11], v12 offset:59264
    v_mfma_f32_32x32x16_bf16 a[72:87], a[24:27], v[208:211], a[72:87]
    s_waitcnt lgkmcnt(6)
    ds_read_b64_tr_b16 a[12:13], v12 offset:61440
    ds_read_b64_tr_b16 a[14:15], v12 offset:62208
    buffer_load_dwordx4 v[116:119], v1, s[12:15], s49 offen offset:1024 sc1
    v_mfma_f32_32x32x16_bf16 a[40:55], a[28:31], v[212:215], a[40:55]
    ds_read_b64_tr_b16 a[16:17], v12 offset:61504
    ds_read_b64_tr_b16 a[18:19], v12 offset:62272
    v_mfma_f32_32x32x16_bf16 a[56:71], a[32:35], v[212:215], a[56:71]
    ds_read_b64_tr_b16 a[20:21], v12 offset:61568
    ds_read_b64_tr_b16 a[22:23], v12 offset:62336
    buffer_load_dwordx4 v[120:123], v1, s[12:15], s49 offen offset:2048 sc1
    v_mfma_f32_32x32x16_bf16 a[72:87], a[36:39], v[212:215], a[72:87]
    s_waitcnt lgkmcnt(6)
    ds_read_b64_tr_b16 a[24:25], v12 offset:64512
    ds_read_b64_tr_b16 a[26:27], v12 offset:65280
    v_mfma_f32_32x32x16_bf16 a[40:55], a[0:3], v[216:219], a[40:55]
    ds_read_b64_tr_b16 a[28:29], v12 offset:64576
    ds_read_b64_tr_b16 a[30:31], v12 offset:65344
    buffer_load_dwordx4 v[124:127], v1, s[12:15], s49 offen offset:3072 sc1
    v_mfma_f32_32x32x16_bf16 a[56:71], a[4:7], v[216:219], a[56:71]
    s_add_u32 s49, s49, 4096
    ds_read_b64_tr_b16 a[32:33], v12 offset:64640
    ds_read_b64_tr_b16 a[34:35], v12 offset:65408
    v_add_u32 v12, 67584, v12
    v_mfma_f32_32x32x16_bf16 a[72:87], a[8:11], v[216:219], a[72:87]
    s_waitcnt lgkmcnt(6)
    ds_read_b64_tr_b16 a[36:37], v12 offset:0
    ds_read_b64_tr_b16 a[38:39], v12 offset:768
    buffer_load_dwordx4 v[128:131], v1, s[12:15], s49 offen offset:0 sc1
    v_mfma_f32_32x32x16_bf16 a[40:55], a[12:15], v[220:223], a[40:55]
    ds_read_b64_tr_b16 a[0:1], v12 offset:64
    ds_read_b64_tr_b16 a[2:3], v12 offset:832
    v_mfma_f32_32x32x16_bf16 a[56:71], a[16:19], v[220:223], a[56:71]
    ds_read_b64_tr_b16 a[4:5], v12 offset:128
    ds_read_b64_tr_b16 a[6:7], v12 offset:896
    buffer_load_dwordx4 v[132:135], v1, s[12:15], s49 offen offset:1024 sc1
    v_mfma_f32_32x32x16_bf16 a[72:87], a[20:23], v[220:223], a[72:87]
    s_waitcnt lgkmcnt(6)
    ds_read_b64_tr_b16 a[8:9], v12 offset:3072
    ds_read_b64_tr_b16 a[10:11], v12 offset:3840
    v_mfma_f32_32x32x16_bf16 a[40:55], a[24:27], v[224:227], a[40:55]
    s_add_u32 s49, s49, s28
    ds_read_b64_tr_b16 a[12:13], v12 offset:3136
    ds_read_b64_tr_b16 a[14:15], v12 offset:3904
    buffer_load_dwordx4 v[136:139], v1, s[12:15], s49 offen offset:2048 sc1
    v_mov_b32 v3, 0
    v_accvgpr_read_b32 v8, a248
    v_accvgpr_read_b32 v9, a249
    v_accvgpr_read_b32 v10, a250
    v_accvgpr_read_b32 v11, a251
    v_mfma_f32_32x32x16_bf16 a[56:71], a[28:31], v[224:227], a[56:71]
    ds_read_b64_tr_b16 a[16:17], v12 offset:3200
    ds_read_b64_tr_b16 a[18:19], v12 offset:3968
    v_mfma_f32_32x32x16_bf16 a[72:87], a[32:35], v[224:227], a[72:87]
    s_waitcnt lgkmcnt(6)
    ds_read_b64_tr_b16 a[20:21], v12 offset:6144
    ds_read_b64_tr_b16 a[22:23], v12 offset:6912
    buffer_atomic_add v3, v30, s[12:15], s88 offen sc0 sc1
    v_mfma_f32_32x32x16_bf16 a[40:55], a[36:39], v[228:231], a[40:55]
    ds_read_b64_tr_b16 a[24:25], v12 offset:6208
    ds_read_b64_tr_b16 a[26:27], v12 offset:6976
    buffer_load_dwordx4 v[140:143], v1, s[12:15], s49 offen offset:3072 sc1
    v_mfma_f32_32x32x16_bf16 a[56:71], a[0:3], v[228:231], a[56:71]
    s_waitcnt vmcnt(10)
    ds_read_b64_tr_b16 a[28:29], v12 offset:6272
    ds_read_b64_tr_b16 a[30:31], v12 offset:7040
    v_mov_b32 v24, 1
    v_mfma_f32_32x32x16_bf16 a[72:87], a[4:7], v[228:231], a[72:87]
    s_waitcnt lgkmcnt(6)
    ds_read_b64_tr_b16 a[32:33], v12 offset:9216
    ds_read_b64_tr_b16 a[34:35], v12 offset:9984
    buffer_atomic_add v24, v30, s[12:15], s45 offen sc1
    v_mfma_f32_32x32x16_bf16 a[40:55], a[8:11], v[232:235], a[40:55]
    s_add_u32 s45, s45, 16384
    ds_read_b64_tr_b16 a[36:37], v12 offset:9280
    ds_read_b64_tr_b16 a[38:39], v12 offset:10048
    v_mfma_f32_32x32x16_bf16 a[56:71], a[12:15], v[232:235], a[56:71]
    s_add_u32 s49, s49, 4096
    ds_read_b64_tr_b16 a[0:1], v12 offset:9344
    ds_read_b64_tr_b16 a[2:3], v12 offset:10112
    buffer_load_dwordx4 v[144:147], v1, s[12:15], s49 offen offset:0 sc1
    v_mfma_f32_32x32x16_bf16 a[72:87], a[16:19], v[232:235], a[72:87]
    s_waitcnt lgkmcnt(6)
    ds_read_b64_tr_b16 a[4:5], v12 offset:12288
    ds_read_b64_tr_b16 a[6:7], v12 offset:13056
    buffer_load_dwordx4 v[148:151], v1, s[12:15], s49 offen offset:1024 sc1
    v_mfma_f32_32x32x16_bf16 a[40:55], a[20:23], v[236:239], a[40:55]
    ds_read_b64_tr_b16 a[8:9], v12 offset:12352
    ds_read_b64_tr_b16 a[10:11], v12 offset:13120
    buffer_load_dwordx4 v[152:155], v1, s[12:15], s49 offen offset:2048 sc1
    v_mfma_f32_32x32x16_bf16 a[56:71], a[24:27], v[236:239], a[56:71]
    ds_read_b64_tr_b16 a[12:13], v12 offset:12416
    ds_read_b64_tr_b16 a[14:15], v12 offset:13184
    buffer_load_dwordx4 v[156:159], v1, s[12:15], s49 offen offset:3072 sc1
    v_mfma_f32_32x32x16_bf16 a[72:87], a[28:31], v[236:239], a[72:87]
    s_waitcnt lgkmcnt(6)
    ds_read_b64_tr_b16 a[16:17], v12 offset:15360
    ds_read_b64_tr_b16 a[18:19], v12 offset:16128
    v_mfma_f32_32x32x16_bf16 a[40:55], a[32:35], v[240:243], a[40:55]
    s_add_u32 s49, s49, 4096
    ds_read_b64_tr_b16 a[20:21], v12 offset:15424
    ds_read_b64_tr_b16 a[22:23], v12 offset:16192
    buffer_load_dwordx4 v[160:163], v1, s[12:15], s49 offen offset:0 sc1
    v_mfma_f32_32x32x16_bf16 a[56:71], a[36:39], v[240:243], a[56:71]
    ds_read_b64_tr_b16 a[24:25], v12 offset:15488
    ds_read_b64_tr_b16 a[26:27], v12 offset:16256
    v_mfma_f32_32x32x16_bf16 a[72:87], a[0:3], v[240:243], a[72:87]
    s_waitcnt lgkmcnt(6)
    ds_read_b64_tr_b16 a[28:29], v12 offset:18432
    ds_read_b64_tr_b16 a[30:31], v12 offset:19200
    buffer_load_dwordx4 v[164:167], v1, s[12:15], s49 offen offset:1024 sc1
    v_mfma_f32_32x32x16_bf16 a[40:55], a[4:7], v[244:247], a[40:55]
    ds_read_b64_tr_b16 a[32:33], v12 offset:18496
    ds_read_b64_tr_b16 a[34:35], v12 offset:19264
    v_mfma_f32_32x32x16_bf16 a[56:71], a[8:11], v[244:247], a[56:71]
    s_waitcnt vmcnt(8)
    v_cmp_ne_u32 vcc, 4, v3
    s_nop 0
    s_bitcmp1_b32 vcc_lo, 0
    s_cbranch_scc1 L_spin2
L_back2:
    ds_read_b64_tr_b16 a[36:37], v12 offset:18560
    ds_read_b64_tr_b16 a[38:39], v12 offset:19328
    buffer_load_dwordx4 v[196:199], v8, s[12:15], s80 offen offset:0 sc1
    v_mfma_f32_32x32x16_bf16 a[72:87], a[12:15], v[244:247], a[72:87]
    s_waitcnt lgkmcnt(6)
    v_mfma_f32_32x32x16_bf16 a[40:55], a[16:19], v[248:251], a[40:55]
    buffer_load_dwordx4 v[200:203], v9, s[12:15], s80 offen offset:0 sc1
    v_mfma_f32_32x32x16_bf16 a[56:71], a[20:23], v[248:251], a[56:71]
    v_mfma_f32_32x32x16_bf16 a[72:87], a[24:27], v[248:251], a[72:87]
    s_waitcnt lgkmcnt(0)
    buffer_load_dwordx4 v[204:207], v10, s[12:15], s80 offen offset:0 sc1
    v_mfma_f32_32x32x16_bf16 a[40:55], a[28:31], v[252:255], a[40:55]
    v_mfma_f32_32x32x16_bf16 a[56:71], a[32:35], v[252:255], a[56:71]
    buffer_load_dwordx4 v[208:211], v11, s[12:15], s80 offen offset:0 sc1
    v_mfma_f32_32x32x16_bf16 a[72:87], a[36:39], v[252:255], a[72:87]
    buffer_load_dwordx4 v[212:215], v8, s[12:15], s80 offen offset:1024 sc1
    buffer_load_dwordx4 v[216:219], v9, s[12:15], s80 offen offset:1024 sc1
    buffer_load_dwordx4 v[220:223], v10, s[12:15], s80 offen offset:1024 sc1
    buffer_load_dwordx4 v[224:227], v11, s[12:15], s80 offen offset:1024 sc1
    buffer_load_dwordx4 v[168:171], v1, s[12:15], s49 offen offset:2048 sc1
    buffer_load_dwordx4 v[172:175], v1, s[12:15], s49 offen offset:3072 sc1
    s_nop 2
    v_accvgpr_read_b32 v240, a40
    v_accvgpr_read_b32 v241, a41
    v_accvgpr_read_b32 v242, a42
    v_accvgpr_read_b32 v243, a43
    v_accvgpr_read_b32 v244, a44
    v_accvgpr_read_b32 v245, a45
    v_accvgpr_read_b32 v246, a46
    v_accvgpr_read_b32 v247, a47
    v_exp_f32_e64 v14, -v240
    v_exp_f32_e64 v15, -v241
    v_exp_f32_e64 v16, -v242
    v_exp_f32_e64 v17, -v243
    v_exp_f32_e64 v18, -v244
    v_exp_f32_e64 v19, -v245
    v_exp_f32_e64 v20, -v246
    v_exp_f32_e64 v21, -v247
    v_pk_fma_f32 v[14:15], v[14:15], s[76:77], s[76:77] op_sel_hi:[1,0,0]
    v_pk_fma_f32 v[16:17], v[16:17], s[76:77], s[76:77] op_sel_hi:[1,0,0]
    v_pk_fma_f32 v[18:19], v[18:19], s[76:77], s[76:77] op_sel_hi:[1,0,0]
    v_pk_fma_f32 v[20:21], v[20:21], s[76:77], s[76:77] op_sel_hi:[1,0,0]
    v_rcp_f32 v14, v14
L_pg0_3:
    s_cbranch_execz L_pgret0
    v_rcp_f32 v15, v15
    v_rcp_f32 v16, v16
    v_rcp_f32 v17, v17
    v_rcp_f32 v18, v18
    v_rcp_f32 v19, v19
    v_rcp_f32 v20, v20
    v_rcp_f32 v21, v21
    v_pk_mul_f32 v[240:241], v[240:241], v[14:15]
    v_pk_mul_f32 v[242:243], v[242:243], v[16:17]
    v_pk_mul_f32 v[244:245], v[244:245], v[18:19]
    v_pk_mul_f32 v[246:247], v[246:247], v[20:21]
    v_cvt_pk_bf16_f32 v240, v240, v241
    v_cvt_pk_bf16_f32 v241, v242, v243
    v_cvt_pk_bf16_f32 v242, v244, v245
    v_cvt_pk_bf16_f32 v243, v246, v247
    buffer_store_dwordx4 v[240:243], v13, s[12:15], s43 offen offset:0 sc1
    s_add_u32 s49, s49, 4096
    buffer_load_dwordx4 v[176:179], v1, s[12:15], s49 offen offset:0 sc1
    buffer_load_dwordx4 v[180:183], v1, s[12:15], s49 offen offset:1024 sc1
    v_accvgpr_read_b32 v248, a48
    v_accvgpr_read_b32 v249, a49
    v_accvgpr_read_b32 v250, a50
    v_accvgpr_read_b32 v251, a51
    v_accvgpr_read_b32 v252, a52
    v_accvgpr_read_b32 v253, a53
    v_accvgpr_read_b32 v254, a54
    v_accvgpr_read_b32 v255, a55
    v_exp_f32_e64 v14, -v248
    v_exp_f32_e64 v15, -v249
    v_exp_f32_e64 v16, -v250
    v_exp_f32_e64 v17, -v251
    v_exp_f32_e64 v18, -v252
    v_exp_f32_e64 v19, -v253
    v_exp_f32_e64 v20, -v254
    v_exp_f32_e64 v21, -v255
    v_pk_fma_f32 v[14:15], v[14:15], s[76:77], s[76:77] op_sel_hi:[1,0,0]
    v_pk_fma_f32 v[16:17], v[16:17], s[76:77], s[76:77] op_sel_hi:[1,0,0]
    v_pk_fma_f32 v[18:19], v[18:19], s[76:77], s[76:77] op_sel_hi:[1,0,0]
    v_pk_fma_f32 v[20:21], v[20:21], s[76:77], s[76:77] op_sel_hi:[1,0,0]
    v_rcp_f32 v14, v14
    v_rcp_f32 v15, v15
    v_rcp_f32 v16, v16
    v_rcp_f32 v17, v17
    v_rcp_f32 v18, v18
    v_rcp_f32 v19, v19
    v_rcp_f32 v20, v20
    v_rcp_f32 v21, v21
    v_pk_mul_f32 v[248:249], v[248:249], v[14:15]
    v_pk_mul_f32 v[250:251], v[250:251], v[16:17]
    v_pk_mul_f32 v[252:253], v[252:253], v[18:19]
    v_pk_mul_f32 v[254:255], v[254:255], v[20:21]
    v_cvt_pk_bf16_f32 v248, v248, v249
    v_cvt_pk_bf16_f32 v249, v250, v251
    v_cvt_pk_bf16_f32 v250, v252, v253
    v_cvt_pk_bf16_f32 v251, v254, v255
    buffer_store_dwordx4 v[248:251], v13, s[12:15], s43 offen offset:512 sc1
    buffer_load_dwordx4 v[184:187], v1, s[12:15], s49 offen offset:2048 sc1
    buffer_load_dwordx4 v[188:191], v1, s[12:15], s49 offen offset:3072 sc1
    v_accvgpr_read_b32 v240, a56
    v_accvgpr_read_b32 v241, a57
    v_accvgpr_read_b32 v242, a58
    v_accvgpr_read_b32 v243, a59
    v_accvgpr_read_b32 v244, a60
    v_accvgpr_read_b32 v245, a61
    v_accvgpr_read_b32 v246, a62
    v_accvgpr_read_b32 v247, a63
    v_exp_f32_e64 v14, -v240
    v_exp_f32_e64 v15, -v241
    v_exp_f32_e64 v16, -v242
    v_exp_f32_e64 v17, -v243
    v_exp_f32_e64 v18, -v244
    v_exp_f32_e64 v19, -v245
    v_exp_f32_e64 v20, -v246
    v_exp_f32_e64 v21, -v247
    v_pk_fma_f32 v[14:15], v[14:15], s[76:77], s[76:77] op_sel_hi:[1,0,0]
    v_pk_fma_f32 v[16:17], v[16:17], s[76:77], s[76:77] op_sel_hi:[1,0,0]
    v_pk_fma_f32 v[18:19], v[18:19], s[76:77], s[76:77] op_sel_hi:[1,0,0]
    v_pk_fma_f32 v[20:21], v[20:21], s[76:77], s[76:77] op_sel_hi:[1,0,0]
    v_rcp_f32 v14, v14
    v_rcp_f32 v15, v15
    v_rcp_f32 v16, v16
    v_rcp_f32 v17, v17
    v_rcp_f32 v18, v18
    v_rcp_f32 v19, v19
    v_rcp_f32 v20, v20
    v_rcp_f32 v21, v21
    v_pk_mul_f32 v[240:241], v[240:241], v[14:15]
    v_pk_mul_f32 v[242:243], v[242:243], v[16:17]
    v_pk_mul_f32 v[244:245], v[244:245], v[18:19]
    v_pk_mul_f32 v[246:247], v[246:247], v[20:21]
    v_cvt_pk_bf16_f32 v240, v240, v241
    v_cvt_pk_bf16_f32 v241, v242, v243
    v_cvt_pk_bf16_f32 v242, v244, v245
    v_cvt_pk_bf16_f32 v243, v246, v247
    buffer_store_dwordx4 v[240:243], v13, s[12:15], s44 offen offset:1024 sc1
    s_add_u32 s49, s49, 4096
    buffer_load_dwordx4 v[192:195], v1, s[12:15], s49 offen offset:0 sc1
    buffer_load_dwordx4 v[32:35], v1, s[12:15], s49 offen offset:1024 sc1
    v_accvgpr_read_b32 v248, a64
    v_accvgpr_read_b32 v249, a65
    v_accvgpr_read_b32 v250, a66
    v_accvgpr_read_b32 v251, a67
    v_accvgpr_read_b32 v252, a68
    v_accvgpr_read_b32 v253, a69
    v_accvgpr_read_b32 v254, a70
    v_accvgpr_read_b32 v255, a71
    v_exp_f32_e64 v14, -v248
    v_exp_f32_e64 v15, -v249
    v_exp_f32_e64 v16, -v250
    v_exp_f32_e64 v17, -v251
    v_exp_f32_e64 v18, -v252
    v_exp_f32_e64 v19, -v253
    v_exp_f32_e64 v20, -v254
    v_exp_f32_e64 v21, -v255
    v_pk_fma_f32 v[14:15], v[14:15], s[76:77], s[76:77] op_sel_hi:[1,0,0]
    v_pk_fma_f32 v[16:17], v[16:17], s[76:77], s[76:77] op_sel_hi:[1,0,0]
    v_pk_fma_f32 v[18:19], v[18:19], s[76:77], s[76:77] op_sel_hi:[1,0,0]
    v_pk_fma_f32 v[20:21], v[20:21], s[76:77], s[76:77] op_sel_hi:[1,0,0]
    v_rcp_f32 v14, v14
    v_rcp_f32 v15, v15
    v_rcp_f32 v16, v16
    v_rcp_f32 v17, v17
    v_rcp_f32 v18, v18
    v_rcp_f32 v19, v19
    v_rcp_f32 v20, v20
    v_rcp_f32 v21, v21
    v_pk_mul_f32 v[248:249], v[248:249], v[14:15]
    v_pk_mul_f32 v[250:251], v[250:251], v[16:17]
    v_pk_mul_f32 v[252:253], v[252:253], v[18:19]
    v_pk_mul_f32 v[254:255], v[254:255], v[20:21]
    v_cvt_pk_bf16_f32 v248, v248, v249
    v_cvt_pk_bf16_f32 v249, v250, v251
    v_cvt_pk_bf16_f32 v250, v252, v253
    v_cvt_pk_bf16_f32 v251, v254, v255
    buffer_store_dwordx4 v[248:251], v13, s[12:15], s44 offen offset:1536 sc1
    buffer_load_dwordx4 v[36:39], v1, s[12:15], s49 offen offset:2048 sc1
    buffer_load_dwordx4 v[40:43], v1, s[12:15], s49 offen offset:3072 sc1
    v_accvgpr_read_b32 v240, a72
    v_accvgpr_read_b32 v241, a73
    v_accvgpr_read_b32 v242, a74
    v_accvgpr_read_b32 v243, a75
    v_accvgpr_read_b32 v244, a76
    v_accvgpr_read_b32 v245, a77
    v_accvgpr_read_b32 v246, a78
    v_accvgpr_read_b32 v247, a79
    v_exp_f32_e64 v14, -v240
    v_exp_f32_e64 v15, -v241
    v_exp_f32_e64 v16, -v242
    v_exp_f32_e64 v17, -v243
    v_exp_f32_e64 v18, -v244
    v_exp_f32_e64 v19, -v245
    v_exp_f32_e64 v20, -v246
    v_exp_f32_e64 v21, -v247
    v_pk_fma_f32 v[14:15], v[14:15], s[76:77], s[76:77] op_sel_hi:[1,0,0]
    v_pk_fma_f32 v[16:17], v[16:17], s[76:77], s[76:77] op_sel_hi:[1,0,0]
    v_pk_fma_f32 v[18:19], v[18:19], s[76:77], s[76:77] op_sel_hi:[1,0,0]
    v_pk_fma_f32 v[20:21], v[20:21], s[76:77], s[76:77] op_sel_hi:[1,0,0]
    v_rcp_f32 v14, v14
    v_rcp_f32 v15, v15
    v_rcp_f32 v16, v16
    v_rcp_f32 v17, v17
    v_rcp_f32 v18, v18
    v_rcp_f32 v19, v19
    v_rcp_f32 v20, v20
    v_rcp_f32 v21, v21
    v_pk_mul_f32 v[240:241], v[240:241], v[14:15]
    v_pk_mul_f32 v[242:243], v[242:243], v[16:17]
    v_pk_mul_f32 v[244:245], v[244:245], v[18:19]
    v_pk_mul_f32 v[246:247], v[246:247], v[20:21]
    v_cvt_pk_bf16_f32 v240, v240, v241
    v_cvt_pk_bf16_f32 v241, v242, v243
    v_cvt_pk_bf16_f32 v242, v244, v245
    v_cvt_pk_bf16_f32 v243, v246, v247
    buffer_store_dwordx4 v[240:243], v13, s[12:15], s44 offen offset:2048 sc1
    s_add_u32 s49, s49, 4096
    buffer_load_dwordx4 v[44:47], v1, s[12:15], s49 offen offset:0 sc1
    buffer_load_dwordx4 v[48:51], v1, s[12:15], s49 offen offset:1024 sc1
    v_accvgpr_read_b32 v248, a80
    v_accvgpr_read_b32 v249, a81
    v_accvgpr_read_b32 v250, a82
    v_accvgpr_read_b32 v251, a83
    v_accvgpr_read_b32 v252, a84
    v_accvgpr_read_b32 v253, a85
    v_accvgpr_read_b32 v254, a86
    v_accvgpr_read_b32 v255, a87
    v_exp_f32_e64 v14, -v248
    v_exp_f32_e64 v15, -v249
    v_exp_f32_e64 v16, -v250
    v_exp_f32_e64 v17, -v251
    v_exp_f32_e64 v18, -v252
    v_exp_f32_e64 v19, -v253
    v_exp_f32_e64 v20, -v254
    v_exp_f32_e64 v21, -v255
    v_pk_fma_f32 v[14:15], v[14:15], s[76:77], s[76:77] op_sel_hi:[1,0,0]
    v_pk_fma_f32 v[16:17], v[16:17], s[76:77], s[76:77] op_sel_hi:[1,0,0]
    v_pk_fma_f32 v[18:19], v[18:19], s[76:77], s[76:77] op_sel_hi:[1,0,0]
    v_pk_fma_f32 v[20:21], v[20:21], s[76:77], s[76:77] op_sel_hi:[1,0,0]
    v_rcp_f32 v14, v14
    v_rcp_f32 v15, v15
    v_rcp_f32 v16, v16
    v_rcp_f32 v17, v17
    v_rcp_f32 v18, v18
    v_rcp_f32 v19, v19
    v_rcp_f32 v20, v20
    v_rcp_f32 v21, v21
    v_pk_mul_f32 v[248:249], v[248:249], v[14:15]
    v_pk_mul_f32 v[250:251], v[250:251], v[16:17]
    v_pk_mul_f32 v[252:253], v[252:253], v[18:19]
    v_pk_mul_f32 v[254:255], v[254:255], v[20:21]
    v_cvt_pk_bf16_f32 v248, v248, v249
    v_cvt_pk_bf16_f32 v249, v250, v251
    v_cvt_pk_bf16_f32 v250, v252, v253
    v_cvt_pk_bf16_f32 v251, v254, v255
    buffer_store_dwordx4 v[248:251], v13, s[12:15], s44 offen offset:2560 sc1
    s_waitcnt vmcnt(25)
    v_mfma_f32_16x16x32_bf16 a[0:3], a[128:131], v[196:199], 0
    s_add_u32 s88, s88, 16384
    v_mov_b32 v3, 0
    v_mfma_f32_16x16x32_bf16 a[4:7], a[132:135], v[196:199], 0
    buffer_atomic_add v3, v30, s[12:15], s88 offen sc0 sc1
    v_mfma_f32_16x16x32_bf16 a[8:11], a[136:139], v[196:199], 0
    v_mfma_f32_16x16x32_bf16 a[12:15], a[140:143], v[196:199], 0
    buffer_load_dwordx4 v[52:55], v1, s[56:59], s49 offen offset:2048 sc1
    v_mfma_f32_16x16x32_bf16 a[16:19], a[144:147], v[196:199], 0
    s_waitcnt vmcnt(26)
    v_mfma_f32_16x16x32_bf16 a[20:23], a[128:131], v[200:203], 0
    v_mfma_f32_16x16x32_bf16 a[24:27], a[132:135], v[200:203], 0
    v_mfma_f32_16x16x32_bf16 a[28:31], a[136:139], v[200:203], 0
    v_mfma_f32_16x16x32_bf16 a[32:35], a[140:143], v[200:203], 0
    buffer_load_dwordx4 v[56:59], v1, s[56:59], s49 offen offset:3072 sc1
    v_mfma_f32_16x16x32_bf16 a[36:39], a[144:147], v[200:203], 0
    s_add_u32 s49, s49, 4096
    buffer_load_dwordx4 v[228:231], v8, s[12:15], s81 offen offset:0 sc1
    s_waitcnt vmcnt(27)
    v_mfma_f32_16x16x32_bf16 a[88:91], a[128:131], v[204:207], 0
    v_mfma_f32_16x16x32_bf16 a[92:95], a[132:135], v[204:207], 0
    v_mfma_f32_16x16x32_bf16 a[96:99], a[136:139], v[204:207], 0
    v_mfma_f32_16x16x32_bf16 a[100:103], a[140:143], v[204:207], 0
    v_mfma_f32_16x16x32_bf16 a[104:107], a[144:147], v[204:207], 0
    buffer_load_dwordx4 v[232:235], v9, s[12:15], s81 offen offset:0 sc1
    s_waitcnt vmcnt(27)
    v_mfma_f32_16x16x32_bf16 a[108:111], a[128:131], v[208:211], 0
    v_mfma_f32_16x16x32_bf16 a[112:115], a[132:135], v[208:211], 0
    buffer_load_dwordx4 v[60:63], v1, s[56:59], s49 offen offset:0 sc1
    v_mfma_f32_16x16x32_bf16 a[116:119], a[136:139], v[208:211], 0
    v_mfma_f32_16x16x32_bf16 a[120:123], a[140:143], v[208:211], 0
    v_mfma_f32_16x16x32_bf16 a[124:127], a[144:147], v[208:211], 0
    buffer_load_dwordx4 v[196:199], v10, s[12:15], s81 offen offset:0 sc1
    s_waitcnt vmcnt(28)
    v_mfma_f32_16x16x32_bf16 a[0:3], a[148:151], v[212:215], a[0:3]
    v_mfma_f32_16x16x32_bf16 a[4:7], a[152:155], v[212:215], a[4:7]
    v_mfma_f32_16x16x32_bf16 a[8:11], a[156:159], v[212:215], a[8:11]
    v_mfma_f32_16x16x32_bf16 a[12:15], a[160:163], v[212:215], a[12:15]
    v_mfma_f32_16x16x32_bf16 a[16:19], a[164:167], v[212:215], a[16:19]
    buffer_load_dwordx4 v[200:203], v11, s[12:15], s81 offen offset:0 sc1
    s_waitcnt vmcnt(28)
    v_mfma_f32_16x16x32_bf16 a[20:23], a[148:151], v[216:219], a[20:23]
    buffer_load_dwordx4 v[64:67], v1, s[56:59], s49 offen offset:1024 sc1
    v_mfma_f32_16x16x32_bf16 a[24:27], a[152:155], v[216:219], a[24:27]
    v_mfma_f32_16x16x32_bf16 a[28:31], a[156:159], v[216:219], a[28:31]
    v_mfma_f32_16x16x32_bf16 a[32:35], a[160:163], v[216:219], a[32:35]
    v_mfma_f32_16x16x32_bf16 a[36:39], a[164:167], v[216:219], a[36:39]
    buffer_load_dwordx4 v[204:207], v8, s[12:15], s81 offen offset:1024 sc1
    s_waitcnt vmcnt(29)
    v_mfma_f32_16x16x32_bf16 a[88:91], a[148:151], v[220:223], a[88:91]
    v_mfma_f32_16x16x32_bf16 a[92:95], a[152:155], v[220:223], a[92:95]
    v_mfma_f32_16x16x32_bf16 a[96:99], a[156:159], v[220:223], a[96:99]
    v_mfma_f32_16x16x32_bf16 a[100:103], a[160:163], v[220:223], a[100:103]
    buffer_load_dwordx4 v[68:71], v1, s[56:59], s49 offen offset:2048 sc1
    v_mfma_f32_16x16x32_bf16 a[104:107], a[164:167], v[220:223], a[104:107]
    buffer_load_dwordx4 v[208:211], v9, s[12:15], s81 offen offset:1024 sc1
    s_waitcnt vmcnt(30)
    v_mfma_f32_16x16x32_bf16 a[108:111], a[148:151], v[224:227], a[108:111]
    v_mfma_f32_16x16x32_bf16 a[112:115], a[152:155], v[224:227], a[112:115]
    v_mfma_f32_16x16x32_bf16 a[116:119], a[156:159], v[224:227], a[116:119]
    v_mfma_f32_16x16x32_bf16 a[120:123], a[160:163], v[224:227], a[120:123]
    v_mfma_f32_16x16x32_bf16 a[124:127], a[164:167], v[224:227], a[124:127]
    buffer_load_dwordx4 v[212:215], v10, s[12:15], s81 offen offset:1024 sc1
    s_waitcnt vmcnt(9)
    v_mfma_f32_16x16x32_bf16 a[0:3], a[168:171], v[228:231], a[0:3]
    v_mfma_f32_16x16x32_bf16 a[4:7], a[172:175], v[228:231], a[4:7]
    v_mfma_f32_16x16x32_bf16 a[8:11], a[176:179], v[228:231], a[8:11]
    v_mfma_f32_16x16x32_bf16 a[12:15], a[180:183], v[228:231], a[12:15]
    buffer_load_dwordx4 v[72:75], v1, s[56:59], s49 offen offset:3072 sc1
    v_mfma_f32_16x16x32_bf16 a[16:19], a[184:187], v[228:231], a[16:19]
    s_add_u32 s49, s49, 4096
    buffer_load_dwordx4 v[216:219], v11, s[12:15], s81 offen offset:1024 sc1
    v_cmp_ne_u32 vcc, 4, v3
    s_nop 0
    s_bitcmp1_b32 vcc_lo, 0
    s_cbranch_scc1 L_spin3
L_back3:
    s_waitcnt vmcnt(10)
    v_mfma_f32_16x16x32_bf16 a[20:23], a[168:171], v[232:235], a[20:23]
    v_mov_b32 v22, 1
    v_mfma_f32_16x16x32_bf16 a[24:27], a[172:175], v[232:235], a[24:27]
    buffer_atomic_add v22, v30, s[12:15], s45 offen sc1
    v_mfma_f32_16x16x32_bf16 a[28:31], a[176:179], v[232:235], a[28:31]
    s_add_u32 s45, s45, 16384
    v_mfma_f32_16x16x32_bf16 a[32:35], a[180:183], v[232:235], a[32:35]
    s_mul_i32 s90, s64, 16128
    v_mfma_f32_16x16x32_bf16 a[36:39], a[184:187], v[232:235], a[36:39]
    s_add_u32 s90, s90, 0
    buffer_load_dwordx4 v[220:223], v8, s[12:15], s82 offen offset:0 sc1
    s_waitcnt vmcnt(10)
    v_mfma_f32_16x16x32_bf16 a[88:91], a[168:171], v[196:199], a[88:91]
    s_movk_i32 s91, 1280
    buffer_load_dwordx4 v[76:79], v1, s[56:59], s49 offen offset:0 sc1
    v_mfma_f32_16x16x32_bf16 a[92:95], a[172:175], v[196:199], a[92:95]
    s_movk_i32 s93, 336
    v_add_u32 v22, 0, v0
    v_mul_u32_u24 v23, 205, v22
    v_mfma_f32_16x16x32_bf16 a[96:99], a[176:179], v[196:199], a[96:99]
    v_lshrrev_b32 v23, 11, v23
    v_mul_u32_u24 v12, 10, v23
    v_mfma_f32_16x16x32_bf16 a[100:103], a[180:183], v[196:199], a[100:103]
    v_sub_u32 v22, v22, v12
    v_lshlrev_b32 v22, 4, v22
    v_mfma_f32_16x16x32_bf16 a[104:107], a[184:187], v[196:199], a[104:107]
    buffer_load_dwordx4 v[224:227], v9, s[12:15], s82 offen offset:0 sc1
    s_waitcnt vmcnt(11)
    v_mfma_f32_16x16x32_bf16 a[108:111], a[168:171], v[200:203], a[108:111]
    v_mad_u32_u24 v12, v23, s91, v22
    v_mad_u32_u24 v15, v23, s93, v22
    v_mfma_f32_16x16x32_bf16 a[112:115], a[172:175], v[200:203], a[112:115]
    v_add_u32 v15, s90, v15
    v_add_u32 v22, 64, v0
    v_mfma_f32_16x16x32_bf16 a[116:119], a[176:179], v[200:203], a[116:119]
    v_mul_u32_u24 v23, 205, v22
    v_lshrrev_b32 v23, 11, v23
    v_mfma_f32_16x16x32_bf16 a[120:123], a[180:183], v[200:203], a[120:123]
    v_mul_u32_u24 v13, 10, v23
    v_sub_u32 v22, v22, v13
    v_mfma_f32_16x16x32_bf16 a[124:127], a[184:187], v[200:203], a[124:127]
    buffer_load_dwordx4 v[228:231], v10, s[12:15], s82 offen offset:0 sc1
    s_waitcnt vmcnt(10)
    v_mfma_f32_16x16x32_bf16 a[0:3], a[188:191], v[204:207], a[0:3]
    buffer_load_dwordx4 v[80:83], v1, s[56:59], s49 offen offset:1024 sc1
    v_mfma_f32_16x16x32_bf16 a[4:7], a[192:195], v[204:207], a[4:7]
    v_lshlrev_b32 v22, 4, v22
    v_mad_u32_u24 v13, v23, s91, v22
    v_mfma_f32_16x16x32_bf16 a[8:11], a[196:199], v[204:207], a[8:11]
    v_mad_u32_u24 v16, v23, s93, v22
    v_add_u32 v16, s90, v16
    v_mfma_f32_16x16x32_bf16 a[12:15], a[200:203], v[204:207], a[12:15]
    v_and_b32 v22, 31, v0
    v_add_u32 v22, 128, v22
    v_mfma_f32_16x16x32_bf16 a[16:19], a[204:207], v[204:207], a[16:19]
    buffer_load_dwordx4 v[232:235], v11, s[12:15], s82 offen offset:0 sc1
    s_waitcnt vmcnt(10)
    v_mfma_f32_16x16x32_bf16 a[20:23], a[188:191], v[208:211], a[20:23]
    v_mul_u32_u24 v23, 205, v22
    v_lshrrev_b32 v23, 11, v23
    v_mfma_f32_16x16x32_bf16 a[24:27], a[192:195], v[208:211], a[24:27]
    v_mul_u32_u24 v14, 10, v23
    v_sub_u32 v22, v22, v14
    v_mfma_f32_16x16x32_bf16 a[28:31], a[196:199], v[208:211], a[28:31]
    v_lshlrev_b32 v22, 4, v22
    v_mad_u32_u24 v14, v23, s91, v22
    v_mfma_f32_16x16x32_bf16 a[32:35], a[200:203], v[208:211], a[32:35]
    buffer_load_dwordx4 v[84:87], v1, s[56:59], s49 offen offset:2048 sc1
    v_mfma_f32_16x16x32_bf16 a[36:39], a[204:207], v[208:211], a[36:39]
    buffer_load_dwordx4 v[196:199], v8, s[12:15], s82 offen offset:1024 sc1
    s_waitcnt vmcnt(11)
    v_mfma_f32_16x16x32_bf16 a[88:91], a[188:191], v[212:215], a[88:91]
    v_mad_u32_u24 v17, v23, s93, v22
    v_add_u32 v17, s90, v17
    v_mfma_f32_16x16x32_bf16 a[92:95], a[192:195], v[212:215], a[92:95]
    v_lshrrev_b32 v23, 5, v0
    v_lshl_add_u32 v14, v23, 30, v14
    v_mfma_f32_16x16x32_bf16 a[96:99], a[196:199], v[212:215], a[96:99]
    v_and_b32 v22, 15, v0
    v_mul_u32_u24 v22, 336, v22
    v_mfma_f32_16x16x32_bf16 a[100:103], a[200:203], v[212:215], a[100:103]
    v_lshl_add_u32 v22, v23, 4, v22
    v_bfe_u32 v23, v0, 4, 1
    v_mfma_f32_16x16x32_bf16 a[104:107], a[204:207], v[212:215], a[104:107]
    buffer_load_dwordx4 v[200:203], v9, s[12:15], s82 offen offset:1024 sc1
    s_waitcnt vmcnt(10)
    v_mfma_f32_16x16x32_bf16 a[108:111], a[188:191], v[216:219], a[108:111]
    buffer_load_dwordx4 v[88:91], v1, s[56:59], s49 offen offset:3072 sc1
    v_mfma_f32_16x16x32_bf16 a[112:115], a[192:195], v[216:219], a[112:115]
    s_add_u32 s49, s49, s29
    v_mul_u32_u24 v23, 160, v23
    v_add_u32 v22, v22, v23
    v_mfma_f32_16x16x32_bf16 a[116:119], a[196:199], v[216:219], a[116:119]
    s_add_u32 s49, s49, 4096
    v_mfma_f32_16x16x32_bf16 a[120:123], a[200:203], v[216:219], a[120:123]
    s_add_u32 s90, s90, 98304
    v_add_u32 v21, s90, v22
    v_mfma_f32_16x16x32_bf16 a[124:127], a[204:207], v[216:219], a[124:127]
    s_add_u32 s90, s64, 1
    buffer_load_dwordx4 v[204:207], v10, s[12:15], s82 offen offset:1024 sc1
    s_waitcnt vmcnt(10)
    v_mfma_f32_16x16x32_bf16 a[0:3], a[208:211], v[220:223], a[0:3]
    s_add_u32 s88, s88, 16384
    v_mov_b32 v3, 0
    v_mfma_f32_16x16x32_bf16 a[4:7], a[212:215], v[220:223], a[4:7]
    s_and_b32 s90, s90, 3
    buffer_atomic_add v3, v30, s[12:15], s88 offen sc0 sc1
    v_mfma_f32_16x16x32_bf16 a[8:11], a[216:219], v[220:223], a[8:11]
    s_mul_i32 s90, s90, 16128
    v_mfma_f32_16x16x32_bf16 a[12:15], a[220:223], v[220:223], a[12:15]
    s_add_u32 s90, s90, 0
    v_add_u32 v18, s90, v22
    v_mfma_f32_16x16x32_bf16 a[16:19], a[224:227], v[220:223], a[16:19]
    s_add_u32 s90, s64, 2
    buffer_load_dwordx4 v[208:211], v11, s[12:15], s82 offen offset:1024 sc1
    s_waitcnt vmcnt(10)
    v_mfma_f32_16x16x32_bf16 a[20:23], a[208:211], v[224:227], a[20:23]
    s_and_b32 s90, s90, 3
    buffer_load_dwordx4 a[40:43], v1, s[12:15], s49 offen offset:0 sc1
    v_mfma_f32_16x16x32_bf16 a[24:27], a[212:215], v[224:227], a[24:27]
    s_mul_i32 s90, s90, 16128
    v_mfma_f32_16x16x32_bf16 a[28:31], a[216:219], v[224:227], a[28:31]
    s_add_u32 s90, s90, 5376
    v_add_u32 v19, s90, v22
    v_mfma_f32_16x16x32_bf16 a[32:35], a[220:223], v[224:227], a[32:35]
    s_add_u32 s90, s64, 3
    v_mfma_f32_16x16x32_bf16 a[36:39], a[224:227], v[224:227], a[36:39]
    s_and_b32 s90, s90, 3
    buffer_load_dwordx4 v[212:215], v8, s[12:15], s83 offen offset:0 sc1
    s_waitcnt vmcnt(11)
    v_mfma_f32_16x16x32_bf16 a[88:91], a[208:211], v[228:231], a[88:91]
    s_mul_i32 s90, s90, 16128
    v_mfma_f32_16x16x32_bf16 a[92:95], a[212:215], v[228:231], a[92:95]
    s_add_u32 s90, s90, 10752
    v_add_u32 v20, s90, v22
    v_mfma_f32_16x16x32_bf16 a[96:99], a[216:219], v[228:231], a[96:99]
    v_mfma_f32_16x16x32_bf16 a[100:103], a[220:223], v[228:231], a[100:103]
    buffer_load_dwordx4 a[44:47], v1, s[12:15], s49 offen offset:1024 sc1
    v_mfma_f32_16x16x32_bf16 a[104:107], a[224:227], v[228:231], a[104:107]
    buffer_load_dwordx4 v[216:219], v9, s[12:15], s83 offen offset:0 sc1
    s_waitcnt vmcnt(11)
    v_mfma_f32_16x16x32_bf16 a[108:111], a[208:211], v[232:235], a[108:111]
    v_mfma_f32_16x16x32_bf16 a[112:115], a[212:215], v[232:235], a[112:115]
    v_mfma_f32_16x16x32_bf16 a[116:119], a[216:219], v[232:235], a[116:119]
    v_mfma_f32_16x16x32_bf16 a[120:123], a[220:223], v[232:235], a[120:123]
    v_mfma_f32_16x16x32_bf16 a[124:127], a[224:227], v[232:235], a[124:127]
    buffer_load_dwordx4 v[220:223], v10, s[12:15], s83 offen offset:0 sc1
    s_waitcnt vmcnt(10)
    v_mfma_f32_16x16x32_bf16 a[0:3], a[228:231], v[196:199], a[0:3]
    v_mfma_f32_16x16x32_bf16 a[4:7], a[232:235], v[196:199], a[4:7]
    buffer_load_dwordx4 a[48:51], v1, s[12:15], s49 offen offset:2048 sc1
    v_mfma_f32_16x16x32_bf16 a[8:11], a[236:239], v[196:199], a[8:11]
    v_mfma_f32_16x16x32_bf16 a[12:15], a[240:243], v[196:199], a[12:15]
    v_mfma_f32_16x16x32_bf16 a[16:19], a[244:247], v[196:199], a[16:19]
    buffer_load_dwordx4 v[224:227], v11, s[12:15], s83 offen offset:0 sc1
    s_waitcnt vmcnt(11)
    v_mfma_f32_16x16x32_bf16 a[20:23], a[228:231], v[200:203], a[20:23]
    v_mfma_f32_16x16x32_bf16 a[24:27], a[232:235], v[200:203], a[24:27]
    v_mfma_f32_16x16x32_bf16 a[28:31], a[236:239], v[200:203], a[28:31]
    v_mfma_f32_16x16x32_bf16 a[32:35], a[240:243], v[200:203], a[32:35]
    v_mfma_f32_16x16x32_bf16 a[36:39], a[244:247], v[200:203], a[36:39]
    buffer_load_dwordx4 v[228:231], v8, s[12:15], s83 offen offset:1024 sc1
    s_waitcnt vmcnt(10)
    v_mfma_f32_16x16x32_bf16 a[88:91], a[228:231], v[204:207], a[88:91]
    buffer_load_dwordx4 a[52:55], v1, s[12:15], s49 offen offset:3072 sc1
    v_mfma_f32_16x16x32_bf16 a[92:95], a[232:235], v[204:207], a[92:95]
    s_add_u32 s49, s49, 4096
    v_mfma_f32_16x16x32_bf16 a[96:99], a[236:239], v[204:207], a[96:99]
    v_mfma_f32_16x16x32_bf16 a[100:103], a[240:243], v[204:207], a[100:103]
    v_mfma_f32_16x16x32_bf16 a[104:107], a[244:247], v[204:207], a[104:107]
    buffer_load_dwordx4 v[232:235], v9, s[12:15], s83 offen offset:1024 sc1
    s_waitcnt vmcnt(10)
    v_mfma_f32_16x16x32_bf16 a[108:111], a[228:231], v[208:211], a[108:111]
    v_mfma_f32_16x16x32_bf16 a[112:115], a[232:235], v[208:211], a[112:115]
    v_mfma_f32_16x16x32_bf16 a[116:119], a[236:239], v[208:211], a[116:119]
    v_mfma_f32_16x16x32_bf16 a[120:123], a[240:243], v[208:211], a[120:123]
    buffer_load_dwordx4 a[56:59], v1, s[12:15], s49 offen offset:0 sc1
    v_mfma_f32_16x16x32_bf16 a[124:127], a[244:247], v[208:211], a[124:127]
    buffer_load_dwordx4 v[196:199], v10, s[12:15], s83 offen offset:1024 sc1
    s_waitcnt vmcnt(10)
    v_mfma_f32_16x16x32_bf16 a[0:3], v[96:99], v[212:215], a[0:3]
    v_mfma_f32_16x16x32_bf16 a[4:7], v[100:103], v[212:215], a[4:7]
    v_mfma_f32_16x16x32_bf16 a[8:11], v[104:107], v[212:215], a[8:11]
    v_mfma_f32_16x16x32_bf16 a[12:15], v[108:111], v[212:215], a[12:15]
    v_mfma_f32_16x16x32_bf16 a[16:19], v[112:115], v[212:215], a[16:19]
    buffer_load_dwordx4 v[200:203], v11, s[12:15], s83 offen offset:1024 sc1
    v_cmp_ne_u32 vcc, 4, v3
    s_nop 0
    s_bitcmp1_b32 vcc_lo, 0
    s_cbranch_scc1 L_spin4
L_back4:
    s_waitcnt vmcnt(9)
    v_mfma_f32_16x16x32_bf16 a[20:23], v[96:99], v[216:219], a[20:23]
    v_mfma_f32_16x16x32_bf16 a[24:27], v[100:103], v[216:219], a[24:27]
    buffer_load_dwordx4 a[60:63], v1, s[12:15], s49 offen offset:1024 sc1
    v_mfma_f32_16x16x32_bf16 a[28:31], v[104:107], v[216:219], a[28:31]
    v_mfma_f32_16x16x32_bf16 a[32:35], v[108:111], v[216:219], a[32:35]
    v_mfma_f32_16x16x32_bf16 a[36:39], v[112:115], v[216:219], a[36:39]
    buffer_load_dwordx4 v[204:207], v8, s[12:15], s84 offen offset:0 sc1
    s_waitcnt vmcnt(10)
    v_mfma_f32_16x16x32_bf16 a[88:91], v[96:99], v[220:223], a[88:91]
    v_mfma_f32_16x16x32_bf16 a[92:95], v[100:103], v[220:223], a[92:95]
    v_mfma_f32_16x16x32_bf16 a[96:99], v[104:107], v[220:223], a[96:99]
    v_mfma_f32_16x16x32_bf16 a[100:103], v[108:111], v[220:223], a[100:103]
    v_mfma_f32_16x16x32_bf16 a[104:107], v[112:115], v[220:223], a[104:107]
    buffer_load_dwordx4 v[208:211], v9, s[12:15], s84 offen offset:0 sc1
    s_waitcnt vmcnt(9)
    v_mfma_f32_16x16x32_bf16 a[108:111], v[96:99], v[224:227], a[108:111]
    buffer_load_dwordx4 a[64:67], v1, s[12:15], s49 offen offset:2048 sc1
    v_mfma_f32_16x16x32_bf16 a[112:115], v[100:103], v[224:227], a[112:115]
    v_mfma_f32_16x16x32_bf16 a[116:119], v[104:107], v[224:227], a[116:119]
    v_mfma_f32_16x16x32_bf16 a[120:123], v[108:111], v[224:227], a[120:123]
    v_mfma_f32_16x16x32_bf16 a[124:127], v[112:115], v[224:227], a[124:127]
    buffer_load_dwordx4 v[212:215], v10, s[12:15], s84 offen offset:0 sc1
    s_waitcnt vmcnt(10)
    v_mfma_f32_16x16x32_bf16 a[0:3], v[116:119], v[228:231], a[0:3]
    v_mfma_f32_16x16x32_bf16 a[4:7], v[120:123], v[228:231], a[4:7]
    v_mfma_f32_16x16x32_bf16 a[8:11], v[124:127], v[228:231], a[8:11]
    v_mfma_f32_16x16x32_bf16 a[12:15], v[128:131], v[228:231], a[12:15]
    buffer_load_dwordx4 a[68:71], v1, s[12:15], s49 offen offset:3072 sc1
    v_mfma_f32_16x16x32_bf16 a[16:19], v[132:135], v[228:231], a[16:19]
    s_add_u32 s49, s49, 4096
    buffer_load_dwordx4 v[216:219], v11, s[12:15], s84 offen offset:0 sc1
    s_waitcnt vmcnt(10)
    v_mfma_f32_16x16x32_bf16 a[20:23], v[116:119], v[232:235], a[20:23]
    v_mfma_f32_16x16x32_bf16 a[24:27], v[120:123], v[232:235], a[24:27]
    v_mfma_f32_16x16x32_bf16 a[28:31], v[124:127], v[232:235], a[28:31]
    v_mfma_f32_16x16x32_bf16 a[32:35], v[128:131], v[232:235], a[32:35]
    v_mfma_f32_16x16x32_bf16 a[36:39], v[132:135], v[232:235], a[36:39]
    buffer_load_dwordx4 v[220:223], v8, s[12:15], s84 offen offset:1024 sc1
    s_waitcnt vmcnt(9)
    v_mfma_f32_16x16x32_bf16 a[88:91], v[116:119], v[196:199], a[88:91]
    v_mfma_f32_16x16x32_bf16 a[92:95], v[120:123], v[196:199], a[92:95]
    buffer_load_dwordx4 a[72:75], v1, s[12:15], s49 offen offset:0 sc1
    v_mfma_f32_16x16x32_bf16 a[96:99], v[124:127], v[196:199], a[96:99]
    v_mfma_f32_16x16x32_bf16 a[100:103], v[128:131], v[196:199], a[100:103]
    v_mfma_f32_16x16x32_bf16 a[104:107], v[132:135], v[196:199], a[104:107]
    buffer_load_dwordx4 v[224:227], v9, s[12:15], s84 offen offset:1024 sc1
    s_waitcnt vmcnt(10)
    v_mfma_f32_16x16x32_bf16 a[108:111], v[116:119], v[200:203], a[108:111]
    v_mfma_f32_16x16x32_bf16 a[112:115], v[120:123], v[200:203], a[112:115]
    v_mfma_f32_16x16x32_bf16 a[116:119], v[124:127], v[200:203], a[116:119]
    v_mfma_f32_16x16x32_bf16 a[120:123], v[128:131], v[200:203], a[120:123]
    v_mfma_f32_16x16x32_bf16 a[124:127], v[132:135], v[200:203], a[124:127]
    buffer_load_dwordx4 v[228:231], v10, s[12:15], s84 offen offset:1024 sc1
    s_waitcnt vmcnt(9)
    v_mfma_f32_16x16x32_bf16 a[0:3], v[136:139], v[204:207], a[0:3]
    buffer_load_dwordx4 a[76:79], v1, s[12:15], s49 offen offset:1024 sc1
    v_mfma_f32_16x16x32_bf16 a[4:7], v[140:143], v[204:207], a[4:7]
    v_mfma_f32_16x16x32_bf16 a[8:11], v[144:147], v[204:207], a[8:11]
    v_mfma_f32_16x16x32_bf16 a[12:15], v[148:151], v[204:207], a[12:15]
    v_mfma_f32_16x16x32_bf16 a[16:19], v[152:155], v[204:207], a[16:19]
    buffer_load_dwordx4 v[232:235], v11, s[12:15], s84 offen offset:1024 sc1
    s_waitcnt vmcnt(10)
    v_mfma_f32_16x16x32_bf16 a[20:23], v[136:139], v[208:211], a[20:23]
    v_mfma_f32_16x16x32_bf16 a[24:27], v[140:143], v[208:211], a[24:27]
    v_mfma_f32_16x16x32_bf16 a[28:31], v[144:147], v[208:211], a[28:31]
    v_mfma_f32_16x16x32_bf16 a[32:35], v[148:151], v[208:211], a[32:35]
    buffer_load_dwordx4 a[128:131], v1, s[12:15], s49 offen offset:2048 sc1
    v_mfma_f32_16x16x32_bf16 a[36:39], v[152:155], v[208:211], a[36:39]
    buffer_load_dwordx4 v[196:199], v8, s[12:15], s84 offen offset:2048 sc1
    s_waitcnt vmcnt(10)
    v_mfma_f32_16x16x32_bf16 a[88:91], v[136:139], v[212:215], a[88:91]
    v_mfma_f32_16x16x32_bf16 a[92:95], v[140:143], v[212:215], a[92:95]
    v_mfma_f32_16x16x32_bf16 a[96:99], v[144:147], v[212:215], a[96:99]
    v_mfma_f32_16x16x32_bf16 a[100:103], v[148:151], v[212:215], a[100:103]
    v_mfma_f32_16x16x32_bf16 a[104:107], v[152:155], v[212:215], a[104:107]
    buffer_load_dwordx4 v[200:203], v9, s[12:15], s84 offen offset:2048 sc1
    s_waitcnt vmcnt(9)
    v_mfma_f32_16x16x32_bf16 a[108:111], v[136:139], v[216:219], a[108:111]
    v_mfma_f32_16x16x32_bf16 a[112:115], v[140:143], v[216:219], a[112:115]
    v_mfma_f32_16x16x32_bf16 a[116:119], v[144:147], v[216:219], a[116:119]
    v_mfma_f32_16x16x32_bf16 a[120:123], v[148:151], v[216:219], a[120:123]
    buffer_load_dwordx4 a[132:135], v1, s[12:15], s49 offen offset:3072 sc1
    v_mfma_f32_16x16x32_bf16 a[124:127], v[152:155], v[216:219], a[124:127]
    s_add_u32 s49, s49, 4096
    buffer_load_dwordx4 v[204:207], v10, s[12:15], s84 offen offset:2048 sc1
    s_waitcnt vmcnt(10)
    v_mfma_f32_16x16x32_bf16 a[0:3], v[156:159], v[220:223], a[0:3]
    v_mfma_f32_16x16x32_bf16 a[4:7], v[160:163], v[220:223], a[4:7]
    v_mfma_f32_16x16x32_bf16 a[8:11], v[164:167], v[220:223], a[8:11]
    v_mfma_f32_16x16x32_bf16 a[12:15], v[168:171], v[220:223], a[12:15]
    v_mfma_f32_16x16x32_bf16 a[16:19], v[172:175], v[220:223], a[16:19]
    buffer_load_dwordx4 v[208:211], v11, s[12:15], s84 offen offset:2048 sc1
    s_waitcnt vmcnt(9)
    v_mfma_f32_16x16x32_bf16 a[20:23], v[156:159], v[224:227], a[20:23]
    buffer_load_dwordx4 a[136:139], v1, s[12:15], s49 offen offset:0 sc1
L_pg0_4:
    s_cbranch_execz L_pgret0
    v_mfma_f32_16x16x32_bf16 a[24:27], v[160:163], v[224:227], a[24:27]
    v_mfma_f32_16x16x32_bf16 a[28:31], v[164:167], v[224:227], a[28:31]
    v_mfma_f32_16x16x32_bf16 a[32:35], v[168:171], v[224:227], a[32:35]
    v_mfma_f32_16x16x32_bf16 a[36:39], v[172:175], v[224:227], a[36:39]
    buffer_load_dwordx4 v[212:215], v8, s[12:15], s84 offen offset:3072 sc1
    s_waitcnt vmcnt(10)
    v_mfma_f32_16x16x32_bf16 a[88:91], v[156:159], v[228:231], a[88:91]
    v_mfma_f32_16x16x32_bf16 a[92:95], v[160:163], v[228:231], a[92:95]
    v_mfma_f32_16x16x32_bf16 a[96:99], v[164:167], v[228:231], a[96:99]
    v_mfma_f32_16x16x32_bf16 a[100:103], v[168:171], v[228:231], a[100:103]
    buffer_load_dwordx4 a[140:143], v1, s[12:15], s49 offen offset:1024 sc1
    v_mfma_f32_16x16x32_bf16 a[104:107], v[172:175], v[228:231], a[104:107]
    buffer_load_dwordx4 v[216:219], v9, s[12:15], s84 offen offset:3072 sc1
    s_waitcnt vmcnt(10)
    v_mfma_f32_16x16x32_bf16 a[108:111], v[156:159], v[232:235], a[108:111]
    v_mfma_f32_16x16x32_bf16 a[112:115], v[160:163], v[232:235], a[112:115]
    v_mfma_f32_16x16x32_bf16 a[116:119], v[164:167], v[232:235], a[116:119]
    v_mfma_f32_16x16x32_bf16 a[120:123], v[168:171], v[232:235], a[120:123]
    v_mfma_f32_16x16x32_bf16 a[124:127], v[172:175], v[232:235], a[124:127]
    buffer_load_dwordx4 v[220:223], v10, s[12:15], s84 offen offset:3072 sc1
    s_waitcnt vmcnt(9)
    v_mfma_f32_16x16x32_bf16 a[0:3], v[176:179], v[196:199], a[0:3]
    s_add_u32 s88, s88, 16384
    v_mov_b32 v3, 0
    v_mfma_f32_16x16x32_bf16 a[4:7], v[180:183], v[196:199], a[4:7]
    buffer_atomic_add v3, v30, s[12:15], s88 offen sc0 sc1
    v_mfma_f32_16x16x32_bf16 a[8:11], v[184:187], v[196:199], a[8:11]
    buffer_load_dwordx4 v[116:119], v12, s[4:7], s89 offen
    v_mfma_f32_16x16x32_bf16 a[12:15], v[188:191], v[196:199], a[12:15]
    buffer_load_dwordx4 a[144:147], v1, s[12:15], s49 offen offset:2048 sc1
    v_mfma_f32_16x16x32_bf16 a[16:19], v[192:195], v[196:199], a[16:19]
    buffer_load_dwordx4 v[224:227], v11, s[12:15], s84 offen offset:3072 sc1
    s_waitcnt vmcnt(12)
    v_mfma_f32_16x16x32_bf16 a[20:23], v[176:179], v[200:203], a[20:23]
    buffer_load_dwordx4 v[120:123], v13, s[4:7], s89 offen
    v_mfma_f32_16x16x32_bf16 a[24:27], v[180:183], v[200:203], a[24:27]
    buffer_load_dwordx4 v[124:127], v14, s[4:7], s89 offen
    v_mfma_f32_16x16x32_bf16 a[28:31], v[184:187], v[200:203], a[28:31]
    v_mfma_f32_16x16x32_bf16 a[32:35], v[188:191], v[200:203], a[32:35]
    v_mfma_f32_16x16x32_bf16 a[36:39], v[192:195], v[200:203], a[36:39]
    buffer_load_dwordx4 v[228:231], v8, s[12:15], s85 offen offset:0 sc1
    s_waitcnt vmcnt(13)
    v_mfma_f32_16x16x32_bf16 a[88:91], v[176:179], v[204:207], a[88:91]
    buffer_load_dwordx4 a[148:151], v1, s[12:15], s49 offen offset:3072 sc1
    v_mfma_f32_16x16x32_bf16 a[92:95], v[180:183], v[204:207], a[92:95]
    s_add_u32 s49, s49, 4096
    v_mfma_f32_16x16x32_bf16 a[96:99], v[184:187], v[204:207], a[96:99]
    v_mfma_f32_16x16x32_bf16 a[100:103], v[188:191], v[204:207], a[100:103]
    v_mfma_f32_16x16x32_bf16 a[104:107], v[192:195], v[204:207], a[104:107]
    buffer_load_dwordx4 v[232:235], v9, s[12:15], s85 offen offset:0 sc1
    s_waitcnt vmcnt(14)
    v_mfma_f32_16x16x32_bf16 a[108:111], v[176:179], v[208:211], a[108:111]
    v_mfma_f32_16x16x32_bf16 a[112:115], v[180:183], v[208:211], a[112:115]
    v_mfma_f32_16x16x32_bf16 a[116:119], v[184:187], v[208:211], a[116:119]
    v_mfma_f32_16x16x32_bf16 a[120:123], v[188:191], v[208:211], a[120:123]
    v_mfma_f32_16x16x32_bf16 a[124:127], v[192:195], v[208:211], a[124:127]
    buffer_load_dwordx4 v[196:199], v10, s[12:15], s85 offen offset:0 sc1
    s_waitcnt vmcnt(13)
    v_mfma_f32_16x16x32_bf16 a[0:3], v[32:35], v[212:215], a[0:3]
    buffer_load_dwordx4 a[152:155], v1, s[12:15], s49 offen offset:0 sc1
    v_mfma_f32_16x16x32_bf16 a[4:7], v[36:39], v[212:215], a[4:7]
    v_mfma_f32_16x16x32_bf16 a[8:11], v[40:43], v[212:215], a[8:11]
    v_mfma_f32_16x16x32_bf16 a[12:15], v[44:47], v[212:215], a[12:15]
    v_mfma_f32_16x16x32_bf16 a[16:19], v[48:51], v[212:215], a[16:19]
    buffer_load_dwordx4 v[200:203], v11, s[12:15], s85 offen offset:0 sc1
    s_waitcnt vmcnt(13)
    v_mfma_f32_16x16x32_bf16 a[20:23], v[32:35], v[216:219], a[20:23]
    v_mfma_f32_16x16x32_bf16 a[24:27], v[36:39], v[216:219], a[24:27]
    v_mfma_f32_16x16x32_bf16 a[28:31], v[40:43], v[216:219], a[28:31]
    v_mfma_f32_16x16x32_bf16 a[32:35], v[44:47], v[216:219], a[32:35]
    buffer_load_dwordx4 a[156:159], v1, s[12:15], s49 offen offset:1024 sc1
    v_mfma_f32_16x16x32_bf16 a[36:39], v[48:51], v[216:219], a[36:39]
    buffer_load_dwordx4 v[204:207], v8, s[12:15], s85 offen offset:1024 sc1
    s_waitcnt vmcnt(14)
    v_mfma_f32_16x16x32_bf16 a[88:91], v[32:35], v[220:223], a[88:91]
    v_mfma_f32_16x16x32_bf16 a[92:95], v[36:39], v[220:223], a[92:95]
    v_mfma_f32_16x16x32_bf16 a[96:99], v[40:43], v[220:223], a[96:99]
    v_mfma_f32_16x16x32_bf16 a[100:103], v[44:47], v[220:223], a[100:103]
    v_mfma_f32_16x16x32_bf16 a[104:107], v[48:51], v[220:223], a[104:107]
    buffer_load_dwordx4 v[208:211], v9, s[12:15], s85 offen offset:1024 sc1
    s_waitcnt vmcnt(11)
    v_mfma_f32_16x16x32_bf16 a[108:111], v[32:35], v[224:227], a[108:111]
    v_mfma_f32_16x16x32_bf16 a[112:115], v[36:39], v[224:227], a[112:115]
    buffer_load_dwordx4 a[160:163], v1, s[12:15], s49 offen offset:2048 sc1
    v_mfma_f32_16x16x32_bf16 a[116:119], v[40:43], v[224:227], a[116:119]
    v_mfma_f32_16x16x32_bf16 a[120:123], v[44:47], v[224:227], a[120:123]
    v_mfma_f32_16x16x32_bf16 a[124:127], v[48:51], v[224:227], a[124:127]
    buffer_load_dwordx4 v[212:215], v10, s[12:15], s85 offen offset:1024 sc1
    s_waitcnt vmcnt(10)
    v_mfma_f32_16x16x32_bf16 a[0:3], v[52:55], v[228:231], a[0:3]
    v_mfma_f32_16x16x32_bf16 a[4:7], v[56:59], v[228:231], a[4:7]
    v_mfma_f32_16x16x32_bf16 a[8:11], v[60:63], v[228:231], a[8:11]
    v_mfma_f32_16x16x32_bf16 a[12:15], v[64:67], v[228:231], a[12:15]
    v_mfma_f32_16x16x32_bf16 a[16:19], v[68:71], v[228:231], a[16:19]
    buffer_load_dwordx4 v[216:219], v11, s[12:15], s85 offen offset:1024 sc1
    v_cmp_ne_u32 vcc, 4, v3
    s_nop 0
    s_bitcmp1_b32 vcc_lo, 0
    s_cbranch_scc1 L_spin5
L_back5:
    s_waitcnt vmcnt(9)
    v_mfma_f32_16x16x32_bf16 a[20:23], v[52:55], v[232:235], a[20:23]
    buffer_load_dwordx4 a[164:167], v1, s[12:15], s49 offen offset:3072 sc1
    v_mfma_f32_16x16x32_bf16 a[24:27], v[56:59], v[232:235], a[24:27]
    s_add_u32 s49, s49, 4096
    v_mfma_f32_16x16x32_bf16 a[28:31], v[60:63], v[232:235], a[28:31]
    v_mfma_f32_16x16x32_bf16 a[32:35], v[64:67], v[232:235], a[32:35]
    v_mfma_f32_16x16x32_bf16 a[36:39], v[68:71], v[232:235], a[36:39]
    buffer_load_dwordx4 v[220:223], v8, s[12:15], s86 offen offset:0 sc1
    s_waitcnt vmcnt(10)
    v_mfma_f32_16x16x32_bf16 a[88:91], v[52:55], v[196:199], a[88:91]
    v_mfma_f32_16x16x32_bf16 a[92:95], v[56:59], v[196:199], a[92:95]
    v_mfma_f32_16x16x32_bf16 a[96:99], v[60:63], v[196:199], a[96:99]
    v_mfma_f32_16x16x32_bf16 a[100:103], v[64:67], v[196:199], a[100:103]
    buffer_load_dwordx4 a[168:171], v1, s[12:15], s49 offen offset:0 sc1
    v_mfma_f32_16x16x32_bf16 a[104:107], v[68:71], v[196:199], a[104:107]
    buffer_load_dwordx4 v[224:227], v9, s[12:15], s86 offen offset:0 sc1
    s_waitcnt vmcnt(10)
    v_mfma_f32_16x16x32_bf16 a[108:111], v[52:55], v[200:203], a[108:111]
    v_mfma_f32_16x16x32_bf16 a[112:115], v[56:59], v[200:203], a[112:115]
    v_mfma_f32_16x16x32_bf16 a[116:119], v[60:63], v[200:203], a[116:119]
    v_mfma_f32_16x16x32_bf16 a[120:123], v[64:67], v[200:203], a[120:123]
    v_mfma_f32_16x16x32_bf16 a[124:127], v[68:71], v[200:203], a[124:127]
    buffer_load_dwordx4 v[228:231], v10, s[12:15], s86 offen offset:0 sc1
    s_waitcnt vmcnt(9)
    v_mfma_f32_16x16x32_bf16 a[0:3], v[72:75], v[204:207], a[0:3]
    v_mfma_f32_16x16x32_bf16 a[4:7], v[76:79], v[204:207], a[4:7]
    buffer_load_dwordx4 a[172:175], v1, s[12:15], s49 offen offset:1024 sc1
    v_mfma_f32_16x16x32_bf16 a[8:11], v[80:83], v[204:207], a[8:11]
    v_mfma_f32_16x16x32_bf16 a[12:15], v[84:87], v[204:207], a[12:15]
    v_mfma_f32_16x16x32_bf16 a[16:19], v[88:91], v[204:207], a[16:19]
    buffer_load_dwordx4 v[232:235], v11, s[12:15], s86 offen offset:0 sc1
    s_waitcnt vmcnt(10)
    v_mfma_f32_16x16x32_bf16 a[20:23], v[72:75], v[208:211], a[20:23]
    v_mfma_f32_16x16x32_bf16 a[24:27], v[76:79], v[208:211], a[24:27]
    v_mfma_f32_16x16x32_bf16 a[28:31], v[80:83], v[208:211], a[28:31]
    v_lshlrev_b32 v128, 16, v116
    v_and_b32 v129, s75, v116
    v_mfma_f32_16x16x32_bf16 a[32:35], v[84:87], v[208:211], a[32:35]
    v_lshlrev_b32 v130, 16, v117
    v_and_b32 v131, s75, v117
    v_mfma_f32_16x16x32_bf16 a[36:39], v[88:91], v[208:211], a[36:39]
    buffer_load_dwordx4 v[196:199], v8, s[12:15], s86 offen offset:1024 sc1
    s_waitcnt vmcnt(9)
    v_mfma_f32_16x16x32_bf16 a[88:91], v[72:75], v[212:215], a[88:91]
    buffer_load_dwordx4 a[176:179], v1, s[12:15], s49 offen offset:2048 sc1
    v_mfma_f32_16x16x32_bf16 a[92:95], v[76:79], v[212:215], a[92:95]
    v_lshlrev_b32 v132, 16, v118
    v_and_b32 v133, s75, v118
    v_mfma_f32_16x16x32_bf16 a[96:99], v[80:83], v[212:215], a[96:99]
    v_lshlrev_b32 v134, 16, v119
    v_and_b32 v135, s75, v119
    v_mfma_f32_16x16x32_bf16 a[100:103], v[84:87], v[212:215], a[100:103]
    v_lshlrev_b32 v136, 16, v120
    v_and_b32 v137, s75, v120
    v_mfma_f32_16x16x32_bf16 a[104:107], v[88:91], v[212:215], a[104:107]
    buffer_load_dwordx4 v[200:203], v9, s[12:15], s86 offen offset:1024 sc1
    s_waitcnt vmcnt(10)
    v_mfma_f32_16x16x32_bf16 a[108:111], v[72:75], v[216:219], a[108:111]
    v_lshlrev_b32 v138, 16, v121
    v_and_b32 v139, s75, v121
    v_mfma_f32_16x16x32_bf16 a[112:115], v[76:79], v[216:219], a[112:115]
    v_lshlrev_b32 v140, 16, v122
    v_and_b32 v141, s75, v122
    v_mfma_f32_16x16x32_bf16 a[116:119], v[80:83], v[216:219], a[116:119]
    v_lshlrev_b32 v142, 16, v123
    v_and_b32 v143, s75, v123
    v_mfma_f32_16x16x32_bf16 a[120:123], v[84:87], v[216:219], a[120:123]
    buffer_load_dwordx4 a[180:183], v1, s[12:15], s49 offen offset:3072 sc1
    v_mfma_f32_16x16x32_bf16 a[124:127], v[88:91], v[216:219], a[124:127]
    s_add_u32 s49, s49, 4096
    buffer_load_dwordx4 v[204:207], v10, s[12:15], s86 offen offset:1024 sc1
    s_waitcnt vmcnt(10)
    v_mfma_f32_16x16x32_bf16 a[0:3], a[40:43], v[220:223], a[0:3]
    v_lshlrev_b32 v144, 16, v124
    v_and_b32 v145, s75, v124
    v_mfma_f32_16x16x32_bf16 a[4:7], a[44:47], v[220:223], a[4:7]
    v_lshlrev_b32 v146, 16, v125
    v_and_b32 v147, s75, v125
    v_mfma_f32_16x16x32_bf16 a[8:11], a[48:51], v[220:223], a[8:11]
    v_lshlrev_b32 v148, 16, v126
    v_and_b32 v149, s75, v126
    v_mfma_f32_16x16x32_bf16 a[12:15], a[52:55], v[220:223], a[12:15]
    v_lshlrev_b32 v150, 16, v127
    v_and_b32 v151, s75, v127
    v_mfma_f32_16x16x32_bf16 a[16:19], a[56:59], v[220:223], a[16:19]
    buffer_load_dwordx4 v[208:211], v11, s[12:15], s86 offen offset:1024 sc1
    s_waitcnt vmcnt(9)
    v_mfma_f32_16x16x32_bf16 a[20:23], a[40:43], v[224:227], a[20:23]
    v_mfma_f32_16x16x32_bf16 a[24:27], a[44:47], v[224:227], a[24:27]
    buffer_load_dwordx4 a[184:187], v1, s[12:15], s49 offen offset:0 sc1
    v_mfma_f32_16x16x32_bf16 a[28:31], a[48:51], v[224:227], a[28:31]
    v_mfma_f32_16x16x32_bf16 a[32:35], a[52:55], v[224:227], a[32:35]
    v_mfma_f32_16x16x32_bf16 a[36:39], a[56:59], v[224:227], a[36:39]
    buffer_load_dwordx4 v[212:215], v8, s[12:15], s86 offen offset:2048 sc1
    s_waitcnt vmcnt(10)
    v_mfma_f32_16x16x32_bf16 a[88:91], a[40:43], v[228:231], a[88:91]
    v_mfma_f32_16x16x32_bf16 a[92:95], a[44:47], v[228:231], a[92:95]
    v_mfma_f32_16x16x32_bf16 a[96:99], a[48:51], v[228:231], a[96:99]
    v_mfma_f32_16x16x32_bf16 a[100:103], a[52:55], v[228:231], a[100:103]
    v_mfma_f32_16x16x32_bf16 a[104:107], a[56:59], v[228:231], a[104:107]
    buffer_load_dwordx4 v[216:219], v8, s[12:15], s86 offen offset:3072 sc1
    s_waitcnt vmcnt(9)
    v_mfma_f32_16x16x32_bf16 a[108:111], a[40:43], v[232:235], a[108:111]
    v_mfma_f32_16x16x32_bf16 a[112:115], a[44:47], v[232:235], a[112:115]
    v_mfma_f32_16x16x32_bf16 a[116:119], a[48:51], v[232:235], a[116:119]
    v_mfma_f32_16x16x32_bf16 a[120:123], a[52:55], v[232:235], a[120:123]
    v_mfma_f32_16x16x32_bf16 a[124:127], a[56:59], v[232:235], a[124:127]
    buffer_load_dwordx4 v[220:223], v8, s[12:15], s87 offen offset:0 sc1
    s_waitcnt vmcnt(9)
    v_mfma_f32_16x16x32_bf16 a[0:3], a[60:63], v[196:199], a[0:3]
    v_mfma_f32_16x16x32_bf16 a[4:7], a[64:67], v[196:199], a[4:7]
    v_mfma_f32_16x16x32_bf16 a[8:11], a[68:71], v[196:199], a[8:11]
    v_mfma_f32_16x16x32_bf16 a[12:15], a[72:75], v[196:199], a[12:15]
    v_mfma_f32_16x16x32_bf16 a[16:19], a[76:79], v[196:199], a[16:19]
    buffer_load_dwordx4 v[224:227], v9, s[12:15], s86 offen offset:2048 sc1
    s_waitcnt vmcnt(8)
    v_mfma_f32_16x16x32_bf16 a[20:23], a[60:63], v[200:203], a[20:23]
    v_mfma_f32_16x16x32_bf16 a[24:27], a[64:67], v[200:203], a[24:27]
    v_mfma_f32_16x16x32_bf16 a[28:31], a[68:71], v[200:203], a[28:31]
    v_mfma_f32_16x16x32_bf16 a[32:35], a[72:75], v[200:203], a[32:35]
    v_mfma_f32_16x16x32_bf16 a[36:39], a[76:79], v[200:203], a[36:39]
    buffer_load_dwordx4 v[228:231], v9, s[12:15], s86 offen offset:3072 sc1
    s_waitcnt vmcnt(7)
    v_mfma_f32_16x16x32_bf16 a[88:91], a[60:63], v[204:207], a[88:91]
    v_mfma_f32_16x16x32_bf16 a[92:95], a[64:67], v[204:207], a[92:95]
    v_mfma_f32_16x16x32_bf16 a[96:99], a[68:71], v[204:207], a[96:99]
    v_mfma_f32_16x16x32_bf16 a[100:103], a[72:75], v[204:207], a[100:103]
    v_mfma_f32_16x16x32_bf16 a[104:107], a[76:79], v[204:207], a[104:107]
    buffer_load_dwordx4 v[232:235], v9, s[12:15], s87 offen offset:0 sc1
    s_waitcnt vmcnt(7)
    v_mfma_f32_16x16x32_bf16 a[108:111], a[60:63], v[208:211], a[108:111]
    v_mfma_f32_16x16x32_bf16 a[112:115], a[64:67], v[208:211], a[112:115]
    v_mfma_f32_16x16x32_bf16 a[116:119], a[68:71], v[208:211], a[116:119]
    v_mfma_f32_16x16x32_bf16 a[120:123], a[72:75], v[208:211], a[120:123]
    v_mfma_f32_16x16x32_bf16 a[124:127], a[76:79], v[208:211], a[124:127]
    buffer_load_dwordx4 v[196:199], v10, s[12:15], s86 offen offset:2048 sc1
    s_waitcnt vmcnt(6)
    v_mfma_f32_16x16x32_bf16 a[0:3], a[128:131], v[212:215], a[0:3]
    v_mfma_f32_16x16x32_bf16 a[4:7], a[132:135], v[212:215], a[4:7]
    v_mfma_f32_16x16x32_bf16 a[8:11], a[136:139], v[212:215], a[8:11]
    v_mfma_f32_16x16x32_bf16 a[12:15], a[140:143], v[212:215], a[12:15]
    v_mfma_f32_16x16x32_bf16 a[16:19], a[144:147], v[212:215], a[16:19]
    buffer_load_dwordx4 v[200:203], v10, s[12:15], s86 offen offset:3072 sc1
    s_waitcnt vmcnt(6)
    v_mfma_f32_16x16x32_bf16 a[0:3], a[148:151], v[216:219], a[0:3]
    v_mfma_f32_16x16x32_bf16 a[4:7], a[152:155], v[216:219], a[4:7]
    v_mfma_f32_16x16x32_bf16 a[8:11], a[156:159], v[216:219], a[8:11]
    v_mfma_f32_16x16x32_bf16 a[12:15], a[160:163], v[216:219], a[12:15]
    v_mfma_f32_16x16x32_bf16 a[16:19], a[164:167], v[216:219], a[16:19]
    buffer_load_dwordx4 v[204:207], v10, s[12:15], s87 offen offset:0 sc1
    s_waitcnt vmcnt(6)
    v_mfma_f32_16x16x32_bf16 a[0:3], a[168:171], v[220:223], a[0:3]
    v_mfma_f32_16x16x32_bf16 a[4:7], a[172:175], v[220:223], a[4:7]
    v_mfma_f32_16x16x32_bf16 a[8:11], a[176:179], v[220:223], a[8:11]
    v_mfma_f32_16x16x32_bf16 a[12:15], a[180:183], v[220:223], a[12:15]
    v_mfma_f32_16x16x32_bf16 a[16:19], a[184:187], v[220:223], a[16:19]
    buffer_load_dwordx4 v[208:211], v11, s[12:15], s86 offen offset:2048 sc1
    s_waitcnt vmcnt(6)
    v_mfma_f32_16x16x32_bf16 a[20:23], a[128:131], v[224:227], a[20:23]
    v_mfma_f32_16x16x32_bf16 a[24:27], a[132:135], v[224:227], a[24:27]
    v_mfma_f32_16x16x32_bf16 a[28:31], a[136:139], v[224:227], a[28:31]
    v_mfma_f32_16x16x32_bf16 a[32:35], a[140:143], v[224:227], a[32:35]
    ds_write_b128 v18, a[0:3] offset:0
    v_mfma_f32_16x16x32_bf16 a[36:39], a[144:147], v[224:227], a[36:39]
    buffer_load_dwordx4 v[212:215], v11, s[12:15], s86 offen offset:3072 sc1
    s_waitcnt vmcnt(6)
    v_mfma_f32_16x16x32_bf16 a[20:23], a[148:151], v[228:231], a[20:23]
    ds_write_b128 v18, a[4:7] offset:32
    v_mfma_f32_16x16x32_bf16 a[24:27], a[152:155], v[228:231], a[24:27]
    ds_write_b128 v18, a[8:11] offset:64
    v_mfma_f32_16x16x32_bf16 a[28:31], a[156:159], v[228:231], a[28:31]
    ds_write_b128 v18, a[12:15] offset:96
    v_mfma_f32_16x16x32_bf16 a[32:35], a[160:163], v[228:231], a[32:35]
    ds_write_b128 v18, a[16:19] offset:128
    v_mfma_f32_16x16x32_bf16 a[36:39], a[164:167], v[228:231], a[36:39]
    buffer_load_dwordx4 v[216:219], v11, s[12:15], s87 offen offset:0 sc1
    s_waitcnt vmcnt(6)
    v_mfma_f32_16x16x32_bf16 a[20:23], a[168:171], v[232:235], a[20:23]
    v_mfma_f32_16x16x32_bf16 a[24:27], a[172:175], v[232:235], a[24:27]
    v_mfma_f32_16x16x32_bf16 a[28:31], a[176:179], v[232:235], a[28:31]
    v_mfma_f32_16x16x32_bf16 a[32:35], a[180:183], v[232:235], a[32:35]
    v_mfma_f32_16x16x32_bf16 a[36:39], a[184:187], v[232:235], a[36:39]
    s_waitcnt vmcnt(5)
    v_mfma_f32_16x16x32_bf16 a[88:91], a[128:131], v[196:199], a[88:91]
    v_mfma_f32_16x16x32_bf16 a[92:95], a[132:135], v[196:199], a[92:95]
    v_mfma_f32_16x16x32_bf16 a[96:99], a[136:139], v[196:199], a[96:99]
    v_mfma_f32_16x16x32_bf16 a[100:103], a[140:143], v[196:199], a[100:103]
    ds_write_b128 v19, a[20:23] offset:0
    v_mfma_f32_16x16x32_bf16 a[104:107], a[144:147], v[196:199], a[104:107]
    ds_write_b128 v19, a[24:27] offset:32
    s_waitcnt vmcnt(4)
    v_mfma_f32_16x16x32_bf16 a[88:91], a[148:151], v[200:203], a[88:91]
    ds_write_b128 v19, a[28:31] offset:64
    v_mfma_f32_16x16x32_bf16 a[92:95], a[152:155], v[200:203], a[92:95]
    ds_write_b128 v19, a[32:35] offset:96
    v_mfma_f32_16x16x32_bf16 a[96:99], a[156:159], v[200:203], a[96:99]
    ds_write_b128 v19, a[36:39] offset:128
    v_mfma_f32_16x16x32_bf16 a[100:103], a[160:163], v[200:203], a[100:103]
    v_mfma_f32_16x16x32_bf16 a[104:107], a[164:167], v[200:203], a[104:107]
    s_waitcnt vmcnt(3)
    v_mfma_f32_16x16x32_bf16 a[88:91], a[168:171], v[204:207], a[88:91]
    v_mfma_f32_16x16x32_bf16 a[92:95], a[172:175], v[204:207], a[92:95]
    v_mfma_f32_16x16x32_bf16 a[96:99], a[176:179], v[204:207], a[96:99]
    v_mfma_f32_16x16x32_bf16 a[100:103], a[180:183], v[204:207], a[100:103]
    v_mfma_f32_16x16x32_bf16 a[104:107], a[184:187], v[204:207], a[104:107]
    s_waitcnt vmcnt(2)
    v_mfma_f32_16x16x32_bf16 a[108:111], a[128:131], v[208:211], a[108:111]
    v_mfma_f32_16x16x32_bf16 a[112:115], a[132:135], v[208:211], a[112:115]
    v_mfma_f32_16x16x32_bf16 a[116:119], a[136:139], v[208:211], a[116:119]
    v_mfma_f32_16x16x32_bf16 a[120:123], a[140:143], v[208:211], a[120:123]
    ds_write_b128 v20, a[88:91] offset:0
    v_mfma_f32_16x16x32_bf16 a[124:127], a[144:147], v[208:211], a[124:127]
    ds_write_b128 v20, a[92:95] offset:32
    s_waitcnt vmcnt(1)
    v_mfma_f32_16x16x32_bf16 a[108:111], a[148:151], v[212:215], a[108:111]
    ds_write_b128 v20, a[96:99] offset:64
    v_mfma_f32_16x16x32_bf16 a[112:115], a[152:155], v[212:215], a[112:115]
    ds_write_b128 v20, a[100:103] offset:96
    v_mfma_f32_16x16x32_bf16 a[116:119], a[156:159], v[212:215], a[116:119]
    ds_write_b128 v20, a[104:107] offset:128
    v_mfma_f32_16x16x32_bf16 a[120:123], a[160:163], v[212:215], a[120:123]
    v_mfma_f32_16x16x32_bf16 a[124:127], a[164:167], v[212:215], a[124:127]
    s_waitcnt vmcnt(0)
    v_mfma_f32_16x16x32_bf16 a[108:111], a[168:171], v[216:219], a[108:111]
    v_mfma_f32_16x16x32_bf16 a[112:115], a[172:175], v[216:219], a[112:115]
    s_waitcnt lgkmcnt(0)
    s_barrier
    v_mfma_f32_16x16x32_bf16 a[116:119], a[176:179], v[216:219], a[116:119]
    ds_read_b128 v[152:155], v15 offset:0
    ds_read_b128 v[156:159], v15 offset:160
    v_mfma_f32_16x16x32_bf16 a[120:123], a[180:183], v[216:219], a[120:123]
    ds_read_b128 v[32:35], v15 offset:5376
    ds_read_b128 v[36:39], v15 offset:5536
    v_mfma_f32_16x16x32_bf16 a[124:127], a[184:187], v[216:219], a[124:127]
    ds_read_b128 v[56:59], v15 offset:10752
    ds_read_b128 v[60:63], v15 offset:10912
    ds_read_b128 v[160:163], v16 offset:0
    ds_read_b128 v[164:167], v16 offset:160
    ds_read_b128 v[40:43], v16 offset:5376
    ds_read_b128 v[44:47], v16 offset:5536
    ds_read_b128 v[64:67], v16 offset:10752
    ds_read_b128 v[68:71], v16 offset:10912
    ds_read_b128 v[168:171], v17 offset:0
    ds_read_b128 v[172:175], v17 offset:160
    ds_read_b128 v[48:51], v17 offset:5376
    ds_read_b128 v[52:55], v17 offset:5536
    ds_read_b128 v[72:75], v17 offset:10752
    ds_read_b128 v[76:79], v17 offset:10912
    v_add_u32 v15, 98304, v15
    v_add_u32 v16, 98304, v16
    v_add_u32 v17, 98304, v17
    ds_write_b128 v21, a[108:111] offset:0
    ds_write_b128 v21, a[112:115] offset:32
    ds_write_b128 v21, a[116:119] offset:64
    ds_write_b128 v21, a[120:123] offset:96
    ds_write_b128 v21, a[124:127] offset:128
    ds_read_b128 v[196:199], v15 offset:0
    ds_read_b128 v[200:203], v15 offset:160
    ds_read_b128 v[204:207], v16 offset:0
    ds_read_b128 v[208:211], v16 offset:160
    ds_read_b128 v[212:215], v17 offset:0
    ds_read_b128 v[216:219], v17 offset:160
    s_waitcnt lgkmcnt(15)
    v_pk_add_f32 v[128:129], v[128:129], v[152:153]
    v_pk_add_f32 v[130:131], v[130:131], v[154:155]
    v_pk_add_f32 v[132:133], v[132:133], v[156:157]
    v_pk_add_f32 v[134:135], v[134:135], v[158:159]
    v_pk_add_f32 v[128:129], v[128:129], v[32:33]
    v_pk_add_f32 v[130:131], v[130:131], v[34:35]
    v_pk_add_f32 v[132:133], v[132:133], v[36:37]
    v_pk_add_f32 v[134:135], v[134:135], v[38:39]
    v_pk_add_f32 v[128:129], v[128:129], v[56:57]
    v_pk_add_f32 v[130:131], v[130:131], v[58:59]
    v_pk_add_f32 v[132:133], v[132:133], v[60:61]
    v_pk_add_f32 v[134:135], v[134:135], v[62:63]
    v_pk_add_f32 v[136:137], v[136:137], v[160:161]
    v_pk_add_f32 v[138:139], v[138:139], v[162:163]
    v_pk_add_f32 v[140:141], v[140:141], v[164:165]
    v_pk_add_f32 v[142:143], v[142:143], v[166:167]
    v_pk_add_f32 v[136:137], v[136:137], v[40:41]
    v_pk_add_f32 v[138:139], v[138:139], v[42:43]
    v_pk_add_f32 v[140:141], v[140:141], v[44:45]
    v_pk_add_f32 v[142:143], v[142:143], v[46:47]
    v_pk_add_f32 v[136:137], v[136:137], v[64:65]
    v_pk_add_f32 v[138:139], v[138:139], v[66:67]
    v_pk_add_f32 v[140:141], v[140:141], v[68:69]
    v_pk_add_f32 v[142:143], v[142:143], v[70:71]
    v_pk_add_f32 v[144:145], v[144:145], v[168:169]
    v_pk_add_f32 v[146:147], v[146:147], v[170:171]
    v_pk_add_f32 v[148:149], v[148:149], v[172:173]
    v_pk_add_f32 v[150:151], v[150:151], v[174:175]
    s_waitcnt lgkmcnt(14)
    v_pk_add_f32 v[144:145], v[144:145], v[48:49]
    v_pk_add_f32 v[146:147], v[146:147], v[50:51]
    s_waitcnt lgkmcnt(13)
    v_pk_add_f32 v[148:149], v[148:149], v[52:53]
    v_pk_add_f32 v[150:151], v[150:151], v[54:55]
    s_waitcnt lgkmcnt(12)
    v_pk_add_f32 v[144:145], v[144:145], v[72:73]
    v_pk_add_f32 v[146:147], v[146:147], v[74:75]
    s_waitcnt lgkmcnt(11)
    v_pk_add_f32 v[148:149], v[148:149], v[76:77]
    v_pk_add_f32 v[150:151], v[150:151], v[78:79]
    s_waitcnt lgkmcnt(5)
    v_pk_add_f32 v[128:129], v[128:129], v[196:197]
    v_pk_add_f32 v[130:131], v[130:131], v[198:199]
    s_waitcnt lgkmcnt(4)
    v_pk_add_f32 v[132:133], v[132:133], v[200:201]
    v_pk_add_f32 v[134:135], v[134:135], v[202:203]
    v_cvt_pk_bf16_f32 v128, v128, v129
    v_cvt_pk_bf16_f32 v129, v130, v131
    v_cvt_pk_bf16_f32 v130, v132, v133
    v_cvt_pk_bf16_f32 v131, v134, v135
    buffer_store_dwordx4 v[128:131], v12, s[20:23], s89 offen
    s_waitcnt lgkmcnt(3)
    v_pk_add_f32 v[136:137], v[136:137], v[204:205]
    v_pk_add_f32 v[138:139], v[138:139], v[206:207]
    s_waitcnt lgkmcnt(2)
    v_pk_add_f32 v[140:141], v[140:141], v[208:209]
    v_pk_add_f32 v[142:143], v[142:143], v[210:211]
    v_cvt_pk_bf16_f32 v136, v136, v137
    v_cvt_pk_bf16_f32 v137, v138, v139
    v_cvt_pk_bf16_f32 v138, v140, v141
    v_cvt_pk_bf16_f32 v139, v142, v143
    buffer_store_dwordx4 v[136:139], v13, s[20:23], s89 offen
    s_waitcnt lgkmcnt(1)
    v_pk_add_f32 v[144:145], v[144:145], v[212:213]
    v_pk_add_f32 v[146:147], v[146:147], v[214:215]
    s_waitcnt lgkmcnt(0)
    v_pk_add_f32 v[148:149], v[148:149], v[216:217]
    v_pk_add_f32 v[150:151], v[150:151], v[218:219]
    v_cvt_pk_bf16_f32 v144, v144, v145
    v_cvt_pk_bf16_f32 v145, v146, v147
    v_cvt_pk_bf16_f32 v146, v148, v149
    v_cvt_pk_bf16_f32 v147, v150, v151
    buffer_store_dwordx4 v[144:147], v14, s[20:23], s89 offen
    s_endpgm
.p2align 12
L_attn:
    s_mov_b32 s74, 0x3f803f80
    v_mov_b32 v44, 0
    v_mov_b32 v45, 0
    v_mov_b32 v46, 0
    v_mov_b32 v47, 0
    v_and_b32 v17, 31, v0
    v_lshrrev_b32 v18, 5, v0
    v_bfe_u32 v19, v0, 1, 3
    v_xor_b32 v19, v19, v18
    v_lshlrev_b32 v19, 4, v19
    v_lshl_add_u32 v19, v17, 7, v19
    v_xor_b32 v40, 0, v19
    v_add_u32 v40, s71, v40
    v_xor_b32 v41, 32, v19
    v_add_u32 v41, s71, v41
    v_xor_b32 v42, 64, v19
    v_add_u32 v42, s71, v42
    v_xor_b32 v43, 96, v19
    v_add_u32 v43, s71, v43
    v_bfe_u32 v19, v0, 4, 1
    v_mul_u32_u24 v19, 76800, v19
    v_and_b32 v20, 15, v0
    v_lshl_add_u32 v19, v20, 4, v19
    v_lshl_add_u32 v13, v18, 8, v19
    v_cmp_eq_u32 vcc, 0, v0
    v_lshlrev_b32 v1, 4, v0
    v_mov_b32 v30, 1073741824
    v_cndmask_b32 v30, v30, v0, vcc
    s_mov_b32 s12, s48
    s_mov_b32 s13, s49
    s_mov_b32 s14, 14680064
    s_mov_b32 s15, 0x20000
    s_mov_b32 s56, s48
    s_mov_b32 s57, s49
    s_mov_b32 s58, 14680064
    s_mov_b32 s59, 0x20000
    s_mov_b32 s20, s44
    s_mov_b32 s21, s45
    s_mov_b32 s22, 2621440
    s_mov_b32 s23, 0x20000
    s_mov_b32 s24, s46
    s_mov_b32 s25, s47
    s_mov_b32 s26, 256
    s_mov_b32 s27, 0x20000
    s_mov_b32 s75, 0xffff0000
    s_mov_b32 s76, 0x3fb8aa3b
    s_mov_b32 s77, 0x3f317218
    s_mov_b32 s78, 0x35c1a2a0
    s_and_b32 s67, s2, 7
    s_lshl_b32 s67, s67, 2
    s_bfe_u32 s81, s2, 0x20003
    s_add_u32 s67, s67, s81
    s_bfe_u32 s68, s2, 0x20005
    s_lshl_b32 s68, s68, 1
    s_and_b32 s81, s81, 1
    s_xor_b32 s81, s81, 0
    s_add_u32 s68, s68, s81
    s_mov_b32 s8, s34
    s_mov_b32 s9, s35
    s_mov_b32 s10, 2457600
    s_mov_b32 s11, 0x20000
    s_lshl_b32 s87, s64, 4
    s_and_b32 s88, s87, 32
    s_mul_i32 s88, s88, 3840
    s_movk_i32 s89, 3840
    v_add_u32 v14, 0, v0
    v_mul_u32_u24 v17, 205, v14
    v_lshrrev_b32 v17, 12, v17
    v_mul_u32_u24 v18, 20, v17
    v_sub_u32 v14, v14, v18
    v_cmp_le_u32 vcc, 10, v14
    v_lshlrev_b32 v14, 4, v14
    v_add_u32 v17, s87, v17
    v_mad_u32_u24 v14, v17, s89, v14
    v_add_u32 v17, 1120, v14
    v_add_u32 v18, 122720, v14
    v_cndmask_b32 v8, v14, v17, vcc
    v_cndmask_b32 v18, v14, v18, vcc
    v_subrev_u32 v18, s88, v18
    v_accvgpr_write_b32 a104, v18
    s_add_u32 m0, s71, 16384
    s_add_u32 s70, s70, 128
    s_sub_u32 s93, s70, 1280
    s_min_u32 s70, s70, s93
    s_add_u32 s1, s70, s0
    buffer_load_dwordx4 v32, s[4:7], s1 offen offset:0 lds
    buffer_load_dwordx4 v33, s[4:7], s1 offen offset:1024 lds
    buffer_load_dwordx4 v34, s[4:7], s1 offen offset:2048 lds
    buffer_load_dwordx4 v35, s[4:7], s1 offen offset:3072 lds
    v_add_u32 v14, 64, v0
    v_mul_u32_u24 v17, 205, v14
    v_lshrrev_b32 v17, 12, v17
    v_mul_u32_u24 v18, 20, v17
    v_sub_u32 v14, v14, v18
    v_cmp_le_u32 vcc, 10, v14
    v_lshlrev_b32 v14, 4, v14
    v_add_u32 v17, s87, v17
    v_mad_u32_u24 v14, v17, s89, v14
    v_subrev_u32 v14, 1024, v14
    v_add_u32 v17, 1120, v14
    v_add_u32 v18, 122720, v14
    v_cndmask_b32 v9, v14, v17, vcc
    v_cndmask_b32 v18, v14, v18, vcc
    v_subrev_u32 v18, s88, v18
    v_accvgpr_write_b32 a105, v18
    v_add_u32 v14, 128, v0
    v_mul_u32_u24 v17, 205, v14
    v_lshrrev_b32 v17, 12, v17
    v_mul_u32_u24 v18, 20, v17
    v_sub_u32 v14, v14, v18
    v_cmp_le_u32 vcc, 10, v14
    v_lshlrev_b32 v14, 4, v14
    v_add_u32 v17, s87, v17
    v_mad_u32_u24 v14, v17, s89, v14
    v_subrev_u32 v14, 2048, v14
    v_add_u32 v17, 1120, v14
    v_add_u32 v18, 122720, v14
    v_cndmask_b32 v10, v14, v17, vcc
    v_cndmask_b32 v18, v14, v18, vcc
    v_subrev_u32 v18, s88, v18
    v_accvgpr_write_b32 a106, v18
    v_add_u32 v14, 192, v0
    v_mul_u32_u24 v17, 205, v14
    v_lshrrev_b32 v17, 12, v17
    v_mul_u32_u24 v18, 20, v17
    v_sub_u32 v14, v14, v18
    v_cmp_le_u32 vcc, 10, v14
    v_lshlrev_b32 v14, 4, v14
    v_add_u32 v17, s87, v17
    v_mad_u32_u24 v14, v17, s89, v14
    v_subrev_u32 v14, 3072, v14
    v_add_u32 v17, 1120, v14
    v_add_u32 v18, 122720, v14
    v_cndmask_b32 v11, v14, v17, vcc
    v_cndmask_b32 v18, v14, v18, vcc
    v_subrev_u32 v18, s88, v18
    v_accvgpr_write_b32 a107, v18
    v_add_u32 v14, 256, v0
    v_mul_u32_u24 v17, 205, v14
    v_lshrrev_b32 v17, 12, v17
    v_mul_u32_u24 v18, 20, v17
    v_sub_u32 v14, v14, v18
    v_cmp_le_u32 vcc, 10, v14
    v_lshlrev_b32 v14, 4, v14
    v_add_u32 v17, s87, v17
    v_mad_u32_u24 v14, v17, s89, v14
    v_add_u32 v17, 1120, v14
    v_add_u32 v18, 122720, v14
    v_cndmask_b32 v12, v14, v17, vcc
    v_cndmask_b32 v18, v14, v18, vcc
    v_subrev_u32 v18, s88, v18
    v_accvgpr_write_b32 a108, v18
    s_mul_i32 s72, s92, 245760
    s_mul_i32 s87, s66, 160
    s_add_u32 s72, s72, s87
    s_lshl_b32 s88, s88, 1
    s_add_u32 s50, s72, s88
    s_sub_u32 s87, s50, 2457600
    s_min_u32 s50, s50, s87
    s_add_u32 s72, s72, 1280
    s_mul_i32 s73, s64, 5120
    s_lshl_b32 s80, s65, 2
    s_add_u32 s80, s80, s64
    s_mul_i32 s80, s80, 153600
    s_mul_i32 s42, s66, 2560
    s_add_u32 s42, s42, s80
    s_add_u32 s42, s42, 55296
    s_mul_i32 s43, s66, 2560
    s_add_u32 s43, s43, s80
    s_add_u32 s43, s43, 55296
    s_lshl_b32 s80, s65, 2
    s_and_b32 s81, s64, 2
    s_add_u32 s80, s80, s81
    s_lshl_b32 s80, s80, 1
    s_lshr_b32 s81, s66, 1
    s_add_u32 s80, s80, s81
    s_lshl_b32 s80, s80, 7
    s_add_u32 s45, s80, 13811712
    s_mul_i32 s80, s68, 5
    s_lshr_b32 s80, s80, 2
    s_mul_i32 s80, s80, 76
    s_lshl_b32 s81, s64, 3
    s_add_u32 s80, s80, s81
    s_lshl_b32 s81, s64, 1
    s_sub_u32 s81, 24, s81
    s_sub_u32 s82, 18, s64
    v_lshrrev_b32 v14, 1, v0
    v_min_u32 v14, 18, v14
    v_mov_b32 v15, s81
    v_cmp_le_u32 vcc, 8, v14
    v_mov_b32 v16, s82
    s_nop 0
    v_cndmask_b32 v15, 0, v15, vcc
    v_cmp_le_u32 vcc, 14, v14
    v_add3_u32 v14, v14, v15, s80
    v_and_b32 v15, 1, v0
    v_cndmask_b32 v16, 0, v16, vcc
    v_mul_u32_u24 v15, 76, v15
    v_add3_u32 v14, v14, v15, v16
    v_mul_u32_u24 v15, 10923, v14
    v_lshrrev_b32 v15, 16, v15
    v_lshl_add_u32 v14, v15, 1, v14
    v_and_b32 v14, 3, v14
    v_lshl_add_u32 v14, v15, 5, v14
    v_lshlrev_b32 v14, 2, v14
    v_add_u32 v14, 13729792, v14
    v_accvgpr_write_b32 a111, v14
    s_mul_i32 s49, s68, 389120
    s_mul_i32 s80, s64, 40960
    s_add_u32 s49, s49, s80
    s_add_u32 s49, s49, 10485760
    s_lshl_b32 s80, s66, 2
    s_add_u32 s80, s80, s64
    s_mul_i32 s48, s80, 3072
    s_add_u32 s48, s48, 13631488
    s_lshl_b32 s80, s80, 7
    s_add_u32 s47, s80, 13746176
    v_lshrrev_b32 v17, 5, v0
    v_and_b32 v18, 31, v0
    v_mul_u32_u24 v14, 2624, v17
    v_lshl_add_u32 v19, v18, 4, v14
    s_mul_i32 s80, s64, 10496
    s_add_u32 s80, s80, 102400
    v_add_u32 v5, s80, v19
    s_mul_i32 s81, s64, 320
    s_add_u32 s81, s81, 102400
    v_add_u32 v6, s81, v19
    v_add_u32 v7, 1280, v6
    v_add_u32 v19, 104960, v14
    v_cmp_gt_u32 vcc, 20, v18
    s_add_u32 m0, s71, 32768
    s_add_u32 s70, s70, 128
    s_sub_u32 s93, s70, 1280
    s_min_u32 s70, s70, s93
    s_add_u32 s1, s70, s0
    buffer_load_dwordx4 v32, s[4:7], s1 offen offset:0 lds
    buffer_load_dwordx4 v33, s[4:7], s1 offen offset:1024 lds
    buffer_load_dwordx4 v34, s[4:7], s1 offen offset:2048 lds
    buffer_load_dwordx4 v35, s[4:7], s1 offen offset:3072 lds
    s_waitcnt vmcnt(8)
    ds_read_b128 v[96:99], v40 offset:0
    ds_read_b128 v[100:103], v41 offset:0
    ds_read_b128 v[104:107], v42 offset:0
    ds_read_b128 v[108:111], v43 offset:0
    v_cmp_gt_u32 s[94:95], 16, v18
    v_lshlrev_b32 v26, 2, v18
    v_cndmask_b32 v7, v19, v7, vcc
    v_lshl_add_u32 v26, v17, 9, v26
    v_mov_b32 v15, 1073741824
    v_cndmask_b32 v26, v15, v26, vcc
    v_cmp_gt_u32 vcc, 20, v0
    v_and_b32 v28, 3, v0
    v_mul_u32_u24 v28, 2624, v28
    v_cndmask_b32 v27, v15, v26, vcc
    v_add_u32 v28, s80, v28
    s_mul_i32 s81, s64, 1728
    s_add_u32 s81, s81, 0
    s_waitcnt lgkmcnt(3)
    v_dot2c_f32_bf16 v44, s74, v96
    v_dot2c_f32_bf16 v46, v96, v96
    v_dot2c_f32_bf16 v45, s74, v97
    v_dot2c_f32_bf16 v47, v97, v97
    v_dot2c_f32_bf16 v44, s74, v98
    v_dot2c_f32_bf16 v46, v98, v98
    v_dot2c_f32_bf16 v45, s74, v99
    v_dot2c_f32_bf16 v47, v99, v99
    s_waitcnt lgkmcnt(2)
    v_dot2c_f32_bf16 v44, s74, v100
    v_dot2c_f32_bf16 v46, v100, v100
    v_dot2c_f32_bf16 v45, s74, v101
    v_dot2c_f32_bf16 v47, v101, v101
    v_dot2c_f32_bf16 v44, s74, v102
    v_dot2c_f32_bf16 v46, v102, v102
    v_dot2c_f32_bf16 v45, s74, v103
    v_dot2c_f32_bf16 v47, v103, v103
    s_waitcnt lgkmcnt(1)
    v_dot2c_f32_bf16 v44, s74, v104
    v_dot2c_f32_bf16 v46, v104, v104
    v_dot2c_f32_bf16 v45, s74, v105
    v_dot2c_f32_bf16 v47, v105, v105
    v_dot2c_f32_bf16 v44, s74, v106
    v_dot2c_f32_bf16 v46, v106, v106
    v_dot2c_f32_bf16 v45, s74, v107
    v_dot2c_f32_bf16 v47, v107, v107
    s_waitcnt lgkmcnt(0)
    v_dot2c_f32_bf16 v44, s74, v108
    v_dot2c_f32_bf16 v46, v108, v108
    v_dot2c_f32_bf16 v45, s74, v109
    v_dot2c_f32_bf16 v47, v109, v109
    v_dot2c_f32_bf16 v44, s74, v110
    v_dot2c_f32_bf16 v46, v110, v110
    v_dot2c_f32_bf16 v45, s74, v111
    v_dot2c_f32_bf16 v47, v111, v111
    s_add_u32 m0, s71, 49152
    s_add_u32 s70, s70, 128
    s_sub_u32 s93, s70, 1280
    s_min_u32 s70, s70, s93
    s_add_u32 s1, s70, s0
    buffer_load_dwordx4 v32, s[4:7], s1 offen offset:0 lds
    buffer_load_dwordx4 v33, s[4:7], s1 offen offset:1024 lds
    buffer_load_dwordx4 v34, s[4:7], s1 offen offset:2048 lds
    buffer_load_dwordx4 v35, s[4:7], s1 offen offset:3072 lds
    s_waitcnt vmcnt(8)
    ds_read_b128 v[112:115], v40 offset:16384
    ds_read_b128 v[116:119], v41 offset:16384
    ds_read_b128 v[120:123], v42 offset:16384
    ds_read_b128 v[124:127], v43 offset:16384
    v_lshrrev_b32 v14, 3, v0
    v_add_u32 v14, v14, v0
    v_lshl_add_u32 v14, v14, 3, s81
    v_accvgpr_write_b32 a254, v14
    v_bfe_u32 v15, v0, 3, 2
    v_and_b32 v16, 3, v0
    v_lshl_add_u32 v15, v15, 2, v16
    v_bfe_u32 v16, v0, 2, 1
    v_and_b32 v17, 14, v15
    v_lshl_add_u32 v16, v16, 1, v15
    v_add_u32 v16, v16, v17
    v_cmp_gt_u32 vcc, 10, v15
    v_lshrrev_b32 v15, 5, v0
    s_waitcnt lgkmcnt(3)
    v_dot2c_f32_bf16 v44, s74, v112
    v_dot2c_f32_bf16 v46, v112, v112
    v_dot2c_f32_bf16 v45, s74, v113
    v_dot2c_f32_bf16 v47, v113, v113
    v_dot2c_f32_bf16 v44, s74, v114
    v_dot2c_f32_bf16 v46, v114, v114
    v_dot2c_f32_bf16 v45, s74, v115
    v_dot2c_f32_bf16 v47, v115, v115
    s_waitcnt lgkmcnt(2)
    v_dot2c_f32_bf16 v44, s74, v116
    v_dot2c_f32_bf16 v46, v116, v116
    v_dot2c_f32_bf16 v45, s74, v117
    v_dot2c_f32_bf16 v47, v117, v117
    v_dot2c_f32_bf16 v44, s74, v118
    v_dot2c_f32_bf16 v46, v118, v118
    v_dot2c_f32_bf16 v45, s74, v119
    v_dot2c_f32_bf16 v47, v119, v119
    s_waitcnt lgkmcnt(1)
    v_dot2c_f32_bf16 v44, s74, v120
    v_dot2c_f32_bf16 v46, v120, v120
    v_dot2c_f32_bf16 v45, s74, v121
    v_dot2c_f32_bf16 v47, v121, v121
    v_dot2c_f32_bf16 v44, s74, v122
    v_dot2c_f32_bf16 v46, v122, v122
    v_dot2c_f32_bf16 v45, s74, v123
    v_dot2c_f32_bf16 v47, v123, v123
    s_waitcnt lgkmcnt(0)
    v_dot2c_f32_bf16 v44, s74, v124
    v_dot2c_f32_bf16 v46, v124, v124
    v_dot2c_f32_bf16 v45, s74, v125
    v_dot2c_f32_bf16 v47, v125, v125
    v_dot2c_f32_bf16 v44, s74, v126
    v_dot2c_f32_bf16 v46, v126, v126
    v_dot2c_f32_bf16 v45, s74, v127
    v_dot2c_f32_bf16 v47, v127, v127
    s_add_u32 m0, s71, 0
    s_add_u32 s70, s70, 128
    s_sub_u32 s93, s70, 1280
    s_min_u32 s70, s70, s93
    s_add_u32 s1, s70, s0
    buffer_load_dwordx4 v32, s[4:7], s1 offen offset:0 lds
    buffer_load_dwordx4 v33, s[4:7], s1 offen offset:1024 lds
    buffer_load_dwordx4 v34, s[4:7], s1 offen offset:2048 lds
    buffer_load_dwordx4 v35, s[4:7], s1 offen offset:3072 lds
    s_waitcnt vmcnt(8)
    ds_read_b128 v[128:131], v40 offset:32768
    ds_read_b128 v[132:135], v41 offset:32768
    ds_read_b128 v[136:139], v42 offset:32768
    ds_read_b128 v[140:143], v43 offset:32768
    v_lshlrev_b32 v15, 3, v15
    v_cndmask_b32 v16, 20, v16, vcc
    v_mul_u32_u24 v16, 72, v16
    v_add_u32 v17, v16, v15
    v_accvgpr_write_b32 a255, v17
    v_mul_u32_u24 v15, 5, v15
    v_sub_u32 v16, v16, v15
    v_add_u32 v16, 40, v16
    v_accvgpr_write_b32 a253, v16
    v_lshrrev_b32 v14, 5, v0
    v_bfe_u32 v15, v0, 2, 2
    v_lshl_add_u32 v14, v14, 3, v15
    v_mul_u32_u24 v14, 320, v14
    s_waitcnt lgkmcnt(3)
    v_dot2c_f32_bf16 v44, s74, v128
    v_dot2c_f32_bf16 v46, v128, v128
    v_dot2c_f32_bf16 v45, s74, v129
    v_dot2c_f32_bf16 v47, v129, v129
    v_dot2c_f32_bf16 v44, s74, v130
    v_dot2c_f32_bf16 v46, v130, v130
    v_dot2c_f32_bf16 v45, s74, v131
    v_dot2c_f32_bf16 v47, v131, v131
    s_waitcnt lgkmcnt(2)
    v_dot2c_f32_bf16 v44, s74, v132
    v_dot2c_f32_bf16 v46, v132, v132
    v_dot2c_f32_bf16 v45, s74, v133
    v_dot2c_f32_bf16 v47, v133, v133
    v_dot2c_f32_bf16 v44, s74, v134
    v_dot2c_f32_bf16 v46, v134, v134
    v_dot2c_f32_bf16 v45, s74, v135
    v_dot2c_f32_bf16 v47, v135, v135
    s_waitcnt lgkmcnt(1)
    v_dot2c_f32_bf16 v44, s74, v136
    v_dot2c_f32_bf16 v46, v136, v136
    v_dot2c_f32_bf16 v45, s74, v137
    v_dot2c_f32_bf16 v47, v137, v137
    v_dot2c_f32_bf16 v44, s74, v138
    v_dot2c_f32_bf16 v46, v138, v138
    v_dot2c_f32_bf16 v45, s74, v139
    v_dot2c_f32_bf16 v47, v139, v139
    s_waitcnt lgkmcnt(0)
    v_dot2c_f32_bf16 v44, s74, v140
    v_dot2c_f32_bf16 v46, v140, v140
    v_dot2c_f32_bf16 v45, s74, v141
    v_dot2c_f32_bf16 v47, v141, v141
    v_dot2c_f32_bf16 v44, s74, v142
    v_dot2c_f32_bf16 v46, v142, v142
    v_dot2c_f32_bf16 v45, s74, v143
    v_dot2c_f32_bf16 v47, v143, v143
    s_add_u32 m0, s71, 16384
    s_add_u32 s70, s70, 128
    s_sub_u32 s93, s70, 1280
    s_min_u32 s70, s70, s93
    s_add_u32 s1, s70, s0
    buffer_load_dwordx4 v32, s[4:7], s1 offen offset:0 lds
    buffer_load_dwordx4 v33, s[4:7], s1 offen offset:1024 lds
    buffer_load_dwordx4 v34, s[4:7], s1 offen offset:2048 lds
    buffer_load_dwordx4 v35, s[4:7], s1 offen offset:3072 lds
    s_waitcnt vmcnt(8)
    ds_read_b128 v[144:147], v40 offset:49152
    ds_read_b128 v[148:151], v41 offset:49152
    ds_read_b128 v[152:155], v42 offset:49152
    ds_read_b128 v[156:159], v43 offset:49152
    v_bfe_u32 v16, v0, 4, 1
    v_lshl_add_u32 v14, v16, 5, v14
    v_and_b32 v16, 3, v0
    v_lshl_add_u32 v4, v16, 3, v14
    s_mul_i32 s80, s64, 8192
    s_mul_i32 s81, s64, 8192
    s_add_u32 s81, s81, 4096
    s_mul_i32 s82, s64, 8192
    s_add_u32 s82, s82, 2048
    s_mul_i32 s83, s64, 8192
    s_add_u32 s83, s83, 6144
    s_mul_i32 s84, s64, 6144
    s_waitcnt lgkmcnt(3)
    v_dot2c_f32_bf16 v44, s74, v144
    v_dot2c_f32_bf16 v46, v144, v144
    v_dot2c_f32_bf16 v45, s74, v145
    v_dot2c_f32_bf16 v47, v145, v145
    v_dot2c_f32_bf16 v44, s74, v146
    v_dot2c_f32_bf16 v46, v146, v146
    v_dot2c_f32_bf16 v45, s74, v147
    v_dot2c_f32_bf16 v47, v147, v147
    s_waitcnt lgkmcnt(2)
    v_dot2c_f32_bf16 v44, s74, v148
    v_dot2c_f32_bf16 v46, v148, v148
    v_dot2c_f32_bf16 v45, s74, v149
    v_dot2c_f32_bf16 v47, v149, v149
    v_dot2c_f32_bf16 v44, s74, v150
    v_dot2c_f32_bf16 v46, v150, v150
    v_dot2c_f32_bf16 v45, s74, v151
    v_dot2c_f32_bf16 v47, v151, v151
    s_waitcnt lgkmcnt(1)
    v_dot2c_f32_bf16 v44, s74, v152
    v_dot2c_f32_bf16 v46, v152, v152
    v_dot2c_f32_bf16 v45, s74, v153
    v_dot2c_f32_bf16 v47, v153, v153
    v_dot2c_f32_bf16 v44, s74, v154
    v_dot2c_f32_bf16 v46, v154, v154
    v_dot2c_f32_bf16 v45, s74, v155
    v_dot2c_f32_bf16 v47, v155, v155
    s_waitcnt lgkmcnt(0)
    v_dot2c_f32_bf16 v44, s74, v156
    v_dot2c_f32_bf16 v46, v156, v156
    v_dot2c_f32_bf16 v45, s74, v157
    v_dot2c_f32_bf16 v47, v157, v157
    v_dot2c_f32_bf16 v44, s74, v158
    v_dot2c_f32_bf16 v46, v158, v158
    v_dot2c_f32_bf16 v45, s74, v159
    v_dot2c_f32_bf16 v47, v159, v159
    s_add_u32 m0, s71, 32768
    s_add_u32 s70, s70, 128
    s_sub_u32 s93, s70, 1280
    s_min_u32 s70, s70, s93
    s_add_u32 s1, s70, s0
    buffer_load_dwordx4 v32, s[4:7], s1 offen offset:0 lds
    buffer_load_dwordx4 v33, s[4:7], s1 offen offset:1024 lds
    buffer_load_dwordx4 v34, s[4:7], s1 offen offset:2048 lds
    buffer_load_dwordx4 v35, s[4:7], s1 offen offset:3072 lds
    s_waitcnt vmcnt(8)
    ds_read_b128 v[160:163], v40 offset:0
    ds_read_b128 v[164:167], v41 offset:0
    ds_read_b128 v[168:171], v42 offset:0
    ds_read_b128 v[172:175], v43 offset:0
    s_add_u32 s84, s84, 32768
    s_mul_i32 s85, s64, 6144
    s_add_u32 s85, s85, 36864
    s_mul_i32 s86, s64, 5120
    s_add_u32 s86, s86, 55296
    s_mul_i32 s87, s64, 5120
    s_add_u32 s87, s87, 59392
    s_cmp_eq_u32 s64, 3
    s_cselect_b32 s85, 1073741824, s85
    s_cselect_b32 s58, 0, s14
    s_mul_i32 s28, s64, -10240
    s_add_u32 s28, s28, 122880
    s_waitcnt lgkmcnt(3)
    v_dot2c_f32_bf16 v44, s74, v160
    v_dot2c_f32_bf16 v46, v160, v160
    v_dot2c_f32_bf16 v45, s74, v161
    v_dot2c_f32_bf16 v47, v161, v161
    v_dot2c_f32_bf16 v44, s74, v162
    v_dot2c_f32_bf16 v46, v162, v162
    v_dot2c_f32_bf16 v45, s74, v163
    v_dot2c_f32_bf16 v47, v163, v163
    s_waitcnt lgkmcnt(2)
    v_dot2c_f32_bf16 v44, s74, v164
    v_dot2c_f32_bf16 v46, v164, v164
    v_dot2c_f32_bf16 v45, s74, v165
    v_dot2c_f32_bf16 v47, v165, v165
    v_dot2c_f32_bf16 v44, s74, v166
    v_dot2c_f32_bf16 v46, v166, v166
    v_dot2c_f32_bf16 v45, s74, v167
    v_dot2c_f32_bf16 v47, v167, v167
    s_waitcnt lgkmcnt(1)
    v_dot2c_f32_bf16 v44, s74, v168
    v_dot2c_f32_bf16 v46, v168, v168
    v_dot2c_f32_bf16 v45, s74, v169
    v_dot2c_f32_bf16 v47, v169, v169
    v_dot2c_f32_bf16 v44, s74, v170
    v_dot2c_f32_bf16 v46, v170, v170
    v_dot2c_f32_bf16 v45, s74, v171
    v_dot2c_f32_bf16 v47, v171, v171
    s_waitcnt lgkmcnt(0)
    v_dot2c_f32_bf16 v44, s74, v172
    v_dot2c_f32_bf16 v46, v172, v172
    v_dot2c_f32_bf16 v45, s74, v173
    v_dot2c_f32_bf16 v47, v173, v173
    v_dot2c_f32_bf16 v44, s74, v174
    v_dot2c_f32_bf16 v46, v174, v174
    v_dot2c_f32_bf16 v45, s74, v175
    v_dot2c_f32_bf16 v47, v175, v175
    s_add_u32 m0, s71, 49152
    s_add_u32 s70, s70, 128
    s_sub_u32 s93, s70, 1280
    s_min_u32 s70, s70, s93
    s_add_u32 s1, s70, s0
    buffer_load_dwordx4 v32, s[4:7], s1 offen offset:0 lds
    buffer_load_dwordx4 v33, s[4:7], s1 offen offset:1024 lds
    buffer_load_dwordx4 v34, s[4:7], s1 offen offset:2048 lds
    buffer_load_dwordx4 v35, s[4:7], s1 offen offset:3072 lds
    s_waitcnt vmcnt(8)
    ds_read_b128 v[176:179], v40 offset:16384
    ds_read_b128 v[180:183], v41 offset:16384
    ds_read_b128 v[184:187], v42 offset:16384
    ds_read_b128 v[188:191], v43 offset:16384
    s_mul_i32 s29, s64, -5120
    s_add_u32 s29, s29, 92160
    s_lshl_b32 s89, s67, 2
    s_add_u32 s89, s89, s64
    s_mul_i32 s89, s89, 20480
    s_mul_i32 s90, s68, 160
    s_add_u32 s89, s89, s90
    s_lshl_b32 s88, s67, 2
    s_add_u32 s88, s88, s64
    s_lshl_b32 s88, s88, 7
    s_add_u32 s88, s88, 13762560
    s_lshl_b32 s91, s67, 2
    s_waitcnt lgkmcnt(3)
    v_dot2c_f32_bf16 v44, s74, v176
    v_dot2c_f32_bf16 v46, v176, v176
    v_dot2c_f32_bf16 v45, s74, v177
    v_dot2c_f32_bf16 v47, v177, v177
    v_dot2c_f32_bf16 v44, s74, v178
    v_dot2c_f32_bf16 v46, v178, v178
    v_dot2c_f32_bf16 v45, s74, v179
    v_dot2c_f32_bf16 v47, v179, v179
    s_waitcnt lgkmcnt(2)
    v_dot2c_f32_bf16 v44, s74, v180
    v_dot2c_f32_bf16 v46, v180, v180
    v_dot2c_f32_bf16 v45, s74, v181
    v_dot2c_f32_bf16 v47, v181, v181
    v_dot2c_f32_bf16 v44, s74, v182
    v_dot2c_f32_bf16 v46, v182, v182
    v_dot2c_f32_bf16 v45, s74, v183
    v_dot2c_f32_bf16 v47, v183, v183
    s_waitcnt lgkmcnt(1)
    v_dot2c_f32_bf16 v44, s74, v184
    v_dot2c_f32_bf16 v46, v184, v184
    v_dot2c_f32_bf16 v45, s74, v185
    v_dot2c_f32_bf16 v47, v185, v185
    v_dot2c_f32_bf16 v44, s74, v186
    v_dot2c_f32_bf16 v46, v186, v186
    v_dot2c_f32_bf16 v45, s74, v187
    v_dot2c_f32_bf16 v47, v187, v187
    s_waitcnt lgkmcnt(0)
    v_dot2c_f32_bf16 v44, s74, v188
    v_dot2c_f32_bf16 v46, v188, v188
    v_dot2c_f32_bf16 v45, s74, v189
    v_dot2c_f32_bf16 v47, v189, v189
    v_dot2c_f32_bf16 v44, s74, v190
    v_dot2c_f32_bf16 v46, v190, v190
    v_dot2c_f32_bf16 v45, s74, v191
    v_dot2c_f32_bf16 v47, v191, v191
    s_add_u32 m0, s71, 0
    s_add_u32 s70, s70, 128
    s_sub_u32 s93, s70, 1280
    s_min_u32 s70, s70, s93
    s_add_u32 s1, s70, s0
    buffer_load_dwordx4 v32, s[4:7], s1 offen offset:0 lds
    buffer_load_dwordx4 v33, s[4:7], s1 offen offset:1024 lds
    buffer_load_dwordx4 v34, s[4:7], s1 offen offset:2048 lds
    buffer_load_dwordx4 v35, s[4:7], s1 offen offset:3072 lds
    s_waitcnt vmcnt(8)
    ds_read_b128 v[192:195], v40 offset:32768
    ds_read_b128 v[196:199], v41 offset:32768
    ds_read_b128 v[200:203], v42 offset:32768
    ds_read_b128 v[204:207], v43 offset:32768
    s_add_u32 s90, s64, 1
    s_and_b32 s90, s90, 3
    s_add_u32 s90, s90, s91
    s_mul_i32 s90, s90, 76800
    v_add_u32 v14, s90, v1
    v_accvgpr_write_b32 a248, v14
    s_add_u32 s90, s64, 2
    s_and_b32 s90, s90, 3
    s_add_u32 s90, s90, s91
    s_mul_i32 s90, s90, 76800
    v_add_u32 v14, s90, v1
    v_accvgpr_write_b32 a249, v14
    s_waitcnt lgkmcnt(3)
    v_dot2c_f32_bf16 v44, s74, v192
    v_dot2c_f32_bf16 v46, v192, v192
    v_dot2c_f32_bf16 v45, s74, v193
    v_dot2c_f32_bf16 v47, v193, v193
    v_dot2c_f32_bf16 v44, s74, v194
    v_dot2c_f32_bf16 v46, v194, v194
    v_dot2c_f32_bf16 v45, s74, v195
    v_dot2c_f32_bf16 v47, v195, v195
    s_waitcnt lgkmcnt(2)
    v_dot2c_f32_bf16 v44, s74, v196
    v_dot2c_f32_bf16 v46, v196, v196
    v_dot2c_f32_bf16 v45, s74, v197
    v_dot2c_f32_bf16 v47, v197, v197
    v_dot2c_f32_bf16 v44, s74, v198
    v_dot2c_f32_bf16 v46, v198, v198
    v_dot2c_f32_bf16 v45, s74, v199
    v_dot2c_f32_bf16 v47, v199, v199
    s_waitcnt lgkmcnt(1)
    v_dot2c_f32_bf16 v44, s74, v200
    v_dot2c_f32_bf16 v46, v200, v200
    v_dot2c_f32_bf16 v45, s74, v201
    v_dot2c_f32_bf16 v47, v201, v201
    v_dot2c_f32_bf16 v44, s74, v202
    v_dot2c_f32_bf16 v46, v202, v202
    v_dot2c_f32_bf16 v45, s74, v203
    v_dot2c_f32_bf16 v47, v203, v203
    s_waitcnt lgkmcnt(0)
    v_dot2c_f32_bf16 v44, s74, v204
    v_dot2c_f32_bf16 v46, v204, v204
    v_dot2c_f32_bf16 v45, s74, v205
    v_dot2c_f32_bf16 v47, v205, v205
    v_dot2c_f32_bf16 v44, s74, v206
    v_dot2c_f32_bf16 v46, v206, v206
    v_dot2c_f32_bf16 v45, s74, v207
    v_dot2c_f32_bf16 v47, v207, v207
    s_add_u32 m0, s71, 16384
    s_add_u32 s70, s70, 128
    s_sub_u32 s93, s70, 1280
    s_min_u32 s70, s70, s93
    s_add_u32 s1, s70, s0
    buffer_load_dwordx4 v32, s[4:7], s1 offen offset:0 lds
    buffer_load_dwordx4 v33, s[4:7], s1 offen offset:1024 lds
    buffer_load_dwordx4 v34, s[4:7], s1 offen offset:2048 lds
    buffer_load_dwordx4 v35, s[4:7], s1 offen offset:3072 lds
    s_waitcnt vmcnt(8)
    ds_read_b128 v[208:211], v40 offset:49152
    ds_read_b128 v[212:215], v41 offset:49152
    ds_read_b128 v[216:219], v42 offset:49152
    ds_read_b128 v[220:223], v43 offset:49152
    s_add_u32 s90, s64, 3
    s_and_b32 s90, s90, 3
    s_add_u32 s90, s90, s91
    s_mul_i32 s90, s90, 76800
    v_add_u32 v14, s90, v1
    v_accvgpr_write_b32 a250, v14
    s_add_u32 s90, s64, 4
    s_and_b32 s90, s90, 3
    s_add_u32 s90, s90, s91
    s_mul_i32 s90, s90, 76800
    v_add_u32 v14, s90, v1
    v_accvgpr_write_b32 a251, v14
    s_waitcnt lgkmcnt(3)
    v_dot2c_f32_bf16 v44, s74, v208
    v_dot2c_f32_bf16 v46, v208, v208
    v_dot2c_f32_bf16 v45, s74, v209
    v_dot2c_f32_bf16 v47, v209, v209
    v_dot2c_f32_bf16 v44, s74, v210
    v_dot2c_f32_bf16 v46, v210, v210
    v_dot2c_f32_bf16 v45, s74, v211
    v_dot2c_f32_bf16 v47, v211, v211
    s_waitcnt lgkmcnt(2)
    v_dot2c_f32_bf16 v44, s74, v212
    v_dot2c_f32_bf16 v46, v212, v212
    v_dot2c_f32_bf16 v45, s74, v213
    v_dot2c_f32_bf16 v47, v213, v213
    v_dot2c_f32_bf16 v44, s74, v214
    v_dot2c_f32_bf16 v46, v214, v214
    v_dot2c_f32_bf16 v45, s74, v215
    v_dot2c_f32_bf16 v47, v215, v215
    s_waitcnt lgkmcnt(1)
    v_dot2c_f32_bf16 v44, s74, v216
    v_dot2c_f32_bf16 v46, v216, v216
    v_dot2c_f32_bf16 v45, s74, v217
    v_dot2c_f32_bf16 v47, v217, v217
    v_dot2c_f32_bf16 v44, s74, v218
    v_dot2c_f32_bf16 v46, v218, v218
    v_dot2c_f32_bf16 v45, s74, v219
    v_dot2c_f32_bf16 v47, v219, v219
    s_waitcnt lgkmcnt(0)
    v_dot2c_f32_bf16 v44, s74, v220
    v_dot2c_f32_bf16 v46, v220, v220
    v_dot2c_f32_bf16 v45, s74, v221
    v_dot2c_f32_bf16 v47, v221, v221
    v_dot2c_f32_bf16 v44, s74, v222
    v_dot2c_f32_bf16 v46, v222, v222
    v_dot2c_f32_bf16 v45, s74, v223
    v_dot2c_f32_bf16 v47, v223, v223
    s_add_u32 m0, s73, 0
    s_nop 0
    buffer_load_dwordx4 v8, s[8:11], s72 offen offset:0 lds
    buffer_load_dwordx4 v9, s[8:11], s72 offen offset:1024 lds
    buffer_load_dwordx4 v10, s[8:11], s72 offen offset:2048 lds
    s_waitcnt vmcnt(7)
    ds_read_b128 v[224:227], v40 offset:0
    ds_read_b128 v[228:231], v41 offset:0
    ds_read_b128 v[232:235], v42 offset:0
    ds_read_b128 v[236:239], v43 offset:0
    s_waitcnt lgkmcnt(3)
    v_dot2c_f32_bf16 v44, s74, v224
    v_dot2c_f32_bf16 v46, v224, v224
    v_dot2c_f32_bf16 v45, s74, v225
    v_dot2c_f32_bf16 v47, v225, v225
    v_dot2c_f32_bf16 v44, s74, v226
    v_dot2c_f32_bf16 v46, v226, v226
    v_dot2c_f32_bf16 v45, s74, v227
    v_dot2c_f32_bf16 v47, v227, v227
    s_waitcnt lgkmcnt(2)
    v_dot2c_f32_bf16 v44, s74, v228
    v_dot2c_f32_bf16 v46, v228, v228
    v_dot2c_f32_bf16 v45, s74, v229
    v_dot2c_f32_bf16 v47, v229, v229
    v_dot2c_f32_bf16 v44, s74, v230
    v_dot2c_f32_bf16 v46, v230, v230
    v_dot2c_f32_bf16 v45, s74, v231
    v_dot2c_f32_bf16 v47, v231, v231
    s_waitcnt lgkmcnt(1)
    v_dot2c_f32_bf16 v44, s74, v232
    v_dot2c_f32_bf16 v46, v232, v232
    v_dot2c_f32_bf16 v45, s74, v233
    v_dot2c_f32_bf16 v47, v233, v233
    v_dot2c_f32_bf16 v44, s74, v234
    v_dot2c_f32_bf16 v46, v234, v234
    v_dot2c_f32_bf16 v45, s74, v235
    v_dot2c_f32_bf16 v47, v235, v235
    s_waitcnt lgkmcnt(0)
    v_dot2c_f32_bf16 v44, s74, v236
    v_dot2c_f32_bf16 v46, v236, v236
    v_dot2c_f32_bf16 v45, s74, v237
    v_dot2c_f32_bf16 v47, v237, v237
    v_dot2c_f32_bf16 v44, s74, v238
    v_dot2c_f32_bf16 v46, v238, v238
    v_dot2c_f32_bf16 v45, s74, v239
    v_dot2c_f32_bf16 v47, v239, v239
    buffer_load_dwordx4 v11, s[8:11], s72 offen offset:3072 lds
    s_add_u32 m0, s73, 4096
    s_nop 0
    buffer_load_dwordx4 v12, s[8:11], s72 offen offset:0 lds
    s_waitcnt vmcnt(5)
    ds_read_b128 v[240:243], v40 offset:16384
    ds_read_b128 v[244:247], v41 offset:16384
    ds_read_b128 v[248:251], v42 offset:16384
    ds_read_b128 v[252:255], v43 offset:16384
    s_waitcnt lgkmcnt(3)
    v_dot2c_f32_bf16 v44, s74, v240
    v_dot2c_f32_bf16 v46, v240, v240
    v_dot2c_f32_bf16 v45, s74, v241
    v_dot2c_f32_bf16 v47, v241, v241
    v_dot2c_f32_bf16 v44, s74, v242
    v_dot2c_f32_bf16 v46, v242, v242
    v_dot2c_f32_bf16 v45, s74, v243
    v_dot2c_f32_bf16 v47, v243, v243
    s_waitcnt lgkmcnt(2)
    v_dot2c_f32_bf16 v44, s74, v244
    v_dot2c_f32_bf16 v46, v244, v244
    v_dot2c_f32_bf16 v45, s74, v245
    v_dot2c_f32_bf16 v47, v245, v245
    v_dot2c_f32_bf16 v44, s74, v246
    v_dot2c_f32_bf16 v46, v246, v246
    v_dot2c_f32_bf16 v45, s74, v247
    v_dot2c_f32_bf16 v47, v247, v247
    s_waitcnt lgkmcnt(1)
    v_dot2c_f32_bf16 v44, s74, v248
    v_dot2c_f32_bf16 v46, v248, v248
    v_dot2c_f32_bf16 v45, s74, v249
    v_dot2c_f32_bf16 v47, v249, v249
    v_dot2c_f32_bf16 v44, s74, v250
    v_dot2c_f32_bf16 v46, v250, v250
    v_dot2c_f32_bf16 v45, s74, v251
    v_dot2c_f32_bf16 v47, v251, v251
    s_waitcnt lgkmcnt(0)
    v_dot2c_f32_bf16 v44, s74, v252
    v_dot2c_f32_bf16 v46, v252, v252
    v_dot2c_f32_bf16 v45, s74, v253
    v_dot2c_f32_bf16 v47, v253, v253
    v_dot2c_f32_bf16 v44, s74, v254
    v_dot2c_f32_bf16 v46, v254, v254
    v_dot2c_f32_bf16 v45, s74, v255
    v_dot2c_f32_bf16 v47, v255, v255
    s_nop 1
    v_add_f32 v44, v44, v45
    v_add_f32 v46, v46, v47
    v_mov_b32 v45, v44
    v_mov_b32 v47, v46
    s_nop 0
    v_permlane32_swap_b32 v44, v45
    v_permlane32_swap_b32 v46, v47
    v_add_f32 v44, v44, v45
    v_add_f32 v46, v46, v47
    v_mul_f32 v44, 0x3acccccd, v44
    v_mul_f32 v46, 0x3acccccd, v46
    v_fma_f32 v46, -v44, v44, v46
    v_max_f32 v46, 0, v46
    v_add_f32 v46, 0x3727c5ac, v46
    v_rsq_f32 v2, v46
    s_nop 0
    v_mul_f32 v2, s76, v2
    v_mul_f32_e64 v3, -v44, v2
    v_lshlrev_b32 v14, 16, v96
    v_and_b32 v15, s75, v96
    v_lshlrev_b32 v16, 16, v97
    v_and_b32 v17, s75, v97
    v_pk_fma_f32 v[14:15], v[14:15], v[2:3], v[2:3] op_sel:[0,0,1] op_sel_hi:[1,0,1]
    v_pk_fma_f32 v[16:17], v[16:17], v[2:3], v[2:3] op_sel:[0,0,1] op_sel_hi:[1,0,1]
    v_cvt_pk_bf16_f32 v96, v14, v15
    v_cvt_pk_bf16_f32 v97, v16, v17
    v_lshlrev_b32 v14, 16, v98
    v_and_b32 v15, s75, v98
    v_lshlrev_b32 v16, 16, v99
    v_and_b32 v17, s75, v99
    v_pk_fma_f32 v[14:15], v[14:15], v[2:3], v[2:3] op_sel:[0,0,1] op_sel_hi:[1,0,1]
    v_pk_fma_f32 v[16:17], v[16:17], v[2:3], v[2:3] op_sel:[0,0,1] op_sel_hi:[1,0,1]
    v_cvt_pk_bf16_f32 v98, v14, v15
    v_cvt_pk_bf16_f32 v99, v16, v17
    v_lshlrev_b32 v14, 16, v100
    v_and_b32 v15, s75, v100
    v_lshlrev_b32 v16, 16, v101
    v_and_b32 v17, s75, v101
    v_pk_fma_f32 v[14:15], v[14:15], v[2:3], v[2:3] op_sel:[0,0,1] op_sel_hi:[1,0,1]
    v_pk_fma_f32 v[16:17], v[16:17], v[2:3], v[2:3] op_sel:[0,0,1] op_sel_hi:[1,0,1]
    v_cvt_pk_bf16_f32 v100, v14, v15
    v_cvt_pk_bf16_f32 v101, v16, v17
    v_lshlrev_b32 v14, 16, v102
    v_and_b32 v15, s75, v102
    v_lshlrev_b32 v16, 16, v103
    v_and_b32 v17, s75, v103
    v_pk_fma_f32 v[14:15], v[14:15], v[2:3], v[2:3] op_sel:[0,0,1] op_sel_hi:[1,0,1]
    v_pk_fma_f32 v[16:17], v[16:17], v[2:3], v[2:3] op_sel:[0,0,1] op_sel_hi:[1,0,1]
    v_cvt_pk_bf16_f32 v102, v14, v15
    v_cvt_pk_bf16_f32 v103, v16, v17
    v_lshlrev_b32 v14, 16, v104
    v_and_b32 v15, s75, v104
    v_lshlrev_b32 v16, 16, v105
    v_and_b32 v17, s75, v105
    v_pk_fma_f32 v[14:15], v[14:15], v[2:3], v[2:3] op_sel:[0,0,1] op_sel_hi:[1,0,1]
    v_pk_fma_f32 v[16:17], v[16:17], v[2:3], v[2:3] op_sel:[0,0,1] op_sel_hi:[1,0,1]
    v_cvt_pk_bf16_f32 v104, v14, v15
    v_cvt_pk_bf16_f32 v105, v16, v17
    v_lshlrev_b32 v14, 16, v106
    v_and_b32 v15, s75, v106
    v_lshlrev_b32 v16, 16, v107
    v_and_b32 v17, s75, v107
    v_pk_fma_f32 v[14:15], v[14:15], v[2:3], v[2:3] op_sel:[0,0,1] op_sel_hi:[1,0,1]
    v_pk_fma_f32 v[16:17], v[16:17], v[2:3], v[2:3] op_sel:[0,0,1] op_sel_hi:[1,0,1]
    v_cvt_pk_bf16_f32 v106, v14, v15
    v_cvt_pk_bf16_f32 v107, v16, v17
    v_lshlrev_b32 v14, 16, v108
    v_and_b32 v15, s75, v108
    v_lshlrev_b32 v16, 16, v109
    v_and_b32 v17, s75, v109
    v_pk_fma_f32 v[14:15], v[14:15], v[2:3], v[2:3] op_sel:[0,0,1] op_sel_hi:[1,0,1]
    v_pk_fma_f32 v[16:17], v[16:17], v[2:3], v[2:3] op_sel:[0,0,1] op_sel_hi:[1,0,1]
    v_cvt_pk_bf16_f32 v108, v14, v15
    v_cvt_pk_bf16_f32 v109, v16, v17
    v_lshlrev_b32 v14, 16, v110
    v_and_b32 v15, s75, v110
    v_lshlrev_b32 v16, 16, v111
    v_and_b32 v17, s75, v111
    v_pk_fma_f32 v[14:15], v[14:15], v[2:3], v[2:3] op_sel:[0,0,1] op_sel_hi:[1,0,1]
    v_pk_fma_f32 v[16:17], v[16:17], v[2:3], v[2:3] op_sel:[0,0,1] op_sel_hi:[1,0,1]
    v_cvt_pk_bf16_f32 v110, v14, v15
    v_cvt_pk_bf16_f32 v111, v16, v17
    v_lshlrev_b32 v14, 16, v112
    v_and_b32 v15, s75, v112
    v_lshlrev_b32 v16, 16, v113
    v_and_b32 v17, s75, v113
    v_pk_fma_f32 v[14:15], v[14:15], v[2:3], v[2:3] op_sel:[0,0,1] op_sel_hi:[1,0,1]
    v_pk_fma_f32 v[16:17], v[16:17], v[2:3], v[2:3] op_sel:[0,0,1] op_sel_hi:[1,0,1]
    v_cvt_pk_bf16_f32 v112, v14, v15
    v_cvt_pk_bf16_f32 v113, v16, v17
    v_lshlrev_b32 v14, 16, v114
    v_and_b32 v15, s75, v114
    v_lshlrev_b32 v16, 16, v115
    v_and_b32 v17, s75, v115
    v_pk_fma_f32 v[14:15], v[14:15], v[2:3], v[2:3] op_sel:[0,0,1] op_sel_hi:[1,0,1]
    v_pk_fma_f32 v[16:17], v[16:17], v[2:3], v[2:3] op_sel:[0,0,1] op_sel_hi:[1,0,1]
    v_cvt_pk_bf16_f32 v114, v14, v15
    v_cvt_pk_bf16_f32 v115, v16, v17
    v_lshlrev_b32 v14, 16, v116
    v_and_b32 v15, s75, v116
    v_lshlrev_b32 v16, 16, v117
    v_and_b32 v17, s75, v117
    v_pk_fma_f32 v[14:15], v[14:15], v[2:3], v[2:3] op_sel:[0,0,1] op_sel_hi:[1,0,1]
    v_pk_fma_f32 v[16:17], v[16:17], v[2:3], v[2:3] op_sel:[0,0,1] op_sel_hi:[1,0,1]
    v_cvt_pk_bf16_f32 v116, v14, v15
    v_cvt_pk_bf16_f32 v117, v16, v17
    v_lshlrev_b32 v14, 16, v118
    v_and_b32 v15, s75, v118
    v_lshlrev_b32 v16, 16, v119
    v_and_b32 v17, s75, v119
    v_pk_fma_f32 v[14:15], v[14:15], v[2:3], v[2:3] op_sel:[0,0,1] op_sel_hi:[1,0,1]
    v_pk_fma_f32 v[16:17], v[16:17], v[2:3], v[2:3] op_sel:[0,0,1] op_sel_hi:[1,0,1]
    v_cvt_pk_bf16_f32 v118, v14, v15
    v_cvt_pk_bf16_f32 v119, v16, v17
    v_lshlrev_b32 v14, 16, v120
    v_and_b32 v15, s75, v120
    v_lshlrev_b32 v16, 16, v121
    v_and_b32 v17, s75, v121
    v_pk_fma_f32 v[14:15], v[14:15], v[2:3], v[2:3] op_sel:[0,0,1] op_sel_hi:[1,0,1]
    v_pk_fma_f32 v[16:17], v[16:17], v[2:3], v[2:3] op_sel:[0,0,1] op_sel_hi:[1,0,1]
    v_cvt_pk_bf16_f32 v120, v14, v15
    v_cvt_pk_bf16_f32 v121, v16, v17
    v_lshlrev_b32 v14, 16, v122
    v_and_b32 v15, s75, v122
    v_lshlrev_b32 v16, 16, v123
    v_and_b32 v17, s75, v123
    v_pk_fma_f32 v[14:15], v[14:15], v[2:3], v[2:3] op_sel:[0,0,1] op_sel_hi:[1,0,1]
    v_pk_fma_f32 v[16:17], v[16:17], v[2:3], v[2:3] op_sel:[0,0,1] op_sel_hi:[1,0,1]
    v_cvt_pk_bf16_f32 v122, v14, v15
    v_cvt_pk_bf16_f32 v123, v16, v17
    v_lshlrev_b32 v14, 16, v124
    v_and_b32 v15, s75, v124
    v_lshlrev_b32 v16, 16, v125
    v_and_b32 v17, s75, v125
    v_pk_fma_f32 v[14:15], v[14:15], v[2:3], v[2:3] op_sel:[0,0,1] op_sel_hi:[1,0,1]
    v_pk_fma_f32 v[16:17], v[16:17], v[2:3], v[2:3] op_sel:[0,0,1] op_sel_hi:[1,0,1]
    v_cvt_pk_bf16_f32 v124, v14, v15
    v_cvt_pk_bf16_f32 v125, v16, v17
    v_lshlrev_b32 v14, 16, v126
    v_and_b32 v15, s75, v126
    v_lshlrev_b32 v16, 16, v127
    v_and_b32 v17, s75, v127
    v_pk_fma_f32 v[14:15], v[14:15], v[2:3], v[2:3] op_sel:[0,0,1] op_sel_hi:[1,0,1]
    v_pk_fma_f32 v[16:17], v[16:17], v[2:3], v[2:3] op_sel:[0,0,1] op_sel_hi:[1,0,1]
    v_cvt_pk_bf16_f32 v126, v14, v15
    v_cvt_pk_bf16_f32 v127, v16, v17
    s_mov_b64 exec, 0
    s_cmp_eq_u32 s64, 0
    s_cbranch_scc1 L_pg1_0
    s_cmp_eq_u32 s64, 1
    s_cbranch_scc1 L_pg1_1
    s_cmp_eq_u32 s64, 2
    s_cbranch_scc1 L_pg1_2
    s_branch L_pg1_3
L_pgret1:
    s_mov_b64 exec, -1
    s_add_u32 s72, s72, 245760
    s_sub_u32 s93, s72, 2457600
    s_min_u32 s72, s72, s93
    s_add_u32 m0, s73, 20480
    s_nop 0
    buffer_load_dwordx4 v8, s[8:11], s72 offen offset:0 lds
    buffer_load_dwordx4 v9, s[8:11], s72 offen offset:1024 lds
    buffer_load_dwordx4 v10, s[8:11], s72 offen offset:2048 lds
    buffer_load_dwordx4 v11, s[8:11], s72 offen offset:3072 lds
    s_add_u32 m0, s73, 24576
    s_nop 0
    buffer_load_dwordx4 v12, s[8:11], s72 offen offset:0 lds
    s_waitcnt vmcnt(5)
    s_barrier
    ds_read_b64_tr_b16 a[0:1], v4 offset:0
    ds_read_b64_tr_b16 a[2:3], v4 offset:1280
    ds_read_b64_tr_b16 a[4:5], v4 offset:64
    ds_read_b64_tr_b16 a[6:7], v4 offset:1344
    ds_read_b64_tr_b16 a[8:9], v4 offset:128
    ds_read_b64_tr_b16 a[10:11], v4 offset:1408
    ds_read_b64_tr_b16 a[12:13], v4 offset:192
    ds_read_b64_tr_b16 a[14:15], v4 offset:1472
    ds_read_b64_tr_b16 a[16:17], v4 offset:256
    ds_read_b64_tr_b16 a[18:19], v4 offset:1536
    ds_read_b64_tr_b16 a[20:21], v4 offset:5120
    ds_read_b64_tr_b16 a[22:23], v4 offset:6400
    ds_read_b64_tr_b16 a[24:25], v4 offset:5184
    ds_read_b64_tr_b16 a[26:27], v4 offset:6464
    ds_read_b64_tr_b16 a[28:29], v4 offset:5248
    ds_read_b64_tr_b16 a[30:31], v4 offset:6528
    s_waitcnt lgkmcnt(14)
    v_mfma_f32_32x32x16_bf16 v[32:47], v[96:99], a[0:3], 0
    s_add_u32 s72, s72, 245760
    ds_read_b64_tr_b16 a[32:33], v4 offset:5312
    ds_read_b64_tr_b16 a[34:35], v4 offset:6592
    v_lshlrev_b32 v14, 16, v128
    v_and_b32 v15, s75, v128
    v_fma_f32 v14, v14, v2, v3
    v_fma_f32 v15, v15, v2, v3
    s_waitcnt lgkmcnt(14)
    v_mfma_f32_32x32x16_bf16 v[48:63], v[96:99], a[4:7], 0
    s_sub_u32 s93, s72, 2457600
    ds_read_b64_tr_b16 a[36:37], v4 offset:5376
    ds_read_b64_tr_b16 a[38:39], v4 offset:6656
    v_cvt_pk_bf16_f32 v128, v14, v15
    v_lshlrev_b32 v16, 16, v129
    v_and_b32 v17, s75, v129
    v_fma_f32 v16, v16, v2, v3
    v_fma_f32 v17, v17, v2, v3
    s_waitcnt lgkmcnt(14)
    v_mfma_f32_32x32x16_bf16 v[64:79], v[96:99], a[8:11], 0
    s_min_u32 s72, s72, s93
    ds_read_b64_tr_b16 a[0:1], v4 offset:10240
    ds_read_b64_tr_b16 a[2:3], v4 offset:11520
    v_cvt_pk_bf16_f32 v129, v16, v17
    v_lshlrev_b32 v14, 16, v130
    v_and_b32 v15, s75, v130
    v_fma_f32 v14, v14, v2, v3
    s_waitcnt lgkmcnt(14)
    v_mfma_f32_32x32x16_bf16 v[80:95], v[96:99], a[12:15], 0
    s_add_u32 m0, s73, 40960
    ds_read_b64_tr_b16 a[4:5], v4 offset:10304
    ds_read_b64_tr_b16 a[6:7], v4 offset:11584
    buffer_load_dwordx4 v8, s[8:11], s72 offen offset:0 lds
    v_fma_f32 v15, v15, v2, v3
    v_cvt_pk_bf16_f32 v130, v14, v15
    s_waitcnt lgkmcnt(14)
    v_mfma_f32_32x32x16_bf16 a[88:103], v[96:99], a[16:19], 0
    s_waitcnt lgkmcnt(4)
    ds_read_b64_tr_b16 a[8:9], v4 offset:10368
    ds_read_b64_tr_b16 a[10:11], v4 offset:11648
    buffer_load_dwordx4 v9, s[8:11], s72 offen offset:1024 lds
    v_lshlrev_b32 v16, 16, v131
    v_and_b32 v17, s75, v131
    v_fma_f32 v16, v16, v2, v3
    v_mfma_f32_32x32x16_bf16 v[32:47], v[100:103], a[20:23], v[32:47]
    ds_read_b64_tr_b16 a[12:13], v4 offset:10432
    ds_read_b64_tr_b16 a[14:15], v4 offset:11712
    v_fma_f32 v17, v17, v2, v3
    v_cvt_pk_bf16_f32 v131, v16, v17
    v_lshlrev_b32 v14, 16, v132
    v_and_b32 v15, s75, v132
    v_mfma_f32_32x32x16_bf16 v[48:63], v[100:103], a[24:27], v[48:63]
    ds_read_b64_tr_b16 a[16:17], v4 offset:10496
    ds_read_b64_tr_b16 a[18:19], v4 offset:11776
    buffer_load_dwordx4 v10, s[8:11], s72 offen offset:2048 lds
    v_fma_f32 v14, v14, v2, v3
    v_fma_f32 v15, v15, v2, v3
    v_mfma_f32_32x32x16_bf16 v[64:79], v[100:103], a[28:31], v[64:79]
    ds_read_b64_tr_b16 a[20:21], v4 offset:15360
    ds_read_b64_tr_b16 a[22:23], v4 offset:16640
    v_cvt_pk_bf16_f32 v132, v14, v15
    v_lshlrev_b32 v16, 16, v133
    v_and_b32 v17, s75, v133
    v_fma_f32 v16, v16, v2, v3
    v_fma_f32 v17, v17, v2, v3
    v_mfma_f32_32x32x16_bf16 v[80:95], v[100:103], a[32:35], v[80:95]
    ds_read_b64_tr_b16 a[24:25], v4 offset:15424
    ds_read_b64_tr_b16 a[26:27], v4 offset:16704
    v_cvt_pk_bf16_f32 v133, v16, v17
    v_lshlrev_b32 v14, 16, v134
    v_and_b32 v15, s75, v134
    v_fma_f32 v14, v14, v2, v3
    v_mfma_f32_32x32x16_bf16 a[88:103], v[100:103], a[36:39], a[88:103]
    s_waitcnt lgkmcnt(4)
    ds_read_b64_tr_b16 a[28:29], v4 offset:15488
    ds_read_b64_tr_b16 a[30:31], v4 offset:16768
    buffer_load_dwordx4 v11, s[8:11], s72 offen offset:3072 lds
    v_fma_f32 v15, v15, v2, v3
    v_cvt_pk_bf16_f32 v134, v14, v15
    v_mfma_f32_32x32x16_bf16 v[32:47], v[104:107], a[0:3], v[32:47]
    s_add_u32 m0, s73, 45056
    ds_read_b64_tr_b16 a[32:33], v4 offset:15552
    ds_read_b64_tr_b16 a[34:35], v4 offset:16832
    v_lshlrev_b32 v16, 16, v135
    v_and_b32 v17, s75, v135
    v_fma_f32 v16, v16, v2, v3
    v_fma_f32 v17, v17, v2, v3
    v_mfma_f32_32x32x16_bf16 v[48:63], v[104:107], a[4:7], v[48:63]
    ds_read_b64_tr_b16 a[36:37], v4 offset:15616
    ds_read_b64_tr_b16 a[38:39], v4 offset:16896
    v_cvt_pk_bf16_f32 v135, v16, v17
    v_lshlrev_b32 v14, 16, v136
    v_and_b32 v15, s75, v136
    v_fma_f32 v14, v14, v2, v3
    v_fma_f32 v15, v15, v2, v3
    v_mfma_f32_32x32x16_bf16 v[64:79], v[104:107], a[8:11], v[64:79]
    s_waitcnt vmcnt(4)
    s_barrier
    ds_read_b64_tr_b16 a[0:1], v4 offset:20480
    ds_read_b64_tr_b16 a[2:3], v4 offset:21760
    buffer_load_dwordx4 v12, s[8:11], s72 offen offset:0 lds
    v_cvt_pk_bf16_f32 v136, v14, v15
    v_mfma_f32_32x32x16_bf16 v[80:95], v[104:107], a[12:15], v[80:95]
    s_add_u32 s72, s72, 245760
    ds_read_b64_tr_b16 a[4:5], v4 offset:20544
    ds_read_b64_tr_b16 a[6:7], v4 offset:21824
    v_lshlrev_b32 v16, 16, v137
    v_and_b32 v17, s75, v137
    v_fma_f32 v16, v16, v2, v3
    v_fma_f32 v17, v17, v2, v3
    v_mfma_f32_32x32x16_bf16 a[88:103], v[104:107], a[16:19], a[88:103]
    s_waitcnt lgkmcnt(4)
    ds_read_b64_tr_b16 a[8:9], v4 offset:20608
    ds_read_b64_tr_b16 a[10:11], v4 offset:21888
    v_cvt_pk_bf16_f32 v137, v16, v17
    v_lshlrev_b32 v14, 16, v138
    v_and_b32 v15, s75, v138
    v_fma_f32 v14, v14, v2, v3
    v_fma_f32 v15, v15, v2, v3
    v_mfma_f32_32x32x16_bf16 v[32:47], v[108:111], a[20:23], v[32:47]
    s_sub_u32 s93, s72, 2457600
    ds_read_b64_tr_b16 a[12:13], v4 offset:20672
    ds_read_b64_tr_b16 a[14:15], v4 offset:21952
    v_cvt_pk_bf16_f32 v138, v14, v15
    v_lshlrev_b32 v16, 16, v139
    v_and_b32 v17, s75, v139
    v_fma_f32 v16, v16, v2, v3
    v_mfma_f32_32x32x16_bf16 v[48:63], v[108:111], a[24:27], v[48:63]
    s_min_u32 s72, s72, s93
    ds_read_b64_tr_b16 a[16:17], v4 offset:20736
    ds_read_b64_tr_b16 a[18:19], v4 offset:22016
    v_fma_f32 v17, v17, v2, v3
    v_cvt_pk_bf16_f32 v139, v16, v17
    v_lshlrev_b32 v14, 16, v140
    v_and_b32 v15, s75, v140
    v_mfma_f32_32x32x16_bf16 v[64:79], v[108:111], a[28:31], v[64:79]
    s_add_u32 m0, s73, 61440
    ds_read_b64_tr_b16 a[20:21], v4 offset:25600
    ds_read_b64_tr_b16 a[22:23], v4 offset:26880
    buffer_load_dwordx4 v8, s[8:11], s72 offen offset:0 lds
    v_fma_f32 v14, v14, v2, v3
    v_fma_f32 v15, v15, v2, v3
    v_cvt_pk_bf16_f32 v140, v14, v15
    v_mfma_f32_32x32x16_bf16 v[80:95], v[108:111], a[32:35], v[80:95]
    ds_read_b64_tr_b16 a[24:25], v4 offset:25664
    ds_read_b64_tr_b16 a[26:27], v4 offset:26944
    buffer_load_dwordx4 v9, s[8:11], s72 offen offset:1024 lds
    v_lshlrev_b32 v16, 16, v141
    v_and_b32 v17, s75, v141
    v_mfma_f32_32x32x16_bf16 a[88:103], v[108:111], a[36:39], a[88:103]
    s_waitcnt lgkmcnt(4)
    ds_read_b64_tr_b16 a[28:29], v4 offset:25728
    ds_read_b64_tr_b16 a[30:31], v4 offset:27008
    v_fma_f32 v16, v16, v2, v3
    v_fma_f32 v17, v17, v2, v3
    v_cvt_pk_bf16_f32 v141, v16, v17
    v_lshlrev_b32 v14, 16, v142
    v_mfma_f32_32x32x16_bf16 v[32:47], v[112:115], a[0:3], v[32:47]
    ds_read_b64_tr_b16 a[32:33], v4 offset:25792
    ds_read_b64_tr_b16 a[34:35], v4 offset:27072
    v_and_b32 v15, s75, v142
    v_fma_f32 v14, v14, v2, v3
    v_fma_f32 v15, v15, v2, v3
    v_cvt_pk_bf16_f32 v142, v14, v15
    v_lshlrev_b32 v16, 16, v143
    v_mfma_f32_32x32x16_bf16 v[48:63], v[112:115], a[4:7], v[48:63]
    ds_read_b64_tr_b16 a[36:37], v4 offset:25856
    ds_read_b64_tr_b16 a[38:39], v4 offset:27136
    buffer_load_dwordx4 v10, s[8:11], s72 offen offset:2048 lds
    v_and_b32 v17, s75, v143
    v_fma_f32 v16, v16, v2, v3
    v_mfma_f32_32x32x16_bf16 v[64:79], v[112:115], a[8:11], v[64:79]
    ds_read_b64_tr_b16 a[0:1], v4 offset:30720
    ds_read_b64_tr_b16 a[2:3], v4 offset:32000
    v_fma_f32 v17, v17, v2, v3
    v_cvt_pk_bf16_f32 v143, v16, v17
    v_lshlrev_b32 v14, 16, v144
    v_and_b32 v15, s75, v144
    v_mfma_f32_32x32x16_bf16 v[80:95], v[112:115], a[12:15], v[80:95]
    ds_read_b64_tr_b16 a[4:5], v4 offset:30784
    ds_read_b64_tr_b16 a[6:7], v4 offset:32064
    v_fma_f32 v14, v14, v2, v3
    v_fma_f32 v15, v15, v2, v3
    v_cvt_pk_bf16_f32 v144, v14, v15
    v_lshlrev_b32 v16, 16, v145
    v_and_b32 v17, s75, v145
    v_mfma_f32_32x32x16_bf16 a[88:103], v[112:115], a[16:19], a[88:103]
    s_waitcnt lgkmcnt(4)
    ds_read_b64_tr_b16 a[8:9], v4 offset:30848
    ds_read_b64_tr_b16 a[10:11], v4 offset:32128
    v_fma_f32 v16, v16, v2, v3
    v_fma_f32 v17, v17, v2, v3
    v_cvt_pk_bf16_f32 v145, v16, v17
    v_lshlrev_b32 v14, 16, v146
    v_mfma_f32_32x32x16_bf16 v[32:47], v[116:119], a[20:23], v[32:47]
    ds_read_b64_tr_b16 a[12:13], v4 offset:30912
    ds_read_b64_tr_b16 a[14:15], v4 offset:32192
    buffer_load_dwordx4 v11, s[8:11], s72 offen offset:3072 lds
    v_and_b32 v15, s75, v146
    v_fma_f32 v14, v14, v2, v3
    v_mfma_f32_32x32x16_bf16 v[48:63], v[116:119], a[24:27], v[48:63]
    s_add_u32 m0, s73, 65536
    ds_read_b64_tr_b16 a[16:17], v4 offset:30976
    ds_read_b64_tr_b16 a[18:19], v4 offset:32256
    v_fma_f32 v15, v15, v2, v3
    v_cvt_pk_bf16_f32 v146, v14, v15
    v_lshlrev_b32 v16, 16, v147
    v_and_b32 v17, s75, v147
    v_fma_f32 v16, v16, v2, v3
    v_mfma_f32_32x32x16_bf16 v[64:79], v[116:119], a[28:31], v[64:79]
    ds_read_b64_tr_b16 a[20:21], v4 offset:35840
    ds_read_b64_tr_b16 a[22:23], v4 offset:37120
    v_fma_f32 v17, v17, v2, v3
    v_cvt_pk_bf16_f32 v147, v16, v17
    v_lshlrev_b32 v14, 16, v148
    v_and_b32 v15, s75, v148
    v_mfma_f32_32x32x16_bf16 v[80:95], v[116:119], a[32:35], v[80:95]
    ds_read_b64_tr_b16 a[24:25], v4 offset:35904
    ds_read_b64_tr_b16 a[26:27], v4 offset:37184
    buffer_load_dwordx4 v12, s[8:11], s72 offen offset:0 lds
    v_fma_f32 v14, v14, v2, v3
    v_fma_f32 v15, v15, v2, v3
    v_mfma_f32_32x32x16_bf16 a[88:103], v[116:119], a[36:39], a[88:103]
    s_waitcnt lgkmcnt(4)
    ds_read_b64_tr_b16 a[28:29], v4 offset:35968
    ds_read_b64_tr_b16 a[30:31], v4 offset:37248
    v_cvt_pk_bf16_f32 v148, v14, v15
    v_lshlrev_b32 v16, 16, v149
    v_and_b32 v17, s75, v149
    v_fma_f32 v16, v16, v2, v3
    v_mfma_f32_32x32x16_bf16 v[32:47], v[120:123], a[0:3], v[32:47]
    s_add_u32 s72, s72, 245760
    ds_read_b64_tr_b16 a[32:33], v4 offset:36032
    ds_read_b64_tr_b16 a[34:35], v4 offset:37312
    v_fma_f32 v17, v17, v2, v3
    v_cvt_pk_bf16_f32 v149, v16, v17
    v_lshlrev_b32 v14, 16, v150
    v_and_b32 v15, s75, v150
    v_fma_f32 v14, v14, v2, v3
    v_mfma_f32_32x32x16_bf16 v[48:63], v[120:123], a[4:7], v[48:63]
    s_sub_u32 s93, s72, 2457600
    ds_read_b64_tr_b16 a[36:37], v4 offset:36096
    ds_read_b64_tr_b16 a[38:39], v4 offset:37376
    v_fma_f32 v15, v15, v2, v3
    v_cvt_pk_bf16_f32 v150, v14, v15
    v_lshlrev_b32 v16, 16, v151
    v_and_b32 v17, s75, v151
    v_mfma_f32_32x32x16_bf16 v[64:79], v[120:123], a[8:11], v[64:79]
    s_waitcnt vmcnt(5)
    s_barrier
    ds_read_b64_tr_b16 a[0:1], v4 offset:40960
    ds_read_b64_tr_b16 a[2:3], v4 offset:42240
    v_fma_f32 v16, v16, v2, v3
    v_fma_f32 v17, v17, v2, v3
    v_cvt_pk_bf16_f32 v151, v16, v17
    v_mfma_f32_32x32x16_bf16 v[80:95], v[120:123], a[12:15], v[80:95]
    s_min_u32 s72, s72, s93
    ds_read_b64_tr_b16 a[4:5], v4 offset:41024
    ds_read_b64_tr_b16 a[6:7], v4 offset:42304
    v_lshlrev_b32 v14, 16, v152
    v_and_b32 v15, s75, v152
    v_fma_f32 v14, v14, v2, v3
    v_fma_f32 v15, v15, v2, v3
    v_cvt_pk_bf16_f32 v152, v14, v15
    v_mfma_f32_32x32x16_bf16 a[88:103], v[120:123], a[16:19], a[88:103]
    s_waitcnt lgkmcnt(4)
    ds_read_b64_tr_b16 a[8:9], v4 offset:41088
    ds_read_b64_tr_b16 a[10:11], v4 offset:42368
    v_lshlrev_b32 v16, 16, v153
    v_and_b32 v17, s75, v153
    v_fma_f32 v16, v16, v2, v3
    v_fma_f32 v17, v17, v2, v3
    v_mfma_f32_32x32x16_bf16 v[32:47], v[124:127], a[20:23], v[32:47]
    s_add_u32 m0, s73, 81920
    ds_read_b64_tr_b16 a[12:13], v4 offset:41152
    ds_read_b64_tr_b16 a[14:15], v4 offset:42432
    buffer_load_dwordx4 v8, s[8:11], s72 offen offset:0 lds
    v_cvt_pk_bf16_f32 v153, v16, v17
    v_lshlrev_b32 v14, 16, v154
    v_mfma_f32_32x32x16_bf16 v[48:63], v[124:127], a[24:27], v[48:63]
    ds_read_b64_tr_b16 a[16:17], v4 offset:41216
    ds_read_b64_tr_b16 a[18:19], v4 offset:42496
    buffer_load_dwordx4 v9, s[8:11], s72 offen offset:1024 lds
    v_and_b32 v15, s75, v154
    v_fma_f32 v14, v14, v2, v3
    v_fma_f32 v15, v15, v2, v3
    v_mfma_f32_32x32x16_bf16 v[64:79], v[124:127], a[28:31], v[64:79]
    ds_read_b64_tr_b16 a[20:21], v4 offset:46080
    ds_read_b64_tr_b16 a[22:23], v4 offset:47360
    v_cvt_pk_bf16_f32 v154, v14, v15
    v_lshlrev_b32 v16, 16, v155
    v_and_b32 v17, s75, v155
    v_fma_f32 v16, v16, v2, v3
    v_mfma_f32_32x32x16_bf16 v[80:95], v[124:127], a[32:35], v[80:95]
    ds_read_b64_tr_b16 a[24:25], v4 offset:46144
    ds_read_b64_tr_b16 a[26:27], v4 offset:47424
    buffer_load_dwordx4 v10, s[8:11], s72 offen offset:2048 lds
    v_fma_f32 v17, v17, v2, v3
    v_cvt_pk_bf16_f32 v155, v16, v17
    v_mfma_f32_32x32x16_bf16 a[88:103], v[124:127], a[36:39], a[88:103]
    s_waitcnt lgkmcnt(4)
    ds_read_b64_tr_b16 a[28:29], v4 offset:46208
    ds_read_b64_tr_b16 a[30:31], v4 offset:47488
    v_lshlrev_b32 v14, 16, v156
    v_and_b32 v15, s75, v156
    v_fma_f32 v14, v14, v2, v3
    v_fma_f32 v15, v15, v2, v3
    v_cvt_pk_bf16_f32 v156, v14, v15
    v_mfma_f32_32x32x16_bf16 v[32:47], v[128:131], a[0:3], v[32:47]
    ds_read_b64_tr_b16 a[32:33], v4 offset:46272
    ds_read_b64_tr_b16 a[34:35], v4 offset:47552
    v_lshlrev_b32 v18, 2, v0
    v_lshlrev_b32 v16, 16, v157
    v_and_b32 v17, s75, v157
    v_fma_f32 v16, v16, v2, v3
    v_mfma_f32_32x32x16_bf16 v[48:63], v[128:131], a[4:7], v[48:63]
    ds_read_b64_tr_b16 a[36:37], v4 offset:46336
    ds_read_b64_tr_b16 a[38:39], v4 offset:47616
    buffer_load_dwordx4 v11, s[8:11], s72 offen offset:3072 lds
    v_fma_f32 v17, v17, v2, v3
    v_cvt_pk_bf16_f32 v157, v16, v17
    v_mfma_f32_32x32x16_bf16 v[64:79], v[128:131], a[8:11], v[64:79]
    s_add_u32 m0, s73, 86016
    ds_read_b64_tr_b16 a[0:1], v4 offset:51200
    ds_read_b64_tr_b16 a[2:3], v4 offset:52480
    buffer_load_dword v19, v18, s[24:27], 0 offen sc1
    v_lshlrev_b32 v14, 16, v158
    v_and_b32 v15, s75, v158
    v_fma_f32 v14, v14, v2, v3
    v_mfma_f32_32x32x16_bf16 v[80:95], v[128:131], a[12:15], v[80:95]
    ds_read_b64_tr_b16 a[4:5], v4 offset:51264
    ds_read_b64_tr_b16 a[6:7], v4 offset:52544
    v_fma_f32 v15, v15, v2, v3
    v_cvt_pk_bf16_f32 v158, v14, v15
    v_lshlrev_b32 v16, 16, v159
    v_and_b32 v17, s75, v159
    v_mfma_f32_32x32x16_bf16 a[88:103], v[128:131], a[16:19], a[88:103]
    s_waitcnt lgkmcnt(4)
    ds_read_b64_tr_b16 a[8:9], v4 offset:51328
    ds_read_b64_tr_b16 a[10:11], v4 offset:52608
    buffer_load_dwordx4 v12, s[8:11], s72 offen offset:0 lds
    v_fma_f32 v16, v16, v2, v3
    v_fma_f32 v17, v17, v2, v3
    v_mfma_f32_32x32x16_bf16 v[32:47], v[132:135], a[20:23], v[32:47]
    s_add_u32 s72, s72, 245760
    ds_read_b64_tr_b16 a[12:13], v4 offset:51392
    ds_read_b64_tr_b16 a[14:15], v4 offset:52672
    v_cvt_pk_bf16_f32 v159, v16, v17
    v_lshlrev_b32 v14, 16, v160
    v_and_b32 v15, s75, v160
    v_fma_f32 v14, v14, v2, v3
    v_mfma_f32_32x32x16_bf16 v[48:63], v[132:135], a[24:27], v[48:63]
    s_sub_u32 s93, s72, 2457600
    ds_read_b64_tr_b16 a[16:17], v4 offset:51456
    ds_read_b64_tr_b16 a[18:19], v4 offset:52736
    v_fma_f32 v15, v15, v2, v3
    v_cvt_pk_bf16_f32 v160, v14, v15
    v_lshlrev_b32 v16, 16, v161
    v_and_b32 v17, s75, v161
    v_fma_f32 v16, v16, v2, v3
    v_mfma_f32_32x32x16_bf16 v[64:79], v[132:135], a[28:31], v[64:79]
    s_min_u32 s72, s72, s93
    ds_read_b64_tr_b16 a[20:21], v4 offset:56320
    ds_read_b64_tr_b16 a[22:23], v4 offset:57600
    v_fma_f32 v17, v17, v2, v3
    v_cvt_pk_bf16_f32 v161, v16, v17
    v_lshlrev_b32 v14, 16, v162
    v_and_b32 v15, s75, v162
    v_mfma_f32_32x32x16_bf16 v[80:95], v[132:135], a[32:35], v[80:95]
    s_add_u32 m0, s73, 0
    ds_read_b64_tr_b16 a[24:25], v4 offset:56384
    ds_read_b64_tr_b16 a[26:27], v4 offset:57664
    buffer_load_dwordx4 v8, s[8:11], s72 offen offset:0 lds
    v_fma_f32 v14, v14, v2, v3
    v_fma_f32 v15, v15, v2, v3
    v_mfma_f32_32x32x16_bf16 a[88:103], v[132:135], a[36:39], a[88:103]
    s_waitcnt lgkmcnt(4)
    ds_read_b64_tr_b16 a[28:29], v4 offset:56448
    ds_read_b64_tr_b16 a[30:31], v4 offset:57728
    v_cvt_pk_bf16_f32 v162, v14, v15
    v_lshlrev_b32 v16, 16, v163
    v_and_b32 v17, s75, v163
    v_fma_f32 v16, v16, v2, v3
    v_fma_f32 v17, v17, v2, v3
    v_mfma_f32_32x32x16_bf16 v[32:47], v[136:139], a[0:3], v[32:47]
    ds_read_b64_tr_b16 a[32:33], v4 offset:56512
    ds_read_b64_tr_b16 a[34:35], v4 offset:57792
    buffer_load_dwordx4 v9, s[8:11], s72 offen offset:1024 lds
    v_cvt_pk_bf16_f32 v163, v16, v17
    v_lshlrev_b32 v14, 16, v164
    v_mfma_f32_32x32x16_bf16 v[48:63], v[136:139], a[4:7], v[48:63]
    ds_read_b64_tr_b16 a[36:37], v4 offset:56576
    ds_read_b64_tr_b16 a[38:39], v4 offset:57856
    v_and_b32 v15, s75, v164
    v_fma_f32 v14, v14, v2, v3
    v_fma_f32 v15, v15, v2, v3
    v_cvt_pk_bf16_f32 v164, v14, v15
    v_mfma_f32_32x32x16_bf16 v[64:79], v[136:139], a[8:11], v[64:79]
    s_waitcnt vmcnt(8)
    s_barrier
    ds_read_b64_tr_b16 a[0:1], v4 offset:61440
L_pg1_0:
    s_cbranch_execz L_pg1_4
    ds_read_b64_tr_b16 a[2:3], v4 offset:62720
    v_lshlrev_b32 v16, 16, v165
    v_and_b32 v17, s75, v165
    v_fma_f32 v16, v16, v2, v3
    v_fma_f32 v17, v17, v2, v3
    v_mfma_f32_32x32x16_bf16 v[80:95], v[136:139], a[12:15], v[80:95]
    ds_read_b64_tr_b16 a[4:5], v4 offset:61504
    ds_read_b64_tr_b16 a[6:7], v4 offset:62784
    buffer_load_dwordx4 v10, s[8:11], s72 offen offset:2048 lds
    v_cvt_pk_bf16_f32 v165, v16, v17
    v_lshlrev_b32 v14, 16, v166
    v_mfma_f32_32x32x16_bf16 a[88:103], v[136:139], a[16:19], a[88:103]
    s_waitcnt lgkmcnt(4)
    ds_read_b64_tr_b16 a[8:9], v4 offset:61568
    ds_read_b64_tr_b16 a[10:11], v4 offset:62848
    v_and_b32 v15, s75, v166
    v_fma_f32 v14, v14, v2, v3
    v_fma_f32 v15, v15, v2, v3
    v_cvt_pk_bf16_f32 v166, v14, v15
    v_mfma_f32_32x32x16_bf16 v[32:47], v[140:143], a[20:23], v[32:47]
    ds_read_b64_tr_b16 a[12:13], v4 offset:61632
    ds_read_b64_tr_b16 a[14:15], v4 offset:62912
    v_lshlrev_b32 v16, 16, v167
    v_and_b32 v17, s75, v167
    v_fma_f32 v16, v16, v2, v3
    v_fma_f32 v17, v17, v2, v3
    v_cvt_pk_bf16_f32 v167, v16, v17
    v_mfma_f32_32x32x16_bf16 v[48:63], v[140:143], a[24:27], v[48:63]
    ds_read_b64_tr_b16 a[16:17], v4 offset:61696
    ds_read_b64_tr_b16 a[18:19], v4 offset:62976
    v_add_u32 v4, 66560, v4
    v_lshlrev_b32 v14, 16, v168
    v_and_b32 v15, s75, v168
    v_fma_f32 v14, v14, v2, v3
    v_mfma_f32_32x32x16_bf16 v[64:79], v[140:143], a[28:31], v[64:79]
    ds_read_b64_tr_b16 a[20:21], v4 offset:0
    ds_read_b64_tr_b16 a[22:23], v4 offset:1280
    buffer_load_dwordx4 v11, s[8:11], s72 offen offset:3072 lds
    v_fma_f32 v15, v15, v2, v3
    v_cvt_pk_bf16_f32 v168, v14, v15
    v_mfma_f32_32x32x16_bf16 v[80:95], v[140:143], a[32:35], v[80:95]
    s_add_u32 m0, s73, 4096
    ds_read_b64_tr_b16 a[24:25], v4 offset:64
    ds_read_b64_tr_b16 a[26:27], v4 offset:1344
    v_lshlrev_b32 v16, 16, v169
    v_and_b32 v17, s75, v169
    v_fma_f32 v16, v16, v2, v3
    v_fma_f32 v17, v17, v2, v3
    v_cvt_pk_bf16_f32 v169, v16, v17
    v_mfma_f32_32x32x16_bf16 a[88:103], v[140:143], a[36:39], a[88:103]
    s_waitcnt lgkmcnt(4)
    ds_read_b64_tr_b16 a[28:29], v4 offset:128
    ds_read_b64_tr_b16 a[30:31], v4 offset:1408
    v_lshlrev_b32 v14, 16, v170
    v_and_b32 v15, s75, v170
    v_fma_f32 v14, v14, v2, v3
    v_fma_f32 v15, v15, v2, v3
    v_mfma_f32_32x32x16_bf16 v[32:47], v[144:147], a[0:3], v[32:47]
    s_waitcnt vmcnt(5)
    v_cmp_ne_u32 vcc, 1, v19
    s_cbranch_vccnz L_spin6
L_back6:
    ds_read_b64_tr_b16 a[32:33], v4 offset:192
    ds_read_b64_tr_b16 a[34:35], v4 offset:1472
    buffer_load_dwordx4 v12, s[8:11], s72 offen offset:0 lds
    v_cvt_pk_bf16_f32 v170, v14, v15
    v_lshlrev_b32 v16, 16, v171
    v_mfma_f32_32x32x16_bf16 v[48:63], v[144:147], a[4:7], v[48:63]
    s_add_u32 s72, s72, 245760
    ds_read_b64_tr_b16 a[36:37], v4 offset:256
    ds_read_b64_tr_b16 a[38:39], v4 offset:1536
    v_and_b32 v17, s75, v171
    v_fma_f32 v16, v16, v2, v3
    v_fma_f32 v17, v17, v2, v3
    v_cvt_pk_bf16_f32 v171, v16, v17
    v_lshlrev_b32 v14, 16, v172
    v_mfma_f32_32x32x16_bf16 v[64:79], v[144:147], a[8:11], v[64:79]
    s_sub_u32 s93, s72, 2457600
    ds_read_b64_tr_b16 a[0:1], v4 offset:5120
    ds_read_b64_tr_b16 a[2:3], v4 offset:6400
    v_and_b32 v15, s75, v172
    v_fma_f32 v14, v14, v2, v3
    v_fma_f32 v15, v15, v2, v3
    v_cvt_pk_bf16_f32 v172, v14, v15
    v_mfma_f32_32x32x16_bf16 v[80:95], v[144:147], a[12:15], v[80:95]
    s_min_u32 s72, s72, s93
    ds_read_b64_tr_b16 a[4:5], v4 offset:5184
    ds_read_b64_tr_b16 a[6:7], v4 offset:6464
    v_lshlrev_b32 v16, 16, v173
    v_and_b32 v17, s75, v173
    v_fma_f32 v16, v16, v2, v3
    v_fma_f32 v17, v17, v2, v3
    v_mfma_f32_32x32x16_bf16 a[88:103], v[144:147], a[16:19], a[88:103]
    s_waitcnt lgkmcnt(4)
    ds_read_b64_tr_b16 a[8:9], v4 offset:5248
    ds_read_b64_tr_b16 a[10:11], v4 offset:6528
    v_cvt_pk_bf16_f32 v173, v16, v17
    v_lshlrev_b32 v14, 16, v174
    v_and_b32 v15, s75, v174
    v_fma_f32 v14, v14, v2, v3
    v_mfma_f32_32x32x16_bf16 v[32:47], v[148:151], a[20:23], v[32:47]
    s_add_u32 m0, s73, 20480
    ds_read_b64_tr_b16 a[12:13], v4 offset:5312
    ds_read_b64_tr_b16 a[14:15], v4 offset:6592
    buffer_load_dwordx4 v8, s[8:11], s72 offen offset:0 lds
    v_fma_f32 v15, v15, v2, v3
    v_cvt_pk_bf16_f32 v174, v14, v15
    v_lshlrev_b32 v16, 16, v175
    v_mfma_f32_32x32x16_bf16 v[48:63], v[148:151], a[24:27], v[48:63]
    ds_read_b64_tr_b16 a[16:17], v4 offset:5376
    ds_read_b64_tr_b16 a[18:19], v4 offset:6656
    buffer_load_dwordx4 v9, s[8:11], s72 offen offset:1024 lds
    v_and_b32 v17, s75, v175
    v_fma_f32 v16, v16, v2, v3
    v_mfma_f32_32x32x16_bf16 v[64:79], v[148:151], a[28:31], v[64:79]
    ds_read_b64_tr_b16 a[20:21], v4 offset:10240
    ds_read_b64_tr_b16 a[22:23], v4 offset:11520
    v_fma_f32 v17, v17, v2, v3
    v_cvt_pk_bf16_f32 v175, v16, v17
    v_lshlrev_b32 v14, 16, v176
    v_and_b32 v15, s75, v176
    v_mfma_f32_32x32x16_bf16 v[80:95], v[148:151], a[32:35], v[80:95]
    ds_read_b64_tr_b16 a[24:25], v4 offset:10304
    ds_read_b64_tr_b16 a[26:27], v4 offset:11584
    v_fma_f32 v14, v14, v2, v3
    v_fma_f32 v15, v15, v2, v3
    v_cvt_pk_bf16_f32 v176, v14, v15
    v_lshlrev_b32 v16, 16, v177
    v_and_b32 v17, s75, v177
    v_mfma_f32_32x32x16_bf16 a[88:103], v[148:151], a[36:39], a[88:103]
    s_waitcnt lgkmcnt(4)
    ds_read_b64_tr_b16 a[28:29], v4 offset:10368
    ds_read_b64_tr_b16 a[30:31], v4 offset:11648
    buffer_load_dwordx4 v10, s[8:11], s72 offen offset:2048 lds
    v_fma_f32 v16, v16, v2, v3
    v_fma_f32 v17, v17, v2, v3
    v_mfma_f32_32x32x16_bf16 v[32:47], v[152:155], a[0:3], v[32:47]
    ds_read_b64_tr_b16 a[32:33], v4 offset:10432
    ds_read_b64_tr_b16 a[34:35], v4 offset:11712
    v_cvt_pk_bf16_f32 v177, v16, v17
    v_lshlrev_b32 v14, 16, v178
    v_and_b32 v15, s75, v178
    v_fma_f32 v14, v14, v2, v3
    v_mfma_f32_32x32x16_bf16 v[48:63], v[152:155], a[4:7], v[48:63]
    ds_read_b64_tr_b16 a[36:37], v4 offset:10496
    ds_read_b64_tr_b16 a[38:39], v4 offset:11776
    v_fma_f32 v15, v15, v2, v3
    v_cvt_pk_bf16_f32 v178, v14, v15
    v_lshlrev_b32 v16, 16, v179
    v_and_b32 v17, s75, v179
    v_fma_f32 v16, v16, v2, v3
    v_mfma_f32_32x32x16_bf16 v[64:79], v[152:155], a[8:11], v[64:79]
    s_waitcnt vmcnt(8)
    s_barrier
    ds_read_b64_tr_b16 a[0:1], v4 offset:15360
    ds_read_b64_tr_b16 a[2:3], v4 offset:16640
    buffer_load_dwordx4 v11, s[8:11], s72 offen offset:3072 lds
    v_fma_f32 v17, v17, v2, v3
    v_mfma_f32_32x32x16_bf16 v[80:95], v[152:155], a[12:15], v[80:95]
    s_add_u32 m0, s73, 24576
    ds_read_b64_tr_b16 a[4:5], v4 offset:15424
    ds_read_b64_tr_b16 a[6:7], v4 offset:16704
    v_cvt_pk_bf16_f32 v179, v16, v17
    v_lshlrev_b32 v14, 16, v180
    v_and_b32 v15, s75, v180
    v_fma_f32 v14, v14, v2, v3
    v_mfma_f32_32x32x16_bf16 a[88:103], v[152:155], a[16:19], a[88:103]
    s_waitcnt lgkmcnt(4)
    ds_read_b64_tr_b16 a[8:9], v4 offset:15488
    ds_read_b64_tr_b16 a[10:11], v4 offset:16768
    v_fma_f32 v15, v15, v2, v3
    v_cvt_pk_bf16_f32 v180, v14, v15
    v_lshlrev_b32 v16, 16, v181
    v_and_b32 v17, s75, v181
    v_fma_f32 v16, v16, v2, v3
    v_mfma_f32_32x32x16_bf16 v[32:47], v[156:159], a[20:23], v[32:47]
    ds_read_b64_tr_b16 a[12:13], v4 offset:15552
    ds_read_b64_tr_b16 a[14:15], v4 offset:16832
    v_fma_f32 v17, v17, v2, v3
    v_cvt_pk_bf16_f32 v181, v16, v17
    v_lshlrev_b32 v14, 16, v182
    v_and_b32 v15, s75, v182
    v_mfma_f32_32x32x16_bf16 v[48:63], v[156:159], a[24:27], v[48:63]
    ds_read_b64_tr_b16 a[16:17], v4 offset:15616
    ds_read_b64_tr_b16 a[18:19], v4 offset:16896
    buffer_load_dwordx4 v12, s[8:11], s72 offen offset:0 lds
    v_fma_f32 v14, v14, v2, v3
    v_fma_f32 v15, v15, v2, v3
    v_mfma_f32_32x32x16_bf16 v[64:79], v[156:159], a[28:31], v[64:79]
    s_add_u32 s72, s72, 245760
    ds_read_b64_tr_b16 a[20:21], v4 offset:20480
    ds_read_b64_tr_b16 a[22:23], v4 offset:21760
    v_cvt_pk_bf16_f32 v182, v14, v15
    v_lshlrev_b32 v16, 16, v183
    v_and_b32 v17, s75, v183
    v_fma_f32 v16, v16, v2, v3
    v_fma_f32 v17, v17, v2, v3
    v_mfma_f32_32x32x16_bf16 v[80:95], v[156:159], a[32:35], v[80:95]
    s_sub_u32 s93, s72, 2457600
    ds_read_b64_tr_b16 a[24:25], v4 offset:20544
    ds_read_b64_tr_b16 a[26:27], v4 offset:21824
    v_cvt_pk_bf16_f32 v183, v16, v17
    v_lshlrev_b32 v14, 16, v184
    v_and_b32 v15, s75, v184
    v_fma_f32 v14, v14, v2, v3
    v_mfma_f32_32x32x16_bf16 a[88:103], v[156:159], a[36:39], a[88:103]
    s_waitcnt lgkmcnt(4)
    ds_read_b64_tr_b16 a[28:29], v4 offset:20608
    ds_read_b64_tr_b16 a[30:31], v4 offset:21888
    v_fma_f32 v15, v15, v2, v3
    v_cvt_pk_bf16_f32 v184, v14, v15
    v_lshlrev_b32 v16, 16, v185
    v_and_b32 v17, s75, v185
    v_mfma_f32_32x32x16_bf16 v[32:47], v[160:163], a[0:3], v[32:47]
    s_min_u32 s72, s72, s93
    ds_read_b64_tr_b16 a[32:33], v4 offset:20672
    ds_read_b64_tr_b16 a[34:35], v4 offset:21952
    v_fma_f32 v16, v16, v2, v3
    v_fma_f32 v17, v17, v2, v3
    v_cvt_pk_bf16_f32 v185, v16, v17
    v_lshlrev_b32 v14, 16, v186
    v_and_b32 v15, s75, v186
    v_mfma_f32_32x32x16_bf16 v[48:63], v[160:163], a[4:7], v[48:63]
    s_add_u32 m0, s73, 40960
    ds_read_b64_tr_b16 a[36:37], v4 offset:20736
    ds_read_b64_tr_b16 a[38:39], v4 offset:22016
    buffer_load_dwordx4 v8, s[8:11], s72 offen offset:0 lds
    v_fma_f32 v14, v14, v2, v3
    v_fma_f32 v15, v15, v2, v3
    v_mfma_f32_32x32x16_bf16 v[64:79], v[160:163], a[8:11], v[64:79]
    ds_read_b64_tr_b16 a[0:1], v4 offset:25600
    ds_read_b64_tr_b16 a[2:3], v4 offset:26880
    buffer_load_dwordx4 v9, s[8:11], s72 offen offset:1024 lds
    v_cvt_pk_bf16_f32 v186, v14, v15
    v_lshlrev_b32 v16, 16, v187
    v_mfma_f32_32x32x16_bf16 v[80:95], v[160:163], a[12:15], v[80:95]
    ds_read_b64_tr_b16 a[4:5], v4 offset:25664
    ds_read_b64_tr_b16 a[6:7], v4 offset:26944
    v_and_b32 v17, s75, v187
    v_fma_f32 v16, v16, v2, v3
    v_fma_f32 v17, v17, v2, v3
    v_cvt_pk_bf16_f32 v187, v16, v17
    v_mfma_f32_32x32x16_bf16 a[88:103], v[160:163], a[16:19], a[88:103]
    s_waitcnt lgkmcnt(4)
    ds_read_b64_tr_b16 a[8:9], v4 offset:25728
    ds_read_b64_tr_b16 a[10:11], v4 offset:27008
    v_lshlrev_b32 v14, 16, v188
    v_and_b32 v15, s75, v188
    v_fma_f32 v14, v14, v2, v3
    v_fma_f32 v15, v15, v2, v3
    v_cvt_pk_bf16_f32 v188, v14, v15
    v_mfma_f32_32x32x16_bf16 v[32:47], v[164:167], a[20:23], v[32:47]
    ds_read_b64_tr_b16 a[12:13], v4 offset:25792
    ds_read_b64_tr_b16 a[14:15], v4 offset:27072
    buffer_load_dwordx4 v10, s[8:11], s72 offen offset:2048 lds
    v_lshlrev_b32 v16, 16, v189
    v_and_b32 v17, s75, v189
    v_mfma_f32_32x32x16_bf16 v[48:63], v[164:167], a[24:27], v[48:63]
    ds_read_b64_tr_b16 a[16:17], v4 offset:25856
    ds_read_b64_tr_b16 a[18:19], v4 offset:27136
    v_fma_f32 v16, v16, v2, v3
    v_fma_f32 v17, v17, v2, v3
    v_cvt_pk_bf16_f32 v189, v16, v17
    v_lshlrev_b32 v14, 16, v190
    v_mfma_f32_32x32x16_bf16 v[64:79], v[164:167], a[28:31], v[64:79]
    ds_read_b64_tr_b16 a[20:21], v4 offset:30720
    ds_read_b64_tr_b16 a[22:23], v4 offset:32000
    v_and_b32 v15, s75, v190
    v_fma_f32 v14, v14, v2, v3
    v_fma_f32 v15, v15, v2, v3
    v_cvt_pk_bf16_f32 v190, v14, v15
    v_lshlrev_b32 v16, 16, v191
    v_mfma_f32_32x32x16_bf16 v[80:95], v[164:167], a[32:35], v[80:95]
    ds_read_b64_tr_b16 a[24:25], v4 offset:30784
    ds_read_b64_tr_b16 a[26:27], v4 offset:32064
    buffer_load_dwordx4 v11, s[8:11], s72 offen offset:3072 lds
    v_and_b32 v17, s75, v191
    v_fma_f32 v16, v16, v2, v3
    v_mfma_f32_32x32x16_bf16 a[88:103], v[164:167], a[36:39], a[88:103]
    s_waitcnt lgkmcnt(4)
    ds_read_b64_tr_b16 a[28:29], v4 offset:30848
    ds_read_b64_tr_b16 a[30:31], v4 offset:32128
    v_fma_f32 v17, v17, v2, v3
    v_cvt_pk_bf16_f32 v191, v16, v17
    v_lshlrev_b32 v14, 16, v192
    v_and_b32 v15, s75, v192
    v_mfma_f32_32x32x16_bf16 v[32:47], v[168:171], a[0:3], v[32:47]
    s_add_u32 m0, s73, 45056
    ds_read_b64_tr_b16 a[32:33], v4 offset:30912
    ds_read_b64_tr_b16 a[34:35], v4 offset:32192
    v_fma_f32 v14, v14, v2, v3
    v_fma_f32 v15, v15, v2, v3
    v_cvt_pk_bf16_f32 v192, v14, v15
    v_lshlrev_b32 v16, 16, v193
    v_and_b32 v17, s75, v193
    v_mfma_f32_32x32x16_bf16 v[48:63], v[168:171], a[4:7], v[48:63]
    ds_read_b64_tr_b16 a[36:37], v4 offset:30976
    ds_read_b64_tr_b16 a[38:39], v4 offset:32256
    buffer_load_dwordx4 v12, s[8:11], s72 offen offset:0 lds
    v_add_u32 v4, 4294900736, v4
    v_fma_f32 v16, v16, v2, v3
    v_mfma_f32_32x32x16_bf16 v[64:79], v[168:171], a[8:11], v[64:79]
    s_waitcnt vmcnt(10)
    s_barrier
    ds_read_b64_tr_b16 a[0:1], v4 offset:0
    ds_read_b64_tr_b16 a[2:3], v4 offset:1280
    v_fma_f32 v17, v17, v2, v3
    v_cvt_pk_bf16_f32 v193, v16, v17
    v_lshlrev_b32 v14, 16, v194
    v_mfma_f32_32x32x16_bf16 v[80:95], v[168:171], a[12:15], v[80:95]
    s_add_u32 s72, s72, 245760
    ds_read_b64_tr_b16 a[4:5], v4 offset:64
    ds_read_b64_tr_b16 a[6:7], v4 offset:1344
    v_and_b32 v15, s75, v194
    v_fma_f32 v14, v14, v2, v3
    v_fma_f32 v15, v15, v2, v3
    v_cvt_pk_bf16_f32 v194, v14, v15
    v_lshlrev_b32 v16, 16, v195
    v_mfma_f32_32x32x16_bf16 a[88:103], v[168:171], a[16:19], a[88:103]
    s_waitcnt lgkmcnt(4)
    ds_read_b64_tr_b16 a[8:9], v4 offset:128
    ds_read_b64_tr_b16 a[10:11], v4 offset:1408
    v_and_b32 v17, s75, v195
    v_fma_f32 v16, v16, v2, v3
    v_fma_f32 v17, v17, v2, v3
    v_cvt_pk_bf16_f32 v195, v16, v17
    v_mfma_f32_32x32x16_bf16 v[32:47], v[172:175], a[20:23], v[32:47]
    s_sub_u32 s93, s72, 2457600
    ds_read_b64_tr_b16 a[12:13], v4 offset:192
    ds_read_b64_tr_b16 a[14:15], v4 offset:1472
    v_lshlrev_b32 v14, 16, v196
    v_and_b32 v15, s75, v196
    v_fma_f32 v14, v14, v2, v3
    v_fma_f32 v15, v15, v2, v3
    v_mfma_f32_32x32x16_bf16 v[48:63], v[172:175], a[24:27], v[48:63]
    s_min_u32 s72, s72, s93
    ds_read_b64_tr_b16 a[16:17], v4 offset:256
    ds_read_b64_tr_b16 a[18:19], v4 offset:1536
    v_cvt_pk_bf16_f32 v196, v14, v15
    v_lshlrev_b32 v16, 16, v197
    v_and_b32 v17, s75, v197
    v_fma_f32 v16, v16, v2, v3
    v_fma_f32 v17, v17, v2, v3
    v_mfma_f32_32x32x16_bf16 v[64:79], v[172:175], a[28:31], v[64:79]
    s_add_u32 m0, s73, 61440
    ds_read_b64_tr_b16 a[20:21], v4 offset:5120
    ds_read_b64_tr_b16 a[22:23], v4 offset:6400
    buffer_load_dwordx4 v8, s[8:11], s72 offen offset:0 lds
    v_cvt_pk_bf16_f32 v197, v16, v17
    v_lshlrev_b32 v14, 16, v198
    v_mfma_f32_32x32x16_bf16 v[80:95], v[172:175], a[32:35], v[80:95]
    ds_read_b64_tr_b16 a[24:25], v4 offset:5184
    ds_read_b64_tr_b16 a[26:27], v4 offset:6464
    buffer_load_dwordx4 v9, s[8:11], s72 offen offset:1024 lds
    v_and_b32 v15, s75, v198
    v_fma_f32 v14, v14, v2, v3
    v_mfma_f32_32x32x16_bf16 a[88:103], v[172:175], a[36:39], a[88:103]
    s_waitcnt lgkmcnt(4)
    ds_read_b64_tr_b16 a[28:29], v4 offset:5248
    ds_read_b64_tr_b16 a[30:31], v4 offset:6528
    v_fma_f32 v15, v15, v2, v3
    v_cvt_pk_bf16_f32 v198, v14, v15
    v_lshlrev_b32 v16, 16, v199
    v_and_b32 v17, s75, v199
    v_fma_f32 v16, v16, v2, v3
    v_mfma_f32_32x32x16_bf16 v[32:47], v[176:179], a[0:3], v[32:47]
    ds_read_b64_tr_b16 a[32:33], v4 offset:5312
    ds_read_b64_tr_b16 a[34:35], v4 offset:6592
    v_fma_f32 v17, v17, v2, v3
    v_cvt_pk_bf16_f32 v199, v16, v17
    v_lshlrev_b32 v14, 16, v200
    v_and_b32 v15, s75, v200
    v_mfma_f32_32x32x16_bf16 v[48:63], v[176:179], a[4:7], v[48:63]
    ds_read_b64_tr_b16 a[36:37], v4 offset:5376
    ds_read_b64_tr_b16 a[38:39], v4 offset:6656
    buffer_load_dwordx4 v10, s[8:11], s72 offen offset:2048 lds
    v_fma_f32 v14, v14, v2, v3
    v_fma_f32 v15, v15, v2, v3
    v_mfma_f32_32x32x16_bf16 v[64:79], v[176:179], a[8:11], v[64:79]
    ds_read_b64_tr_b16 a[0:1], v4 offset:10240
    ds_read_b64_tr_b16 a[2:3], v4 offset:11520
    v_cvt_pk_bf16_f32 v200, v14, v15
    v_lshlrev_b32 v16, 16, v201
    v_and_b32 v17, s75, v201
    v_fma_f32 v16, v16, v2, v3
    v_mfma_f32_32x32x16_bf16 v[80:95], v[176:179], a[12:15], v[80:95]
    ds_read_b64_tr_b16 a[4:5], v4 offset:10304
    ds_read_b64_tr_b16 a[6:7], v4 offset:11584
    v_fma_f32 v17, v17, v2, v3
    v_cvt_pk_bf16_f32 v201, v16, v17
    v_lshlrev_b32 v14, 16, v202
    v_and_b32 v15, s75, v202
    v_fma_f32 v14, v14, v2, v3
    v_mfma_f32_32x32x16_bf16 a[88:103], v[176:179], a[16:19], a[88:103]
    s_waitcnt lgkmcnt(4)
    ds_read_b64_tr_b16 a[8:9], v4 offset:10368
    ds_read_b64_tr_b16 a[10:11], v4 offset:11648
    buffer_load_dwordx4 v11, s[8:11], s72 offen offset:3072 lds
    v_fma_f32 v15, v15, v2, v3
    v_cvt_pk_bf16_f32 v202, v14, v15
    v_mfma_f32_32x32x16_bf16 v[32:47], v[180:183], a[20:23], v[32:47]
    s_add_u32 m0, s73, 65536
    ds_read_b64_tr_b16 a[12:13], v4 offset:10432
    ds_read_b64_tr_b16 a[14:15], v4 offset:11712
    v_lshlrev_b32 v16, 16, v203
    v_and_b32 v17, s75, v203
    v_fma_f32 v16, v16, v2, v3
    v_fma_f32 v17, v17, v2, v3
    v_mfma_f32_32x32x16_bf16 v[48:63], v[180:183], a[24:27], v[48:63]
    ds_read_b64_tr_b16 a[16:17], v4 offset:10496
    ds_read_b64_tr_b16 a[18:19], v4 offset:11776
    v_cvt_pk_bf16_f32 v203, v16, v17
    v_lshlrev_b32 v14, 16, v204
    v_and_b32 v15, s75, v204
    v_fma_f32 v14, v14, v2, v3
    v_fma_f32 v15, v15, v2, v3
    v_mfma_f32_32x32x16_bf16 v[64:79], v[180:183], a[28:31], v[64:79]
    ds_read_b64_tr_b16 a[20:21], v4 offset:15360
    ds_read_b64_tr_b16 a[22:23], v4 offset:16640
    buffer_load_dwordx4 v12, s[8:11], s72 offen offset:0 lds
    v_cvt_pk_bf16_f32 v204, v14, v15
    v_lshlrev_b32 v16, 16, v205
    v_mfma_f32_32x32x16_bf16 v[80:95], v[180:183], a[32:35], v[80:95]
    s_add_u32 s72, s72, 245760
    ds_read_b64_tr_b16 a[24:25], v4 offset:15424
    ds_read_b64_tr_b16 a[26:27], v4 offset:16704
    v_and_b32 v17, s75, v205
    v_fma_f32 v16, v16, v2, v3
    v_fma_f32 v17, v17, v2, v3
    v_cvt_pk_bf16_f32 v205, v16, v17
    v_mfma_f32_32x32x16_bf16 a[88:103], v[180:183], a[36:39], a[88:103]
    s_waitcnt lgkmcnt(4)
    ds_read_b64_tr_b16 a[28:29], v4 offset:15488
    ds_read_b64_tr_b16 a[30:31], v4 offset:16768
    v_lshlrev_b32 v14, 16, v206
    v_and_b32 v15, s75, v206
    v_fma_f32 v14, v14, v2, v3
    v_fma_f32 v15, v15, v2, v3
    v_cvt_pk_bf16_f32 v206, v14, v15
    v_mfma_f32_32x32x16_bf16 v[32:47], v[184:187], a[0:3], v[32:47]
    s_sub_u32 s93, s72, 2457600
    ds_read_b64_tr_b16 a[32:33], v4 offset:15552
    ds_read_b64_tr_b16 a[34:35], v4 offset:16832
    v_lshlrev_b32 v16, 16, v207
    v_and_b32 v17, s75, v207
    v_fma_f32 v16, v16, v2, v3
    v_fma_f32 v17, v17, v2, v3
    v_mfma_f32_32x32x16_bf16 v[48:63], v[184:187], a[4:7], v[48:63]
    s_min_u32 s72, s72, s93
    ds_read_b64_tr_b16 a[36:37], v4 offset:15616
    ds_read_b64_tr_b16 a[38:39], v4 offset:16896
    v_cvt_pk_bf16_f32 v207, v16, v17
    v_lshlrev_b32 v14, 16, v208
    v_and_b32 v15, s75, v208
    v_fma_f32 v14, v14, v2, v3
    v_mfma_f32_32x32x16_bf16 v[64:79], v[184:187], a[8:11], v[64:79]
    s_waitcnt vmcnt(10)
    s_barrier
    ds_read_b64_tr_b16 a[0:1], v4 offset:20480
    ds_read_b64_tr_b16 a[2:3], v4 offset:21760
    v_fma_f32 v15, v15, v2, v3
    v_cvt_pk_bf16_f32 v208, v14, v15
    v_lshlrev_b32 v16, 16, v209
    v_and_b32 v17, s75, v209
    v_mfma_f32_32x32x16_bf16 v[80:95], v[184:187], a[12:15], v[80:95]
    s_add_u32 m0, s73, 81920
    ds_read_b64_tr_b16 a[4:5], v4 offset:20544
    ds_read_b64_tr_b16 a[6:7], v4 offset:21824
    buffer_load_dwordx4 v8, s[8:11], s72 offen offset:0 lds
    v_fma_f32 v16, v16, v2, v3
    v_fma_f32 v17, v17, v2, v3
    v_mfma_f32_32x32x16_bf16 a[88:103], v[184:187], a[16:19], a[88:103]
    s_waitcnt lgkmcnt(4)
    ds_read_b64_tr_b16 a[8:9], v4 offset:20608
    ds_read_b64_tr_b16 a[10:11], v4 offset:21888
    buffer_load_dwordx4 v9, s[8:11], s72 offen offset:1024 lds
    v_cvt_pk_bf16_f32 v209, v16, v17
    v_lshlrev_b32 v14, 16, v210
    v_mfma_f32_32x32x16_bf16 v[32:47], v[188:191], a[20:23], v[32:47]
    ds_read_b64_tr_b16 a[12:13], v4 offset:20672
    ds_read_b64_tr_b16 a[14:15], v4 offset:21952
    v_and_b32 v15, s75, v210
    v_fma_f32 v14, v14, v2, v3
    v_fma_f32 v15, v15, v2, v3
    v_cvt_pk_bf16_f32 v210, v14, v15
    v_lshlrev_b32 v16, 16, v211
    v_mfma_f32_32x32x16_bf16 v[48:63], v[188:191], a[24:27], v[48:63]
    ds_read_b64_tr_b16 a[16:17], v4 offset:20736
    ds_read_b64_tr_b16 a[18:19], v4 offset:22016
    buffer_load_dwordx4 v10, s[8:11], s72 offen offset:2048 lds
    v_and_b32 v17, s75, v211
    v_fma_f32 v16, v16, v2, v3
    v_mfma_f32_32x32x16_bf16 v[64:79], v[188:191], a[28:31], v[64:79]
    ds_read_b64_tr_b16 a[20:21], v4 offset:25600
    ds_read_b64_tr_b16 a[22:23], v4 offset:26880
    v_fma_f32 v17, v17, v2, v3
    v_cvt_pk_bf16_f32 v211, v16, v17
    v_lshlrev_b32 v14, 16, v212
    v_and_b32 v15, s75, v212
    v_mfma_f32_32x32x16_bf16 v[80:95], v[188:191], a[32:35], v[80:95]
    ds_read_b64_tr_b16 a[24:25], v4 offset:25664
    ds_read_b64_tr_b16 a[26:27], v4 offset:26944
    v_fma_f32 v14, v14, v2, v3
    v_fma_f32 v15, v15, v2, v3
    v_cvt_pk_bf16_f32 v212, v14, v15
    v_lshlrev_b32 v16, 16, v213
    v_mfma_f32_32x32x16_bf16 a[88:103], v[188:191], a[36:39], a[88:103]
    s_waitcnt lgkmcnt(4)
    ds_read_b64_tr_b16 a[28:29], v4 offset:25728
    ds_read_b64_tr_b16 a[30:31], v4 offset:27008
    v_and_b32 v17, s75, v213
    v_fma_f32 v16, v16, v2, v3
    v_fma_f32 v17, v17, v2, v3
    v_cvt_pk_bf16_f32 v213, v16, v17
    v_lshlrev_b32 v14, 16, v214
    v_mfma_f32_32x32x16_bf16 v[32:47], v[192:195], a[0:3], v[32:47]
    ds_read_b64_tr_b16 a[32:33], v4 offset:25792
    ds_read_b64_tr_b16 a[34:35], v4 offset:27072
    buffer_load_dwordx4 v11, s[8:11], s72 offen offset:3072 lds
    v_and_b32 v15, s75, v214
    v_fma_f32 v14, v14, v2, v3
    v_mfma_f32_32x32x16_bf16 v[48:63], v[192:195], a[4:7], v[48:63]
    s_add_u32 m0, s73, 86016
    ds_read_b64_tr_b16 a[36:37], v4 offset:25856
    ds_read_b64_tr_b16 a[38:39], v4 offset:27136
    v_accvgpr_read_b32 v8, a104
    v_accvgpr_read_b32 v9, a105
    v_accvgpr_read_b32 v10, a106
    v_accvgpr_read_b32 v11, a107
    v_mfma_f32_32x32x16_bf16 v[64:79], v[192:195], a[8:11], v[64:79]
    ds_read_b64_tr_b16 a[0:1], v4 offset:30720
    ds_read_b64_tr_b16 a[2:3], v4 offset:32000
    v_fma_f32 v15, v15, v2, v3
    v_cvt_pk_bf16_f32 v214, v14, v15
    v_lshlrev_b32 v16, 16, v215
    v_and_b32 v17, s75, v215
    v_fma_f32 v16, v16, v2, v3
    v_mfma_f32_32x32x16_bf16 v[80:95], v[192:195], a[12:15], v[80:95]
    ds_read_b64_tr_b16 a[4:5], v4 offset:30784
    ds_read_b64_tr_b16 a[6:7], v4 offset:32064
    buffer_load_dwordx4 v12, s[8:11], s72 offen offset:0 lds
    v_accvgpr_read_b32 v12, a108
    v_fma_f32 v17, v17, v2, v3
    v_mfma_f32_32x32x16_bf16 a[88:103], v[192:195], a[16:19], a[88:103]
    s_waitcnt lgkmcnt(4)
    ds_read_b64_tr_b16 a[8:9], v4 offset:30848
    ds_read_b64_tr_b16 a[10:11], v4 offset:32128
    v_cvt_pk_bf16_f32 v215, v16, v17
    v_lshlrev_b32 v14, 16, v216
    v_and_b32 v15, s75, v216
    v_fma_f32 v14, v14, v2, v3
    v_mfma_f32_32x32x16_bf16 v[32:47], v[196:199], a[20:23], v[32:47]
    s_mov_b32 s72, s50
    ds_read_b64_tr_b16 a[12:13], v4 offset:30912
    ds_read_b64_tr_b16 a[14:15], v4 offset:32192
    v_fma_f32 v15, v15, v2, v3
    v_cvt_pk_bf16_f32 v216, v14, v15
    v_lshlrev_b32 v16, 16, v217
    v_and_b32 v17, s75, v217
    v_fma_f32 v16, v16, v2, v3
    v_mfma_f32_32x32x16_bf16 v[48:63], v[196:199], a[24:27], v[48:63]
    s_add_u32 m0, s73, 0
    ds_read_b64_tr_b16 a[16:17], v4 offset:30976
    ds_read_b64_tr_b16 a[18:19], v4 offset:32256
    v_fma_f32 v17, v17, v2, v3
    v_cvt_pk_bf16_f32 v217, v16, v17
    v_lshlrev_b32 v14, 16, v218
    v_and_b32 v15, s75, v218
    v_mfma_f32_32x32x16_bf16 v[64:79], v[196:199], a[28:31], v[64:79]
    ds_read_b64_tr_b16 a[20:21], v4 offset:35840
    ds_read_b64_tr_b16 a[22:23], v4 offset:37120
    v_fma_f32 v14, v14, v2, v3
    v_fma_f32 v15, v15, v2, v3
    v_cvt_pk_bf16_f32 v218, v14, v15
    v_lshlrev_b32 v16, 16, v219
    v_mfma_f32_32x32x16_bf16 v[80:95], v[196:199], a[32:35], v[80:95]
    ds_read_b64_tr_b16 a[24:25], v4 offset:35904
    ds_read_b64_tr_b16 a[26:27], v4 offset:37184
    v_and_b32 v17, s75, v219
    v_fma_f32 v16, v16, v2, v3
    v_fma_f32 v17, v17, v2, v3
    v_cvt_pk_bf16_f32 v219, v16, v17
L_pg1_1:
    s_cbranch_execz L_pg1_5
    v_lshlrev_b32 v14, 16, v220
    v_mfma_f32_32x32x16_bf16 a[88:103], v[196:199], a[36:39], a[88:103]
    s_waitcnt lgkmcnt(4)
    ds_read_b64_tr_b16 a[28:29], v4 offset:35968
    ds_read_b64_tr_b16 a[30:31], v4 offset:37248
    v_and_b32 v15, s75, v220
    v_fma_f32 v14, v14, v2, v3
    v_fma_f32 v15, v15, v2, v3
    v_cvt_pk_bf16_f32 v220, v14, v15
    v_mfma_f32_32x32x16_bf16 v[32:47], v[200:203], a[0:3], v[32:47]
    ds_read_b64_tr_b16 a[32:33], v4 offset:36032
    ds_read_b64_tr_b16 a[34:35], v4 offset:37312
    v_lshlrev_b32 v16, 16, v221
    v_and_b32 v17, s75, v221
    v_fma_f32 v16, v16, v2, v3
    v_fma_f32 v17, v17, v2, v3
    v_mfma_f32_32x32x16_bf16 v[48:63], v[200:203], a[4:7], v[48:63]
    ds_read_b64_tr_b16 a[36:37], v4 offset:36096
    ds_read_b64_tr_b16 a[38:39], v4 offset:37376
    v_cvt_pk_bf16_f32 v221, v16, v17
    v_lshlrev_b32 v14, 16, v222
    v_and_b32 v15, s75, v222
    v_fma_f32 v14, v14, v2, v3
    v_fma_f32 v15, v15, v2, v3
    v_mfma_f32_32x32x16_bf16 v[64:79], v[200:203], a[8:11], v[64:79]
    s_waitcnt vmcnt(10)
    s_barrier
    ds_read_b64_tr_b16 a[0:1], v4 offset:40960
    ds_read_b64_tr_b16 a[2:3], v4 offset:42240
    buffer_load_dwordx4 v8, s[8:11], s72 offen offset:0 lds
    v_cvt_pk_bf16_f32 v222, v14, v15
    v_mfma_f32_32x32x16_bf16 v[80:95], v[200:203], a[12:15], v[80:95]
    ds_read_b64_tr_b16 a[4:5], v4 offset:41024
    ds_read_b64_tr_b16 a[6:7], v4 offset:42304
    buffer_load_dwordx4 v9, s[8:11], s72 offen offset:1024 lds
    v_lshlrev_b32 v16, 16, v223
    v_and_b32 v17, s75, v223
    v_mfma_f32_32x32x16_bf16 a[88:103], v[200:203], a[16:19], a[88:103]
    s_waitcnt lgkmcnt(4)
    ds_read_b64_tr_b16 a[8:9], v4 offset:41088
    ds_read_b64_tr_b16 a[10:11], v4 offset:42368
    v_fma_f32 v16, v16, v2, v3
    v_fma_f32 v17, v17, v2, v3
    v_cvt_pk_bf16_f32 v223, v16, v17
    v_lshlrev_b32 v14, 16, v224
    v_and_b32 v15, s75, v224
    v_mfma_f32_32x32x16_bf16 v[32:47], v[204:207], a[20:23], v[32:47]
    ds_read_b64_tr_b16 a[12:13], v4 offset:41152
    ds_read_b64_tr_b16 a[14:15], v4 offset:42432
    buffer_load_dwordx4 v10, s[8:11], s72 offen offset:2048 lds
    v_fma_f32 v14, v14, v2, v3
    v_fma_f32 v15, v15, v2, v3
    v_mfma_f32_32x32x16_bf16 v[48:63], v[204:207], a[24:27], v[48:63]
    ds_read_b64_tr_b16 a[16:17], v4 offset:41216
    ds_read_b64_tr_b16 a[18:19], v4 offset:42496
    v_cvt_pk_bf16_f32 v224, v14, v15
    v_lshlrev_b32 v16, 16, v225
    v_and_b32 v17, s75, v225
    v_fma_f32 v16, v16, v2, v3
    v_mfma_f32_32x32x16_bf16 v[64:79], v[204:207], a[28:31], v[64:79]
    ds_read_b64_tr_b16 a[20:21], v4 offset:46080
    ds_read_b64_tr_b16 a[22:23], v4 offset:47360
    v_fma_f32 v17, v17, v2, v3
    v_cvt_pk_bf16_f32 v225, v16, v17
    v_lshlrev_b32 v14, 16, v226
    v_and_b32 v15, s75, v226
    v_mfma_f32_32x32x16_bf16 v[80:95], v[204:207], a[32:35], v[80:95]
    ds_read_b64_tr_b16 a[24:25], v4 offset:46144
    ds_read_b64_tr_b16 a[26:27], v4 offset:47424
    buffer_load_dwordx4 v11, s[8:11], s72 offen offset:3072 lds
    v_fma_f32 v14, v14, v2, v3
    v_fma_f32 v15, v15, v2, v3
    v_cvt_pk_bf16_f32 v226, v14, v15
    v_mfma_f32_32x32x16_bf16 a[88:103], v[204:207], a[36:39], a[88:103]
    s_waitcnt lgkmcnt(4)
    ds_read_b64_tr_b16 a[28:29], v4 offset:46208
    ds_read_b64_tr_b16 a[30:31], v4 offset:47488
    v_lshlrev_b32 v16, 16, v227
    v_and_b32 v17, s75, v227
    v_fma_f32 v16, v16, v2, v3
    v_fma_f32 v17, v17, v2, v3
    v_mfma_f32_32x32x16_bf16 v[32:47], v[208:211], a[0:3], v[32:47]
    s_add_u32 m0, s73, 4096
    ds_read_b64_tr_b16 a[32:33], v4 offset:46272
    ds_read_b64_tr_b16 a[34:35], v4 offset:47552
    v_cvt_pk_bf16_f32 v227, v16, v17
    v_lshlrev_b32 v14, 16, v228
    v_and_b32 v15, s75, v228
    v_fma_f32 v14, v14, v2, v3
    v_mfma_f32_32x32x16_bf16 v[48:63], v[208:211], a[4:7], v[48:63]
    ds_read_b64_tr_b16 a[36:37], v4 offset:46336
    ds_read_b64_tr_b16 a[38:39], v4 offset:47616
    buffer_load_dwordx4 v12, s[8:11], s72 offen offset:0 lds
    v_fma_f32 v15, v15, v2, v3
    v_cvt_pk_bf16_f32 v228, v14, v15
    v_lshlrev_b32 v16, 16, v229
    v_mfma_f32_32x32x16_bf16 v[64:79], v[208:211], a[8:11], v[64:79]
    s_add_u32 s72, s72, 491520
    ds_read_b64_tr_b16 a[0:1], v4 offset:51200
    ds_read_b64_tr_b16 a[2:3], v4 offset:52480
    v_and_b32 v17, s75, v229
    v_fma_f32 v16, v16, v2, v3
    v_fma_f32 v17, v17, v2, v3
    v_cvt_pk_bf16_f32 v229, v16, v17
    v_mfma_f32_32x32x16_bf16 v[80:95], v[208:211], a[12:15], v[80:95]
    s_sub_u32 s93, s72, 2457600
    ds_read_b64_tr_b16 a[4:5], v4 offset:51264
    ds_read_b64_tr_b16 a[6:7], v4 offset:52544
    v_lshlrev_b32 v14, 16, v230
    v_and_b32 v15, s75, v230
    v_fma_f32 v14, v14, v2, v3
    v_fma_f32 v15, v15, v2, v3
    v_mfma_f32_32x32x16_bf16 a[88:103], v[208:211], a[16:19], a[88:103]
    s_waitcnt lgkmcnt(4)
    ds_read_b64_tr_b16 a[8:9], v4 offset:51328
    ds_read_b64_tr_b16 a[10:11], v4 offset:52608
    v_cvt_pk_bf16_f32 v230, v14, v15
    v_lshlrev_b32 v16, 16, v231
    v_and_b32 v17, s75, v231
    v_fma_f32 v16, v16, v2, v3
    v_fma_f32 v17, v17, v2, v3
    v_mfma_f32_32x32x16_bf16 v[32:47], v[212:215], a[20:23], v[32:47]
    s_min_u32 s72, s72, s93
    ds_read_b64_tr_b16 a[12:13], v4 offset:51392
    ds_read_b64_tr_b16 a[14:15], v4 offset:52672
    v_cvt_pk_bf16_f32 v231, v16, v17
    v_lshlrev_b32 v14, 16, v232
    v_and_b32 v15, s75, v232
    v_fma_f32 v14, v14, v2, v3
    v_mfma_f32_32x32x16_bf16 v[48:63], v[212:215], a[24:27], v[48:63]
    s_add_u32 m0, s73, 20480
    ds_read_b64_tr_b16 a[16:17], v4 offset:51456
    ds_read_b64_tr_b16 a[18:19], v4 offset:52736
    v_fma_f32 v15, v15, v2, v3
    v_cvt_pk_bf16_f32 v232, v14, v15
    v_lshlrev_b32 v16, 16, v233
    v_and_b32 v17, s75, v233
    v_mfma_f32_32x32x16_bf16 v[64:79], v[212:215], a[28:31], v[64:79]
    ds_read_b64_tr_b16 a[20:21], v4 offset:56320
    ds_read_b64_tr_b16 a[22:23], v4 offset:57600
    v_fma_f32 v16, v16, v2, v3
    v_fma_f32 v17, v17, v2, v3
    v_cvt_pk_bf16_f32 v233, v16, v17
    v_lshlrev_b32 v14, 16, v234
    v_and_b32 v15, s75, v234
    v_mfma_f32_32x32x16_bf16 v[80:95], v[212:215], a[32:35], v[80:95]
    ds_read_b64_tr_b16 a[24:25], v4 offset:56384
    ds_read_b64_tr_b16 a[26:27], v4 offset:57664
    v_fma_f32 v14, v14, v2, v3
    v_fma_f32 v15, v15, v2, v3
    v_cvt_pk_bf16_f32 v234, v14, v15
    v_lshlrev_b32 v16, 16, v235
    v_mfma_f32_32x32x16_bf16 a[88:103], v[212:215], a[36:39], a[88:103]
    s_waitcnt lgkmcnt(4)
    ds_read_b64_tr_b16 a[28:29], v4 offset:56448
    ds_read_b64_tr_b16 a[30:31], v4 offset:57728
    v_and_b32 v17, s75, v235
    v_fma_f32 v16, v16, v2, v3
    v_fma_f32 v17, v17, v2, v3
    v_cvt_pk_bf16_f32 v235, v16, v17
    v_mfma_f32_32x32x16_bf16 v[32:47], v[216:219], a[0:3], v[32:47]
    ds_read_b64_tr_b16 a[32:33], v4 offset:56512
    ds_read_b64_tr_b16 a[34:35], v4 offset:57792
    v_lshlrev_b32 v14, 16, v236
    v_and_b32 v15, s75, v236
    v_fma_f32 v14, v14, v2, v3
    v_fma_f32 v15, v15, v2, v3
    v_cvt_pk_bf16_f32 v236, v14, v15
    v_mfma_f32_32x32x16_bf16 v[48:63], v[216:219], a[4:7], v[48:63]
    ds_read_b64_tr_b16 a[36:37], v4 offset:56576
    ds_read_b64_tr_b16 a[38:39], v4 offset:57856
    v_lshlrev_b32 v16, 16, v237
    v_and_b32 v17, s75, v237
    v_fma_f32 v16, v16, v2, v3
    v_fma_f32 v17, v17, v2, v3
    v_mfma_f32_32x32x16_bf16 v[64:79], v[216:219], a[8:11], v[64:79]
    s_waitcnt vmcnt(10)
    s_barrier
    ds_read_b64_tr_b16 a[0:1], v4 offset:61440
    ds_read_b64_tr_b16 a[2:3], v4 offset:62720
    buffer_load_dwordx4 v8, s[8:11], s72 offen offset:0 lds
    v_cvt_pk_bf16_f32 v237, v16, v17
    v_mfma_f32_32x32x16_bf16 v[80:95], v[216:219], a[12:15], v[80:95]
    ds_read_b64_tr_b16 a[4:5], v4 offset:61504
    ds_read_b64_tr_b16 a[6:7], v4 offset:62784
    buffer_load_dwordx4 v9, s[8:11], s72 offen offset:1024 lds
    v_lshlrev_b32 v14, 16, v238
    v_and_b32 v15, s75, v238
    v_fma_f32 v14, v14, v2, v3
    v_mfma_f32_32x32x16_bf16 a[88:103], v[216:219], a[16:19], a[88:103]
    s_waitcnt lgkmcnt(4)
    ds_read_b64_tr_b16 a[8:9], v4 offset:61568
    ds_read_b64_tr_b16 a[10:11], v4 offset:62848
    v_fma_f32 v15, v15, v2, v3
    v_cvt_pk_bf16_f32 v238, v14, v15
    v_lshlrev_b32 v16, 16, v239
    v_and_b32 v17, s75, v239
    v_mfma_f32_32x32x16_bf16 v[32:47], v[220:223], a[20:23], v[32:47]
    ds_read_b64_tr_b16 a[12:13], v4 offset:61632
    ds_read_b64_tr_b16 a[14:15], v4 offset:62912
    buffer_load_dwordx4 v10, s[8:11], s72 offen offset:2048 lds
    v_fma_f32 v16, v16, v2, v3
    v_fma_f32 v17, v17, v2, v3
    v_mfma_f32_32x32x16_bf16 v[48:63], v[220:223], a[24:27], v[48:63]
    ds_read_b64_tr_b16 a[16:17], v4 offset:61696
    ds_read_b64_tr_b16 a[18:19], v4 offset:62976
    v_add_u32 v4, 66560, v4
    v_cvt_pk_bf16_f32 v239, v16, v17
    v_lshlrev_b32 v14, 16, v240
    v_and_b32 v15, s75, v240
    v_mfma_f32_32x32x16_bf16 v[64:79], v[220:223], a[28:31], v[64:79]
    ds_read_b64_tr_b16 a[20:21], v4 offset:0
    ds_read_b64_tr_b16 a[22:23], v4 offset:1280
    v_fma_f32 v14, v14, v2, v3
    v_fma_f32 v15, v15, v2, v3
    v_cvt_pk_bf16_f32 v240, v14, v15
    v_lshlrev_b32 v16, 16, v241
    v_and_b32 v17, s75, v241
    v_mfma_f32_32x32x16_bf16 v[80:95], v[220:223], a[32:35], v[80:95]
    ds_read_b64_tr_b16 a[24:25], v4 offset:64
    ds_read_b64_tr_b16 a[26:27], v4 offset:1344
    buffer_load_dwordx4 v11, s[8:11], s72 offen offset:3072 lds
    v_fma_f32 v16, v16, v2, v3
    v_fma_f32 v17, v17, v2, v3
    v_mfma_f32_32x32x16_bf16 a[88:103], v[220:223], a[36:39], a[88:103]
    s_waitcnt lgkmcnt(4)
    ds_read_b64_tr_b16 a[28:29], v4 offset:128
    ds_read_b64_tr_b16 a[30:31], v4 offset:1408
    v_cvt_pk_bf16_f32 v241, v16, v17
    v_lshlrev_b32 v14, 16, v242
    v_and_b32 v15, s75, v242
    v_fma_f32 v14, v14, v2, v3
    v_mfma_f32_32x32x16_bf16 v[32:47], v[224:227], a[0:3], v[32:47]
    s_add_u32 m0, s73, 24576
    ds_read_b64_tr_b16 a[32:33], v4 offset:192
    ds_read_b64_tr_b16 a[34:35], v4 offset:1472
    v_fma_f32 v15, v15, v2, v3
    v_cvt_pk_bf16_f32 v242, v14, v15
    v_lshlrev_b32 v16, 16, v243
    v_and_b32 v17, s75, v243
    v_fma_f32 v16, v16, v2, v3
    v_mfma_f32_32x32x16_bf16 v[48:63], v[224:227], a[4:7], v[48:63]
    ds_read_b64_tr_b16 a[36:37], v4 offset:256
    ds_read_b64_tr_b16 a[38:39], v4 offset:1536
    buffer_load_dwordx4 v12, s[8:11], s72 offen offset:0 lds
    v_fma_f32 v17, v17, v2, v3
    v_cvt_pk_bf16_f32 v243, v16, v17
    v_mfma_f32_32x32x16_bf16 v[64:79], v[224:227], a[8:11], v[64:79]
    s_add_u32 s72, s72, 491520
    ds_read_b64_tr_b16 a[0:1], v4 offset:5120
    ds_read_b64_tr_b16 a[2:3], v4 offset:6400
    v_lshlrev_b32 v14, 16, v244
    v_and_b32 v15, s75, v244
    v_fma_f32 v14, v14, v2, v3
    v_fma_f32 v15, v15, v2, v3
    v_mfma_f32_32x32x16_bf16 v[80:95], v[224:227], a[12:15], v[80:95]
    s_sub_u32 s93, s72, 2457600
    ds_read_b64_tr_b16 a[4:5], v4 offset:5184
    ds_read_b64_tr_b16 a[6:7], v4 offset:6464
    v_cvt_pk_bf16_f32 v244, v14, v15
    v_lshlrev_b32 v16, 16, v245
    v_and_b32 v17, s75, v245
    v_fma_f32 v16, v16, v2, v3
    v_fma_f32 v17, v17, v2, v3
    v_mfma_f32_32x32x16_bf16 a[88:103], v[224:227], a[16:19], a[88:103]
    s_waitcnt lgkmcnt(4)
    ds_read_b64_tr_b16 a[8:9], v4 offset:5248
    ds_read_b64_tr_b16 a[10:11], v4 offset:6528
    v_cvt_pk_bf16_f32 v245, v16, v17
    v_lshlrev_b32 v14, 16, v246
    v_and_b32 v15, s75, v246
    v_fma_f32 v14, v14, v2, v3
    v_mfma_f32_32x32x16_bf16 v[32:47], v[228:231], a[20:23], v[32:47]
    s_min_u32 s72, s72, s93
    ds_read_b64_tr_b16 a[12:13], v4 offset:5312
    ds_read_b64_tr_b16 a[14:15], v4 offset:6592
    v_fma_f32 v15, v15, v2, v3
    v_cvt_pk_bf16_f32 v246, v14, v15
    v_lshlrev_b32 v16, 16, v247
    v_and_b32 v17, s75, v247
    v_mfma_f32_32x32x16_bf16 v[48:63], v[228:231], a[24:27], v[48:63]
    s_add_u32 m0, s73, 40960
    ds_read_b64_tr_b16 a[16:17], v4 offset:5376
    ds_read_b64_tr_b16 a[18:19], v4 offset:6656
    v_fma_f32 v16, v16, v2, v3
    v_fma_f32 v17, v17, v2, v3
    v_cvt_pk_bf16_f32 v247, v16, v17
    v_lshlrev_b32 v14, 16, v248
    v_and_b32 v15, s75, v248
    v_mfma_f32_32x32x16_bf16 v[64:79], v[228:231], a[28:31], v[64:79]
    ds_read_b64_tr_b16 a[20:21], v4 offset:10240
    ds_read_b64_tr_b16 a[22:23], v4 offset:11520
    v_fma_f32 v14, v14, v2, v3
    v_fma_f32 v15, v15, v2, v3
    v_cvt_pk_bf16_f32 v248, v14, v15
    v_lshlrev_b32 v16, 16, v249
    v_mfma_f32_32x32x16_bf16 v[80:95], v[228:231], a[32:35], v[80:95]
    ds_read_b64_tr_b16 a[24:25], v4 offset:10304
    ds_read_b64_tr_b16 a[26:27], v4 offset:11584
    v_and_b32 v17, s75, v249
    v_fma_f32 v16, v16, v2, v3
    v_fma_f32 v17, v17, v2, v3
    v_cvt_pk_bf16_f32 v249, v16, v17
    v_mfma_f32_32x32x16_bf16 a[88:103], v[228:231], a[36:39], a[88:103]
    s_waitcnt lgkmcnt(4)
    ds_read_b64_tr_b16 a[28:29], v4 offset:10368
    ds_read_b64_tr_b16 a[30:31], v4 offset:11648
    v_lshlrev_b32 v14, 16, v250
    v_and_b32 v15, s75, v250
    v_fma_f32 v14, v14, v2, v3
    v_fma_f32 v15, v15, v2, v3
    v_cvt_pk_bf16_f32 v250, v14, v15
    v_mfma_f32_32x32x16_bf16 v[32:47], v[232:235], a[0:3], v[32:47]
    ds_read_b64_tr_b16 a[32:33], v4 offset:10432
    ds_read_b64_tr_b16 a[34:35], v4 offset:11712
    v_lshlrev_b32 v16, 16, v251
    v_and_b32 v17, s75, v251
    v_fma_f32 v16, v16, v2, v3
    v_fma_f32 v17, v17, v2, v3
    v_mfma_f32_32x32x16_bf16 v[48:63], v[232:235], a[4:7], v[48:63]
    ds_read_b64_tr_b16 a[36:37], v4 offset:10496
    ds_read_b64_tr_b16 a[38:39], v4 offset:11776
    v_cvt_pk_bf16_f32 v251, v16, v17
    v_lshlrev_b32 v14, 16, v252
    v_and_b32 v15, s75, v252
    v_fma_f32 v14, v14, v2, v3
    v_mfma_f32_32x32x16_bf16 v[64:79], v[232:235], a[8:11], v[64:79]
    s_waitcnt vmcnt(10)
    s_barrier
    ds_read_b64_tr_b16 a[0:1], v4 offset:15360
    ds_read_b64_tr_b16 a[2:3], v4 offset:16640
    buffer_load_dwordx4 v8, s[8:11], s72 offen offset:0 lds
    v_fma_f32 v15, v15, v2, v3
    v_mfma_f32_32x32x16_bf16 v[80:95], v[232:235], a[12:15], v[80:95]
    ds_read_b64_tr_b16 a[4:5], v4 offset:15424
    ds_read_b64_tr_b16 a[6:7], v4 offset:16704
    buffer_load_dwordx4 v9, s[8:11], s72 offen offset:1024 lds
    v_cvt_pk_bf16_f32 v252, v14, v15
    v_lshlrev_b32 v16, 16, v253
    v_and_b32 v17, s75, v253
    v_mfma_f32_32x32x16_bf16 a[88:103], v[232:235], a[16:19], a[88:103]
    s_waitcnt lgkmcnt(4)
    ds_read_b64_tr_b16 a[8:9], v4 offset:15488
    ds_read_b64_tr_b16 a[10:11], v4 offset:16768
    v_fma_f32 v16, v16, v2, v3
    v_fma_f32 v17, v17, v2, v3
    v_cvt_pk_bf16_f32 v253, v16, v17
    v_lshlrev_b32 v14, 16, v254
    v_mfma_f32_32x32x16_bf16 v[32:47], v[236:239], a[20:23], v[32:47]
    ds_read_b64_tr_b16 a[12:13], v4 offset:15552
    ds_read_b64_tr_b16 a[14:15], v4 offset:16832
    buffer_load_dwordx4 v10, s[8:11], s72 offen offset:2048 lds
    v_and_b32 v15, s75, v254
    v_fma_f32 v14, v14, v2, v3
    v_mfma_f32_32x32x16_bf16 v[48:63], v[236:239], a[24:27], v[48:63]
    ds_read_b64_tr_b16 a[16:17], v4 offset:15616
    ds_read_b64_tr_b16 a[18:19], v4 offset:16896
    v_fma_f32 v15, v15, v2, v3
    v_cvt_pk_bf16_f32 v254, v14, v15
    v_lshlrev_b32 v16, 16, v255
    v_and_b32 v17, s75, v255
    v_fma_f32 v16, v16, v2, v3
    v_mfma_f32_32x32x16_bf16 v[64:79], v[236:239], a[28:31], v[64:79]
    ds_read_b64_tr_b16 a[20:21], v4 offset:20480
    ds_read_b64_tr_b16 a[22:23], v4 offset:21760
    v_fma_f32 v17, v17, v2, v3
    v_cvt_pk_bf16_f32 v255, v16, v17
    v_mfma_f32_32x32x16_bf16 v[80:95], v[236:239], a[32:35], v[80:95]
    ds_read_b64_tr_b16 a[24:25], v4 offset:20544
    ds_read_b64_tr_b16 a[26:27], v4 offset:21824
    buffer_load_dwordx4 v11, s[8:11], s72 offen offset:3072 lds
    v_mfma_f32_32x32x16_bf16 a[88:103], v[236:239], a[36:39], a[88:103]
    s_waitcnt lgkmcnt(4)
    ds_read_b64_tr_b16 a[28:29], v4 offset:20608
    ds_read_b64_tr_b16 a[30:31], v4 offset:21888
    v_mfma_f32_32x32x16_bf16 v[32:47], v[240:243], a[0:3], v[32:47]
    s_add_u32 m0, s73, 45056
    ds_read_b64_tr_b16 a[32:33], v4 offset:20672
    ds_read_b64_tr_b16 a[34:35], v4 offset:21952
    v_mfma_f32_32x32x16_bf16 v[48:63], v[240:243], a[4:7], v[48:63]
    ds_read_b64_tr_b16 a[36:37], v4 offset:20736
    ds_read_b64_tr_b16 a[38:39], v4 offset:22016
    buffer_load_dwordx4 v12, s[8:11], s72 offen offset:0 lds
    v_mfma_f32_32x32x16_bf16 v[64:79], v[240:243], a[8:11], v[64:79]
    s_add_u32 s72, s72, 491520
    ds_read_b64_tr_b16 a[0:1], v4 offset:25600
    ds_read_b64_tr_b16 a[2:3], v4 offset:26880
    v_mfma_f32_32x32x16_bf16 v[80:95], v[240:243], a[12:15], v[80:95]
    s_sub_u32 s93, s72, 2457600
    ds_read_b64_tr_b16 a[4:5], v4 offset:25664
    ds_read_b64_tr_b16 a[6:7], v4 offset:26944
    v_mfma_f32_32x32x16_bf16 a[88:103], v[240:243], a[16:19], a[88:103]
    s_waitcnt lgkmcnt(4)
    ds_read_b64_tr_b16 a[8:9], v4 offset:25728
    ds_read_b64_tr_b16 a[10:11], v4 offset:27008
    v_mfma_f32_32x32x16_bf16 v[32:47], v[244:247], a[20:23], v[32:47]
    s_min_u32 s72, s72, s93
    ds_read_b64_tr_b16 a[12:13], v4 offset:25792
    ds_read_b64_tr_b16 a[14:15], v4 offset:27072
    v_mfma_f32_32x32x16_bf16 v[48:63], v[244:247], a[24:27], v[48:63]
    s_add_u32 m0, s73, 61440
    ds_read_b64_tr_b16 a[16:17], v4 offset:25856
    ds_read_b64_tr_b16 a[18:19], v4 offset:27136
    v_mfma_f32_32x32x16_bf16 v[64:79], v[244:247], a[28:31], v[64:79]
    ds_read_b64_tr_b16 a[20:21], v4 offset:30720
    ds_read_b64_tr_b16 a[22:23], v4 offset:32000
    v_mfma_f32_32x32x16_bf16 v[80:95], v[244:247], a[32:35], v[80:95]
    ds_read_b64_tr_b16 a[24:25], v4 offset:30784
    ds_read_b64_tr_b16 a[26:27], v4 offset:32064
    v_mfma_f32_32x32x16_bf16 a[88:103], v[244:247], a[36:39], a[88:103]
    s_waitcnt lgkmcnt(4)
    ds_read_b64_tr_b16 a[28:29], v4 offset:30848
    ds_read_b64_tr_b16 a[30:31], v4 offset:32128
    v_mfma_f32_32x32x16_bf16 v[32:47], v[248:251], a[0:3], v[32:47]
    ds_read_b64_tr_b16 a[32:33], v4 offset:30912
    ds_read_b64_tr_b16 a[34:35], v4 offset:32192
    v_mfma_f32_32x32x16_bf16 v[48:63], v[248:251], a[4:7], v[48:63]
    ds_read_b64_tr_b16 a[36:37], v4 offset:30976
    ds_read_b64_tr_b16 a[38:39], v4 offset:32256
    v_add_u32 v4, 4294900736, v4
    v_mfma_f32_32x32x16_bf16 v[64:79], v[248:251], a[8:11], v[64:79]
    s_waitcnt vmcnt(10)
    s_barrier
    ds_read_b64_tr_b16 a[0:1], v4 offset:0
    ds_read_b64_tr_b16 a[2:3], v4 offset:1280
    buffer_load_dwordx4 v8, s[8:11], s72 offen offset:0 lds
    v_mfma_f32_32x32x16_bf16 v[80:95], v[248:251], a[12:15], v[80:95]
    ds_read_b64_tr_b16 a[4:5], v4 offset:64
    ds_read_b64_tr_b16 a[6:7], v4 offset:1344
    buffer_load_dwordx4 v9, s[8:11], s72 offen offset:1024 lds
    v_mfma_f32_32x32x16_bf16 a[88:103], v[248:251], a[16:19], a[88:103]
    s_waitcnt lgkmcnt(4)
    ds_read_b64_tr_b16 a[8:9], v4 offset:128
    ds_read_b64_tr_b16 a[10:11], v4 offset:1408
    v_mfma_f32_32x32x16_bf16 v[32:47], v[252:255], a[20:23], v[32:47]
    ds_read_b64_tr_b16 a[12:13], v4 offset:5120
    ds_read_b64_tr_b16 a[14:15], v4 offset:6400
    buffer_load_dwordx4 v10, s[8:11], s72 offen offset:2048 lds
    v_accvgpr_read_b32 v23, a111
    v_mfma_f32_32x32x16_bf16 v[48:63], v[252:255], a[24:27], v[48:63]
    ds_read_b64_tr_b16 a[16:17], v4 offset:5184
    ds_read_b64_tr_b16 a[18:19], v4 offset:6464
    v_mfma_f32_32x32x16_bf16 v[64:79], v[252:255], a[28:31], v[64:79]
    ds_read_b64_tr_b16 a[20:21], v4 offset:5248
    ds_read_b64_tr_b16 a[22:23], v4 offset:6528
    v_mfma_f32_32x32x16_bf16 v[80:95], v[252:255], a[32:35], v[80:95]
    ds_read_b64_tr_b16 a[24:25], v4 offset:160
    ds_read_b64_tr_b16 a[26:27], v4 offset:1440
    buffer_load_dwordx4 v11, s[8:11], s72 offen offset:3072 lds
    v_mfma_f32_32x32x16_bf16 a[88:103], v[252:255], a[36:39], a[88:103]
    s_waitcnt lgkmcnt(8)
    ds_read_b64_tr_b16 a[28:29], v4 offset:224
    ds_read_b64_tr_b16 a[30:31], v4 offset:1504
    v_mfma_f32_32x32x16_bf16 a[40:55], a[0:3], v[96:99], 0
    s_add_u32 m0, s73, 65536
    ds_read_b64_tr_b16 a[32:33], v4 offset:288
    ds_read_b64_tr_b16 a[34:35], v4 offset:1568
    v_mov_b32 v14, s74
    v_mov_b32 v15, s74
    v_mov_b32 v16, s74
    v_mov_b32 v17, s74
    v_cvt_pk_bf16_f32 v80, v80, v81
    v_cvt_pk_bf16_f32 v81, v82, v83
    v_cvt_pk_bf16_f32 v82, v84, v85
    v_cvt_pk_bf16_f32 v83, v86, v87
    v_cvt_pk_bf16_f32 v88, v88, v89
    v_cvt_pk_bf16_f32 v89, v90, v91
    v_cvt_pk_bf16_f32 v90, v92, v93
    v_cvt_pk_bf16_f32 v91, v94, v95
    v_mfma_f32_32x32x16_bf16 a[56:71], a[4:7], v[96:99], 0
    ds_read_b64_tr_b16 a[36:37], v4 offset:5280
    ds_read_b64_tr_b16 a[38:39], v4 offset:6560
    buffer_load_dwordx4 v12, s[8:11], s72 offen offset:0 lds
    ds_write_b128 v28, v[14:17] offset:2560
    ds_write_b128 v5, v[80:83] offset:1536
    v_exp_f32_e64 v14, v32 clamp
    v_exp_f32_e64 v15, v33 clamp
    v_exp_f32_e64 v16, v34 clamp
    v_exp_f32_e64 v17, v35 clamp
    v_max_f32 v32, s78, v32
    v_max_f32 v33, s78, v33
    v_max_f32 v34, s78, v34
    v_max_f32 v35, s78, v35
    v_fma_f32 v32, v32, s77, v14
    v_fma_f32 v33, v33, s77, v15
    v_fma_f32 v34, v34, s77, v16
    v_fma_f32 v35, v35, s77, v17
    v_exp_f32_e64 v14, v36 clamp
    v_exp_f32_e64 v15, v37 clamp
    v_exp_f32_e64 v16, v38 clamp
    v_mfma_f32_32x32x16_bf16 a[72:87], a[8:11], v[96:99], 0
    s_waitcnt lgkmcnt(10)
    ds_read_b64_tr_b16 a[0:1], v4 offset:5344
    ds_read_b64_tr_b16 a[2:3], v4 offset:6624
    buffer_load_dword v22, v23, s[12:15], 0 offen sc1
    ds_write_b128 v5, v[88:91] offset:6784
    v_exp_f32_e64 v17, v39 clamp
    v_max_f32 v36, s78, v36
    v_max_f32 v37, s78, v37
    v_max_f32 v38, s78, v38
    v_max_f32 v39, s78, v39
    v_fma_f32 v36, v36, s77, v14
    v_fma_f32 v37, v37, s77, v15
    v_fma_f32 v38, v38, s77, v16
    v_fma_f32 v39, v39, s77, v17
    v_cvt_pk_bf16_f32 v32, v32, v33
    v_cvt_pk_bf16_f32 v33, v34, v35
    v_cvt_pk_bf16_f32 v34, v36, v37
    v_cvt_pk_bf16_f32 v35, v38, v39
    v_exp_f32_e64 v14, v40 clamp
    v_exp_f32_e64 v15, v41 clamp
    v_mfma_f32_32x32x16_bf16 a[40:55], a[12:15], v[100:103], a[40:55]
    s_add_u32 s72, s72, 491520
    ds_read_b64_tr_b16 a[4:5], v4 offset:5408
    ds_read_b64_tr_b16 a[6:7], v4 offset:6688
    ds_write_b128 v5, v[32:35] offset:0
    v_exp_f32_e64 v16, v42 clamp
    v_exp_f32_e64 v17, v43 clamp
    v_max_f32 v40, s78, v40
    v_max_f32 v41, s78, v41
    v_max_f32 v42, s78, v42
    v_max_f32 v43, s78, v43
    v_fma_f32 v40, v40, s77, v14
    v_fma_f32 v41, v41, s77, v15
    v_fma_f32 v42, v42, s77, v16
    v_fma_f32 v43, v43, s77, v17
    v_exp_f32_e64 v14, v44 clamp
    v_exp_f32_e64 v15, v45 clamp
    v_exp_f32_e64 v16, v46 clamp
    v_exp_f32_e64 v17, v47 clamp
    v_max_f32 v44, s78, v44
    v_mfma_f32_32x32x16_bf16 a[56:71], a[16:19], v[100:103], a[56:71]
    s_sub_u32 s93, s72, 2457600
    ds_read_b64_tr_b16 a[8:9], v4 offset:10240
    ds_read_b64_tr_b16 a[10:11], v4 offset:11520
    v_max_f32 v45, s78, v45
    v_max_f32 v46, s78, v46
    v_max_f32 v47, s78, v47
    v_fma_f32 v44, v44, s77, v14
    v_fma_f32 v45, v45, s77, v15
    v_fma_f32 v46, v46, s77, v16
    v_fma_f32 v47, v47, s77, v17
    v_cvt_pk_bf16_f32 v40, v40, v41
    v_cvt_pk_bf16_f32 v41, v42, v43
    v_cvt_pk_bf16_f32 v42, v44, v45
    v_cvt_pk_bf16_f32 v43, v46, v47
    v_exp_f32_e64 v14, v48 clamp
    v_exp_f32_e64 v15, v49 clamp
    v_exp_f32_e64 v16, v50 clamp
    v_exp_f32_e64 v17, v51 clamp
    v_max_f32 v48, s78, v48
    v_max_f32 v49, s78, v49
    v_mfma_f32_32x32x16_bf16 a[72:87], a[20:23], v[100:103], a[72:87]
    s_waitcnt lgkmcnt(12)
    ds_read_b64_tr_b16 a[12:13], v4 offset:10304
    ds_read_b64_tr_b16 a[14:15], v4 offset:11584
    ds_write_b128 v5, v[40:43] offset:5248
    v_max_f32 v50, s78, v50
    v_max_f32 v51, s78, v51
    v_fma_f32 v48, v48, s77, v14
    v_fma_f32 v49, v49, s77, v15
    v_fma_f32 v50, v50, s77, v16
    v_fma_f32 v51, v51, s77, v17
    v_exp_f32_e64 v14, v52 clamp
    v_exp_f32_e64 v15, v53 clamp
    v_exp_f32_e64 v16, v54 clamp
    v_exp_f32_e64 v17, v55 clamp
    v_max_f32 v52, s78, v52
    v_max_f32 v53, s78, v53
    v_max_f32 v54, s78, v54
    v_max_f32 v55, s78, v55
    v_fma_f32 v52, v52, s77, v14
    v_fma_f32 v53, v53, s77, v15
    v_mfma_f32_32x32x16_bf16 a[40:55], a[24:27], v[104:107], a[40:55]
    s_min_u32 s72, s72, s93
    ds_read_b64_tr_b16 a[16:17], v4 offset:10368
L_pg1_2:
    s_cbranch_execz L_pgret1
    ds_read_b64_tr_b16 a[18:19], v4 offset:11648
    v_fma_f32 v54, v54, s77, v16
    v_fma_f32 v55, v55, s77, v17
    v_cvt_pk_bf16_f32 v48, v48, v49
    v_cvt_pk_bf16_f32 v49, v50, v51
    v_cvt_pk_bf16_f32 v50, v52, v53
    v_cvt_pk_bf16_f32 v51, v54, v55
    v_exp_f32_e64 v14, v56 clamp
    v_exp_f32_e64 v15, v57 clamp
    v_exp_f32_e64 v16, v58 clamp
    v_exp_f32_e64 v17, v59 clamp
    v_max_f32 v56, s78, v56
    v_max_f32 v57, s78, v57
    v_max_f32 v58, s78, v58
    v_max_f32 v59, s78, v59
    v_fma_f32 v56, v56, s77, v14
    v_fma_f32 v57, v57, s77, v15
    v_fma_f32 v58, v58, s77, v16
    v_mfma_f32_32x32x16_bf16 a[56:71], a[28:31], v[104:107], a[56:71]
    s_add_u32 m0, s73, 81920
    ds_read_b64_tr_b16 a[20:21], v4 offset:15360
    ds_read_b64_tr_b16 a[22:23], v4 offset:16640
    ds_write_b128 v5, v[48:51] offset:512
    v_fma_f32 v59, v59, s77, v17
    v_exp_f32_e64 v14, v60 clamp
    v_exp_f32_e64 v15, v61 clamp
    v_exp_f32_e64 v16, v62 clamp
    v_exp_f32_e64 v17, v63 clamp
    v_max_f32 v60, s78, v60
    v_max_f32 v61, s78, v61
    v_max_f32 v62, s78, v62
    v_max_f32 v63, s78, v63
    v_fma_f32 v60, v60, s77, v14
    v_fma_f32 v61, v61, s77, v15
    v_fma_f32 v62, v62, s77, v16
    v_fma_f32 v63, v63, s77, v17
    v_cvt_pk_bf16_f32 v56, v56, v57
    v_cvt_pk_bf16_f32 v57, v58, v59
    v_cvt_pk_bf16_f32 v58, v60, v61
    v_mfma_f32_32x32x16_bf16 a[72:87], a[32:35], v[104:107], a[72:87]
    s_waitcnt lgkmcnt(11)
    ds_read_b64_tr_b16 a[24:25], v4 offset:15424
    ds_read_b64_tr_b16 a[26:27], v4 offset:16704
    v_cvt_pk_bf16_f32 v59, v62, v63
    v_exp_f32_e64 v14, v64 clamp
    v_exp_f32_e64 v15, v65 clamp
    v_exp_f32_e64 v16, v66 clamp
    v_exp_f32_e64 v17, v67 clamp
    v_max_f32 v18, s78, v64
    v_max_f32 v19, s78, v65
    v_max_f32 v20, s78, v66
    v_max_f32 v21, s78, v67
    v_fma_f32 v14, v18, s77, v14
    v_fma_f32 v15, v19, s77, v15
    v_fma_f32 v16, v20, s77, v16
    v_fma_f32 v17, v21, s77, v17
    v_cndmask_b32 v64, v64, v14, s[94:95]
    v_cndmask_b32 v65, v65, v15, s[94:95]
    v_cndmask_b32 v66, v66, v16, s[94:95]
    v_cndmask_b32 v67, v67, v17, s[94:95]
    v_mfma_f32_32x32x16_bf16 a[40:55], a[36:39], v[108:111], a[40:55]
    ds_read_b64_tr_b16 a[28:29], v4 offset:15488
    ds_read_b64_tr_b16 a[30:31], v4 offset:16768
    ds_write_b128 v5, v[56:59] offset:5760
    v_exp_f32_e64 v14, v68 clamp
    v_exp_f32_e64 v15, v69 clamp
    v_exp_f32_e64 v16, v70 clamp
    v_exp_f32_e64 v17, v71 clamp
    v_max_f32 v18, s78, v68
    v_max_f32 v19, s78, v69
    v_max_f32 v20, s78, v70
    v_max_f32 v21, s78, v71
    v_fma_f32 v14, v18, s77, v14
    v_fma_f32 v15, v19, s77, v15
    v_fma_f32 v16, v20, s77, v16
    v_fma_f32 v17, v21, s77, v17
    v_cndmask_b32 v68, v68, v14, s[94:95]
    v_cndmask_b32 v69, v69, v15, s[94:95]
    v_cndmask_b32 v70, v70, v16, s[94:95]
    v_cndmask_b32 v71, v71, v17, s[94:95]
    v_mfma_f32_32x32x16_bf16 a[56:71], a[0:3], v[108:111], a[56:71]
    ds_read_b64_tr_b16 a[32:33], v4 offset:10400
    ds_read_b64_tr_b16 a[34:35], v4 offset:11680
    v_cvt_pk_bf16_f32 v64, v64, v65
    v_cvt_pk_bf16_f32 v65, v66, v67
    v_cvt_pk_bf16_f32 v66, v68, v69
    v_cvt_pk_bf16_f32 v67, v70, v71
    v_exp_f32_e64 v14, v72 clamp
    v_exp_f32_e64 v15, v73 clamp
    v_exp_f32_e64 v16, v74 clamp
    v_exp_f32_e64 v17, v75 clamp
    v_max_f32 v18, s78, v72
    v_max_f32 v19, s78, v73
    v_max_f32 v20, s78, v74
    v_max_f32 v21, s78, v75
    v_fma_f32 v14, v18, s77, v14
    v_fma_f32 v15, v19, s77, v15
    v_fma_f32 v16, v20, s77, v16
    v_fma_f32 v17, v21, s77, v17
    v_cndmask_b32 v72, v72, v14, s[94:95]
    v_mfma_f32_32x32x16_bf16 a[72:87], a[4:7], v[108:111], a[72:87]
    s_waitcnt lgkmcnt(10)
    ds_read_b64_tr_b16 a[36:37], v4 offset:10464
    ds_read_b64_tr_b16 a[38:39], v4 offset:11744
    ds_write_b128 v5, v[64:67] offset:1024
    v_cndmask_b32 v73, v73, v15, s[94:95]
    v_cndmask_b32 v74, v74, v16, s[94:95]
    v_cndmask_b32 v75, v75, v17, s[94:95]
    v_exp_f32_e64 v14, v76 clamp
    v_exp_f32_e64 v15, v77 clamp
    v_exp_f32_e64 v16, v78 clamp
    v_exp_f32_e64 v17, v79 clamp
    v_max_f32 v18, s78, v76
    v_max_f32 v19, s78, v77
    v_max_f32 v20, s78, v78
    v_max_f32 v21, s78, v79
    v_fma_f32 v14, v18, s77, v14
    v_fma_f32 v15, v19, s77, v15
    v_fma_f32 v16, v20, s77, v16
    v_fma_f32 v17, v21, s77, v17
    v_cndmask_b32 v76, v76, v14, s[94:95]
    v_mfma_f32_32x32x16_bf16 a[40:55], a[8:11], v[112:115], a[40:55]
    ds_read_b64_tr_b16 a[0:1], v4 offset:10528
    ds_read_b64_tr_b16 a[2:3], v4 offset:11808
    v_cndmask_b32 v77, v77, v15, s[94:95]
    v_cndmask_b32 v78, v78, v16, s[94:95]
    v_cndmask_b32 v79, v79, v17, s[94:95]
    v_cvt_pk_bf16_f32 v72, v72, v73
    v_cvt_pk_bf16_f32 v73, v74, v75
    v_cvt_pk_bf16_f32 v74, v76, v77
    v_cvt_pk_bf16_f32 v75, v78, v79
    v_accvgpr_read_b32 v80, a88
    v_accvgpr_read_b32 v81, a89
    v_accvgpr_read_b32 v82, a90
    v_accvgpr_read_b32 v83, a91
    v_accvgpr_read_b32 v84, a92
    v_accvgpr_read_b32 v85, a93
    v_accvgpr_read_b32 v86, a94
    v_accvgpr_read_b32 v87, a95
    v_cvt_pk_bf16_f32 v80, v80, v81
    v_cvt_pk_bf16_f32 v81, v82, v83
    v_cvt_pk_bf16_f32 v82, v84, v85
    v_cvt_pk_bf16_f32 v83, v86, v87
    v_accvgpr_read_b32 v88, a96
    v_accvgpr_read_b32 v89, a97
    v_mfma_f32_32x32x16_bf16 a[56:71], a[12:15], v[112:115], a[56:71]
    ds_read_b64_tr_b16 a[4:5], v4 offset:15520
    ds_read_b64_tr_b16 a[6:7], v4 offset:16800
    ds_write_b128 v5, v[72:75] offset:6272
    ds_write_b128 v5, v[80:83] offset:2048
    v_accvgpr_read_b32 v90, a98
    v_accvgpr_read_b32 v91, a99
    v_accvgpr_read_b32 v92, a100
    v_accvgpr_read_b32 v93, a101
    v_accvgpr_read_b32 v94, a102
    v_accvgpr_read_b32 v95, a103
    v_cvt_pk_bf16_f32 v88, v88, v89
    v_cvt_pk_bf16_f32 v89, v90, v91
    v_cvt_pk_bf16_f32 v90, v92, v93
    v_cvt_pk_bf16_f32 v91, v94, v95
    v_mfma_f32_32x32x16_bf16 a[72:87], a[16:19], v[112:115], a[72:87]
    s_waitcnt lgkmcnt(12)
    ds_read_b64_tr_b16 a[8:9], v4 offset:15584
    ds_read_b64_tr_b16 a[10:11], v4 offset:16864
    ds_write_b128 v5, v[88:91] offset:7296
    v_mfma_f32_32x32x16_bf16 a[40:55], a[20:23], v[116:119], a[40:55]
    ds_read_b64_tr_b16 a[12:13], v4 offset:15648
    ds_read_b64_tr_b16 a[14:15], v4 offset:16928
    v_mfma_f32_32x32x16_bf16 a[56:71], a[24:27], v[116:119], a[56:71]
    s_waitcnt vmcnt(6)
    s_barrier
    ds_read_b64_tr_b16 a[16:17], v4 offset:20480
    ds_read_b64_tr_b16 a[18:19], v4 offset:21760
    buffer_load_dwordx4 v8, s[8:11], s72 offen offset:0 lds
    v_mfma_f32_32x32x16_bf16 a[72:87], a[28:31], v[116:119], a[72:87]
    s_waitcnt lgkmcnt(11)
    ds_read_b64_tr_b16 a[20:21], v4 offset:20544
    ds_read_b64_tr_b16 a[22:23], v4 offset:21824
    buffer_load_dwordx4 v9, s[8:11], s72 offen offset:1024 lds
    v_mfma_f32_32x32x16_bf16 a[40:55], a[32:35], v[120:123], a[40:55]
    s_waitcnt lgkmcnt(6)
    s_barrier
    ds_read_b64_tr_b16 a[24:25], v4 offset:20608
    ds_read_b64_tr_b16 a[26:27], v4 offset:21888
    ds_read_b128 v[48:51], v7 offset:0
    ds_read_b128 v[52:55], v6 offset:0
    v_mfma_f32_32x32x16_bf16 a[56:71], a[36:39], v[120:123], a[56:71]
    s_waitcnt vmcnt(2)
    v_cmp_ne_u32 vcc, 1, v22
    s_cbranch_vccnz L_spin7
L_back7:
    ds_read_b64_tr_b16 a[28:29], v4 offset:25600
    ds_read_b64_tr_b16 a[30:31], v4 offset:26880
    buffer_load_dwordx4 v10, s[8:11], s72 offen offset:2048 lds
    ds_read_b128 v[56:59], v7 offset:5248
    ds_read_b128 v[60:63], v6 offset:5248
    v_mfma_f32_32x32x16_bf16 a[72:87], a[0:3], v[120:123], a[72:87]
    s_waitcnt lgkmcnt(12)
    ds_read_b64_tr_b16 a[32:33], v4 offset:25664
    ds_read_b64_tr_b16 a[34:35], v4 offset:26944
    ds_read_b128 v[64:67], v7 offset:10496
    ds_read_b128 v[68:71], v6 offset:10496
    v_mfma_f32_32x32x16_bf16 a[40:55], a[4:7], v[124:127], a[40:55]
    ds_read_b64_tr_b16 a[36:37], v4 offset:25728
    ds_read_b64_tr_b16 a[38:39], v4 offset:27008
    ds_read_b128 v[72:75], v7 offset:15744
    ds_read_b128 v[76:79], v6 offset:15744
    s_waitcnt lgkmcnt(12)
    v_mfma_f32_32x32x16_bf16 v[32:47], v[48:51], v[52:55], 0
    buffer_load_dwordx4 v11, s[8:11], s72 offen offset:3072 lds
    ds_read_b128 v[80:83], v7 offset:20992
    ds_read_b128 v[84:87], v6 offset:20992
    v_mfma_f32_32x32x16_bf16 a[56:71], a[8:11], v[124:127], a[56:71]
    s_add_u32 m0, s73, 86016
    ds_read_b64_tr_b16 a[0:1], v4 offset:20640
    ds_read_b64_tr_b16 a[2:3], v4 offset:21920
    s_waitcnt lgkmcnt(12)
    v_mfma_f32_32x32x16_bf16 v[32:47], v[56:59], v[60:63], v[32:47]
    ds_read_b128 v[88:91], v7 offset:26240
    ds_read_b128 v[92:95], v6 offset:26240
    v_mfma_f32_32x32x16_bf16 a[72:87], a[12:15], v[124:127], a[72:87]
    ds_read_b64_tr_b16 a[4:5], v4 offset:20704
    ds_read_b64_tr_b16 a[6:7], v4 offset:21984
    buffer_load_dwordx4 v12, s[8:11], s72 offen offset:0 lds
    s_waitcnt lgkmcnt(12)
    v_mfma_f32_32x32x16_bf16 v[32:47], v[64:67], v[68:71], v[32:47]
    ds_read_b128 v[48:51], v7 offset:31488
    ds_read_b128 v[52:55], v6 offset:31488
    v_mfma_f32_32x32x16_bf16 a[40:55], a[16:19], v[128:131], a[40:55]
    ds_read_b64_tr_b16 a[8:9], v4 offset:20768
    ds_read_b64_tr_b16 a[10:11], v4 offset:22048
    s_waitcnt lgkmcnt(12)
    v_mfma_f32_32x32x16_bf16 v[32:47], v[72:75], v[76:79], v[32:47]
    ds_read_b128 v[56:59], v7 offset:36736
    ds_read_b128 v[60:63], v6 offset:36736
    v_mfma_f32_32x32x16_bf16 a[56:71], a[20:23], v[128:131], a[56:71]
    ds_read_b64_tr_b16 a[12:13], v4 offset:25760
    ds_read_b64_tr_b16 a[14:15], v4 offset:27040
    buffer_load_dwordx4 a[128:131], v1, s[12:15], s49 offen offset:0 sc1
    s_waitcnt lgkmcnt(14)
    v_mfma_f32_32x32x16_bf16 v[32:47], v[80:83], v[84:87], v[32:47]
    v_mfma_f32_32x32x16_bf16 a[72:87], a[24:27], v[128:131], a[72:87]
    ds_read_b64_tr_b16 a[16:17], v4 offset:25824
    ds_read_b64_tr_b16 a[18:19], v4 offset:27104
    buffer_load_dwordx4 a[132:135], v1, s[12:15], s49 offen offset:1024 sc1
    s_waitcnt lgkmcnt(12)
    v_mfma_f32_32x32x16_bf16 v[32:47], v[88:91], v[92:95], v[32:47]
    v_mfma_f32_32x32x16_bf16 a[40:55], a[28:31], v[132:135], a[40:55]
    ds_read_b64_tr_b16 a[20:21], v4 offset:25888
    ds_read_b64_tr_b16 a[22:23], v4 offset:27168
    buffer_load_dwordx4 a[136:139], v1, s[12:15], s49 offen offset:2048 sc1
    s_waitcnt lgkmcnt(10)
    v_mfma_f32_32x32x16_bf16 v[32:47], v[48:51], v[52:55], v[32:47]
    v_mfma_f32_32x32x16_bf16 a[56:71], a[32:35], v[132:135], a[56:71]
    ds_read_b64_tr_b16 a[24:25], v4 offset:30720
    ds_read_b64_tr_b16 a[26:27], v4 offset:32000
    buffer_load_dwordx4 a[140:143], v1, s[12:15], s49 offen offset:3072 sc1
    s_waitcnt lgkmcnt(8)
    v_mfma_f32_32x32x16_bf16 v[32:47], v[56:59], v[60:63], v[32:47]
    s_add_u32 s49, s49, 4096
    v_mfma_f32_32x32x16_bf16 a[72:87], a[36:39], v[132:135], a[72:87]
    ds_read_b64_tr_b16 a[28:29], v4 offset:30784
    ds_read_b64_tr_b16 a[30:31], v4 offset:32064
    buffer_load_dwordx4 a[144:147], v1, s[12:15], s49 offen offset:0 sc1
    v_mfma_f32_32x32x16_bf16 a[40:55], a[0:3], v[136:139], a[40:55]
    ds_read_b64_tr_b16 a[32:33], v4 offset:30848
    ds_read_b64_tr_b16 a[34:35], v4 offset:32128
    v_mfma_f32_32x32x16_bf16 a[56:71], a[4:7], v[136:139], a[56:71]
    ds_read_b64_tr_b16 a[36:37], v4 offset:35840
    ds_read_b64_tr_b16 a[38:39], v4 offset:37120
    buffer_load_dwordx4 a[148:151], v1, s[12:15], s49 offen offset:1024 sc1
    v_mfma_f32_32x32x16_bf16 a[72:87], a[8:11], v[136:139], a[72:87]
    s_waitcnt lgkmcnt(8)
    ds_read_b64_tr_b16 a[0:1], v4 offset:35904
    ds_read_b64_tr_b16 a[2:3], v4 offset:37184
    buffer_atomic_add_f32 v32, v26, s[12:15], s48 offen offset:0
    v_mfma_f32_32x32x16_bf16 a[40:55], a[12:15], v[140:143], a[40:55]
    ds_read_b64_tr_b16 a[4:5], v4 offset:35968
    ds_read_b64_tr_b16 a[6:7], v4 offset:37248
    buffer_atomic_add_f32 v33, v26, s[12:15], s48 offen offset:128
    v_mfma_f32_32x32x16_bf16 a[56:71], a[16:19], v[140:143], a[56:71]
    ds_read_b64_tr_b16 a[8:9], v4 offset:30880
    ds_read_b64_tr_b16 a[10:11], v4 offset:32160
    buffer_atomic_add_f32 v34, v26, s[12:15], s48 offen offset:256
    v_mfma_f32_32x32x16_bf16 a[72:87], a[20:23], v[140:143], a[72:87]
    s_waitcnt lgkmcnt(8)
    ds_read_b64_tr_b16 a[12:13], v4 offset:30944
    ds_read_b64_tr_b16 a[14:15], v4 offset:32224
    buffer_atomic_add_f32 v35, v26, s[12:15], s48 offen offset:384
    v_mfma_f32_32x32x16_bf16 a[40:55], a[24:27], v[144:147], a[40:55]
    ds_read_b64_tr_b16 a[16:17], v4 offset:31008
    ds_read_b64_tr_b16 a[18:19], v4 offset:32288
    buffer_atomic_add_f32 v36, v26, s[12:15], s48 offen offset:1024
    v_mfma_f32_32x32x16_bf16 a[56:71], a[28:31], v[144:147], a[56:71]
    ds_read_b64_tr_b16 a[20:21], v4 offset:36000
    ds_read_b64_tr_b16 a[22:23], v4 offset:37280
    buffer_atomic_add_f32 v37, v26, s[12:15], s48 offen offset:1152
    v_mfma_f32_32x32x16_bf16 a[72:87], a[32:35], v[144:147], a[72:87]
    s_waitcnt lgkmcnt(8)
    ds_read_b64_tr_b16 a[24:25], v4 offset:36064
    ds_read_b64_tr_b16 a[26:27], v4 offset:37344
    buffer_atomic_add_f32 v38, v26, s[12:15], s48 offen offset:1280
    v_mfma_f32_32x32x16_bf16 a[40:55], a[36:39], v[148:151], a[40:55]
    ds_read_b64_tr_b16 a[28:29], v4 offset:36128
    ds_read_b64_tr_b16 a[30:31], v4 offset:37408
    buffer_atomic_add_f32 v39, v26, s[12:15], s48 offen offset:1408
    v_mfma_f32_32x32x16_bf16 a[56:71], a[0:3], v[148:151], a[56:71]
    ds_read_b64_tr_b16 a[32:33], v4 offset:40960
    ds_read_b64_tr_b16 a[34:35], v4 offset:42240
    buffer_atomic_add_f32 v40, v26, s[12:15], s48 offen offset:2048
    v_mfma_f32_32x32x16_bf16 a[72:87], a[4:7], v[148:151], a[72:87]
    s_waitcnt lgkmcnt(8)
    ds_read_b64_tr_b16 a[36:37], v4 offset:41024
    ds_read_b64_tr_b16 a[38:39], v4 offset:42304
    buffer_atomic_add_f32 v41, v27, s[12:15], s48 offen offset:2176
    v_mfma_f32_32x32x16_bf16 a[40:55], a[8:11], v[152:155], a[40:55]
    ds_read_b64_tr_b16 a[0:1], v4 offset:41088
    ds_read_b64_tr_b16 a[2:3], v4 offset:42368
    buffer_atomic_add_f32 v42, v27, s[12:15], s48 offen offset:2304
    v_mfma_f32_32x32x16_bf16 a[56:71], a[12:15], v[152:155], a[56:71]
    ds_read_b64_tr_b16 a[4:5], v4 offset:46080
    ds_read_b64_tr_b16 a[6:7], v4 offset:47360
    buffer_atomic_add_f32 v43, v27, s[12:15], s48 offen offset:2432
    v_mfma_f32_32x32x16_bf16 a[72:87], a[16:19], v[152:155], a[72:87]
    s_waitcnt lgkmcnt(8)
    ds_read_b64_tr_b16 a[8:9], v4 offset:46144
    ds_read_b64_tr_b16 a[10:11], v4 offset:47424
    buffer_load_dwordx4 a[152:155], v1, s[12:15], s49 offen offset:2048 sc1
    v_mfma_f32_32x32x16_bf16 a[40:55], a[20:23], v[156:159], a[40:55]
    ds_read_b64_tr_b16 a[12:13], v4 offset:46208
    ds_read_b64_tr_b16 a[14:15], v4 offset:47488
    buffer_load_dwordx4 a[156:159], v1, s[12:15], s49 offen offset:3072 sc1
    v_mfma_f32_32x32x16_bf16 a[56:71], a[24:27], v[156:159], a[56:71]
    s_add_u32 s49, s49, 4096
    ds_read_b64_tr_b16 a[16:17], v4 offset:41120
    ds_read_b64_tr_b16 a[18:19], v4 offset:42400
    buffer_load_dwordx4 a[160:163], v1, s[12:15], s49 offen offset:0 sc1
    v_mfma_f32_32x32x16_bf16 a[72:87], a[28:31], v[156:159], a[72:87]
    s_waitcnt lgkmcnt(8)
    ds_read_b64_tr_b16 a[20:21], v4 offset:41184
    ds_read_b64_tr_b16 a[22:23], v4 offset:42464
    buffer_load_dwordx4 a[164:167], v1, s[12:15], s49 offen offset:1024 sc1
    v_mfma_f32_32x32x16_bf16 a[40:55], a[32:35], v[160:163], a[40:55]
    s_add_u32 s49, s49, 12288
    ds_read_b64_tr_b16 a[24:25], v4 offset:41248
    ds_read_b64_tr_b16 a[26:27], v4 offset:42528
    v_mfma_f32_32x32x16_bf16 a[56:71], a[36:39], v[160:163], a[56:71]
    ds_read_b64_tr_b16 a[28:29], v4 offset:46240
    ds_read_b64_tr_b16 a[30:31], v4 offset:47520
    buffer_load_dwordx4 a[168:171], v1, s[12:15], s49 offen offset:0 sc1
    v_mfma_f32_32x32x16_bf16 a[72:87], a[0:3], v[160:163], a[72:87]
    s_waitcnt lgkmcnt(8)
    ds_read_b64_tr_b16 a[32:33], v4 offset:46304
    ds_read_b64_tr_b16 a[34:35], v4 offset:47584
    v_mfma_f32_32x32x16_bf16 a[40:55], a[4:7], v[164:167], a[40:55]
    ds_read_b64_tr_b16 a[36:37], v4 offset:46368
    ds_read_b64_tr_b16 a[38:39], v4 offset:47648
    buffer_load_dwordx4 a[172:175], v1, s[12:15], s49 offen offset:1024 sc1
    v_mfma_f32_32x32x16_bf16 a[56:71], a[8:11], v[164:167], a[56:71]
    ds_read_b64_tr_b16 a[0:1], v4 offset:51200
    ds_read_b64_tr_b16 a[2:3], v4 offset:52480
    v_mfma_f32_32x32x16_bf16 a[72:87], a[12:15], v[164:167], a[72:87]
    s_waitcnt lgkmcnt(8)
    ds_read_b64_tr_b16 a[4:5], v4 offset:51264
    ds_read_b64_tr_b16 a[6:7], v4 offset:52544
    buffer_load_dwordx4 a[176:179], v1, s[12:15], s49 offen offset:2048 sc1
    v_mfma_f32_32x32x16_bf16 a[40:55], a[16:19], v[168:171], a[40:55]
    ds_read_b64_tr_b16 a[8:9], v4 offset:51328
    ds_read_b64_tr_b16 a[10:11], v4 offset:52608
    v_mfma_f32_32x32x16_bf16 a[56:71], a[20:23], v[168:171], a[56:71]
    ds_read_b64_tr_b16 a[12:13], v4 offset:56320
    ds_read_b64_tr_b16 a[14:15], v4 offset:57600
    buffer_load_dwordx4 a[180:183], v1, s[12:15], s49 offen offset:3072 sc1
    v_mfma_f32_32x32x16_bf16 a[72:87], a[24:27], v[168:171], a[72:87]
    s_waitcnt lgkmcnt(8)
    ds_read_b64_tr_b16 a[16:17], v4 offset:56384
    ds_read_b64_tr_b16 a[18:19], v4 offset:57664
    v_mfma_f32_32x32x16_bf16 a[40:55], a[28:31], v[172:175], a[40:55]
    s_add_u32 s49, s49, 4096
    ds_read_b64_tr_b16 a[20:21], v4 offset:56448
    ds_read_b64_tr_b16 a[22:23], v4 offset:57728
    buffer_load_dwordx4 a[184:187], v1, s[12:15], s49 offen offset:0 sc1
    v_mfma_f32_32x32x16_bf16 a[56:71], a[32:35], v[172:175], a[56:71]
    ds_read_b64_tr_b16 a[24:25], v4 offset:51360
    ds_read_b64_tr_b16 a[26:27], v4 offset:52640
    v_mfma_f32_32x32x16_bf16 a[72:87], a[36:39], v[172:175], a[72:87]
    s_waitcnt lgkmcnt(8)
    ds_read_b64_tr_b16 a[28:29], v4 offset:51424
    ds_read_b64_tr_b16 a[30:31], v4 offset:52704
    buffer_load_dwordx4 a[188:191], v1, s[12:15], s49 offen offset:1024 sc1
    v_mfma_f32_32x32x16_bf16 a[40:55], a[0:3], v[176:179], a[40:55]
    ds_read_b64_tr_b16 a[32:33], v4 offset:51488
    ds_read_b64_tr_b16 a[34:35], v4 offset:52768
    v_mfma_f32_32x32x16_bf16 a[56:71], a[4:7], v[176:179], a[56:71]
    ds_read_b64_tr_b16 a[36:37], v4 offset:56480
    ds_read_b64_tr_b16 a[38:39], v4 offset:57760
    buffer_load_dwordx4 a[192:195], v1, s[12:15], s49 offen offset:2048 sc1
    v_mfma_f32_32x32x16_bf16 a[72:87], a[8:11], v[176:179], a[72:87]
    s_waitcnt lgkmcnt(8)
    ds_read_b64_tr_b16 a[0:1], v4 offset:56544
    ds_read_b64_tr_b16 a[2:3], v4 offset:57824
    v_mfma_f32_32x32x16_bf16 a[40:55], a[12:15], v[180:183], a[40:55]
    s_waitcnt vmcnt(11)
    ds_read_b64_tr_b16 a[4:5], v4 offset:56608
    ds_read_b64_tr_b16 a[6:7], v4 offset:57888
    buffer_load_dwordx4 a[196:199], v1, s[12:15], s49 offen offset:3072 sc1
    v_mov_b32 v20, 1
    v_mfma_f32_32x32x16_bf16 a[56:71], a[16:19], v[180:183], a[56:71]
    s_barrier
    ds_read_b64_tr_b16 a[8:9], v4 offset:61440
    ds_read_b64_tr_b16 a[10:11], v4 offset:62720
    buffer_atomic_add v20, v30, s[12:15], s47 offen sc1
    v_accvgpr_read_b32 v5, a253
    v_accvgpr_read_b32 v7, a254
    v_accvgpr_read_b32 v12, a255
    v_mfma_f32_32x32x16_bf16 a[72:87], a[20:23], v[180:183], a[72:87]
    s_waitcnt lgkmcnt(8)
    ds_read_b64_tr_b16 a[12:13], v4 offset:61504
    ds_read_b64_tr_b16 a[14:15], v4 offset:62784
    v_mfma_f32_32x32x16_bf16 a[40:55], a[24:27], v[184:187], a[40:55]
    s_add_u32 s49, s49, 4096
    ds_read_b64_tr_b16 a[16:17], v4 offset:61568
    ds_read_b64_tr_b16 a[18:19], v4 offset:62848
    buffer_load_dwordx4 a[200:203], v1, s[12:15], s49 offen offset:0 sc1
    v_add_u32 v4, 66560, v4
    v_mfma_f32_32x32x16_bf16 a[56:71], a[28:31], v[184:187], a[56:71]
    ds_read_b64_tr_b16 a[20:21], v4 offset:0
    ds_read_b64_tr_b16 a[22:23], v4 offset:1280
    buffer_load_dwordx4 a[204:207], v1, s[12:15], s49 offen offset:1024 sc1
    v_mfma_f32_32x32x16_bf16 a[72:87], a[32:35], v[184:187], a[72:87]
    s_waitcnt lgkmcnt(8)
    ds_read_b64_tr_b16 a[24:25], v4 offset:64
    ds_read_b64_tr_b16 a[26:27], v4 offset:1344
    v_mfma_f32_32x32x16_bf16 a[40:55], a[36:39], v[188:191], a[40:55]
    s_add_u32 s49, s49, 4294948864
    ds_read_b64_tr_b16 a[28:29], v4 offset:128
    ds_read_b64_tr_b16 a[30:31], v4 offset:1408
    buffer_load_dwordx4 a[208:211], v1, s[12:15], s49 offen offset:0 sc1
    v_add_u32 v4, 4294900736, v4
    v_mfma_f32_32x32x16_bf16 a[56:71], a[0:3], v[188:191], a[56:71]
    ds_read_b64_tr_b16 a[32:33], v4 offset:61600
    ds_read_b64_tr_b16 a[34:35], v4 offset:62880
    v_mfma_f32_32x32x16_bf16 a[72:87], a[4:7], v[188:191], a[72:87]
    s_waitcnt lgkmcnt(8)
    ds_read_b64_tr_b16 a[36:37], v4 offset:61664
    ds_read_b64_tr_b16 a[38:39], v4 offset:62944
    buffer_load_dwordx4 a[212:215], v1, s[12:15], s49 offen offset:1024 sc1
    v_mfma_f32_32x32x16_bf16 a[40:55], a[8:11], v[192:195], a[40:55]
    ds_read_b64_tr_b16 a[0:1], v4 offset:61728
    ds_read_b64_tr_b16 a[2:3], v4 offset:63008
    v_add_u32 v4, 66720, v4
    v_mfma_f32_32x32x16_bf16 a[56:71], a[12:15], v[192:195], a[56:71]
    ds_read_b64_tr_b16 a[4:5], v4 offset:0
    ds_read_b64_tr_b16 a[6:7], v4 offset:1280
    buffer_load_dwordx4 a[216:219], v1, s[12:15], s49 offen offset:2048 sc1
    v_mfma_f32_32x32x16_bf16 a[72:87], a[16:19], v[192:195], a[72:87]
    s_waitcnt lgkmcnt(8)
    ds_read_b64_tr_b16 a[8:9], v4 offset:64
    ds_read_b64_tr_b16 a[10:11], v4 offset:1344
    v_mfma_f32_32x32x16_bf16 a[40:55], a[20:23], v[196:199], a[40:55]
    ds_read_b64_tr_b16 a[12:13], v4 offset:128
    ds_read_b64_tr_b16 a[14:15], v4 offset:1408
    buffer_load_dwordx4 a[220:223], v1, s[12:15], s49 offen offset:3072 sc1
    v_mfma_f32_32x32x16_bf16 a[56:71], a[24:27], v[196:199], a[56:71]
    s_add_u32 s49, s49, 4096
    ds_read_b64_tr_b16 a[16:17], v4 offset:4960
    ds_read_b64_tr_b16 a[18:19], v4 offset:6240
    v_mfma_f32_32x32x16_bf16 a[72:87], a[28:31], v[196:199], a[72:87]
    s_waitcnt lgkmcnt(8)
    ds_read_b64_tr_b16 a[20:21], v4 offset:5024
    ds_read_b64_tr_b16 a[22:23], v4 offset:6304
    buffer_load_dwordx4 a[224:227], v1, s[12:15], s49 offen offset:0 sc1
    v_mfma_f32_32x32x16_bf16 a[40:55], a[32:35], v[200:203], a[40:55]
    ds_read_b64_tr_b16 a[24:25], v4 offset:5088
    ds_read_b64_tr_b16 a[26:27], v4 offset:6368
    v_mfma_f32_32x32x16_bf16 a[56:71], a[36:39], v[200:203], a[56:71]
    ds_read_b64_tr_b16 a[28:29], v4 offset:10080
    ds_read_b64_tr_b16 a[30:31], v4 offset:11360
    buffer_load_dwordx4 a[228:231], v1, s[12:15], s49 offen offset:1024 sc1
    v_mfma_f32_32x32x16_bf16 a[72:87], a[0:3], v[200:203], a[72:87]
    s_waitcnt lgkmcnt(8)
    ds_read_b64_tr_b16 a[32:33], v4 offset:10144
    ds_read_b64_tr_b16 a[34:35], v4 offset:11424
    v_mfma_f32_32x32x16_bf16 a[40:55], a[4:7], v[204:207], a[40:55]
    ds_read_b64_tr_b16 a[36:37], v4 offset:10208
    ds_read_b64_tr_b16 a[38:39], v4 offset:11488
    buffer_load_dwordx4 a[232:235], v1, s[12:15], s49 offen offset:2048 sc1
    v_mfma_f32_32x32x16_bf16 a[56:71], a[8:11], v[204:207], a[56:71]
    ds_read_b64_tr_b16 a[0:1], v4 offset:5120
    ds_read_b64_tr_b16 a[2:3], v4 offset:6400
    v_mfma_f32_32x32x16_bf16 a[72:87], a[12:15], v[204:207], a[72:87]
    s_waitcnt lgkmcnt(8)
    ds_read_b64_tr_b16 a[4:5], v4 offset:5184
    ds_read_b64_tr_b16 a[6:7], v4 offset:6464
    buffer_load_dwordx4 a[236:239], v1, s[12:15], s49 offen offset:3072 sc1
    v_mfma_f32_32x32x16_bf16 a[40:55], a[16:19], v[208:211], a[40:55]
    s_add_u32 s49, s49, 4096
    ds_read_b64_tr_b16 a[8:9], v4 offset:5248
    ds_read_b64_tr_b16 a[10:11], v4 offset:6528
    v_mfma_f32_32x32x16_bf16 a[56:71], a[20:23], v[208:211], a[56:71]
    ds_read_b64_tr_b16 a[12:13], v4 offset:10240
    ds_read_b64_tr_b16 a[14:15], v4 offset:11520
    buffer_load_dwordx4 a[240:243], v1, s[12:15], s49 offen offset:0 sc1
    v_mfma_f32_32x32x16_bf16 a[72:87], a[24:27], v[208:211], a[72:87]
    s_waitcnt lgkmcnt(8)
    ds_read_b64_tr_b16 a[16:17], v4 offset:10304
    ds_read_b64_tr_b16 a[18:19], v4 offset:11584
    v_mfma_f32_32x32x16_bf16 a[40:55], a[28:31], v[212:215], a[40:55]
    ds_read_b64_tr_b16 a[20:21], v4 offset:10368
    ds_read_b64_tr_b16 a[22:23], v4 offset:11648
    buffer_load_dwordx4 a[244:247], v1, s[12:15], s49 offen offset:1024 sc1
    v_mfma_f32_32x32x16_bf16 a[56:71], a[32:35], v[212:215], a[56:71]
    s_add_u32 s49, s49, 12288
    ds_read_b64_tr_b16 a[24:25], v4 offset:15200
    ds_read_b64_tr_b16 a[26:27], v4 offset:16480
    v_mfma_f32_32x32x16_bf16 a[72:87], a[36:39], v[212:215], a[72:87]
    s_waitcnt lgkmcnt(8)
    ds_read_b64_tr_b16 a[28:29], v4 offset:15264
    ds_read_b64_tr_b16 a[30:31], v4 offset:16544
    buffer_load_dwordx4 v[96:99], v1, s[12:15], s49 offen offset:0 sc1
    v_mfma_f32_32x32x16_bf16 a[40:55], a[0:3], v[216:219], a[40:55]
    ds_read_b64_tr_b16 a[32:33], v4 offset:15328
    ds_read_b64_tr_b16 a[34:35], v4 offset:16608
    v_mfma_f32_32x32x16_bf16 a[56:71], a[4:7], v[216:219], a[56:71]
    ds_read_b64_tr_b16 a[36:37], v4 offset:20320
    ds_read_b64_tr_b16 a[38:39], v4 offset:21600
    buffer_load_dwordx4 v[100:103], v1, s[12:15], s49 offen offset:1024 sc1
    v_mfma_f32_32x32x16_bf16 a[72:87], a[8:11], v[216:219], a[72:87]
    s_waitcnt lgkmcnt(8)
    ds_read_b64_tr_b16 a[0:1], v4 offset:20384
    ds_read_b64_tr_b16 a[2:3], v4 offset:21664
    v_mfma_f32_32x32x16_bf16 a[40:55], a[12:15], v[220:223], a[40:55]
    ds_read_b64_tr_b16 a[4:5], v4 offset:20448
    ds_read_b64_tr_b16 a[6:7], v4 offset:21728
    buffer_load_dwordx4 v[104:107], v1, s[12:15], s49 offen offset:2048 sc1
    v_mfma_f32_32x32x16_bf16 a[56:71], a[16:19], v[220:223], a[56:71]
    ds_read_b64_tr_b16 a[8:9], v4 offset:15360
    ds_read_b64_tr_b16 a[10:11], v4 offset:16640
    v_mfma_f32_32x32x16_bf16 a[72:87], a[20:23], v[220:223], a[72:87]
    s_waitcnt lgkmcnt(8)
    ds_read_b64_tr_b16 a[12:13], v4 offset:15424
    ds_read_b64_tr_b16 a[14:15], v4 offset:16704
    v_mfma_f32_32x32x16_bf16 a[40:55], a[24:27], v[224:227], a[40:55]
    ds_read_b64_tr_b16 a[16:17], v4 offset:15488
    ds_read_b64_tr_b16 a[18:19], v4 offset:16768
    buffer_load_dwordx4 v[108:111], v1, s[12:15], s49 offen offset:3072 sc1
    v_mov_b32 v6, 0
    v_mov_b32 v3, 0
L_pg1_3:
    s_cbranch_execz L_pgret1
    v_accvgpr_read_b32 v8, a248
    v_accvgpr_read_b32 v9, a249
    v_accvgpr_read_b32 v10, a250
    v_accvgpr_read_b32 v11, a251
    v_mfma_f32_32x32x16_bf16 a[56:71], a[28:31], v[224:227], a[56:71]
    s_add_u32 s49, s49, 4096
    ds_read_b64_tr_b16 a[20:21], v4 offset:20480
    ds_read_b64_tr_b16 a[22:23], v4 offset:21760
    buffer_atomic_add v6, v30, s[12:15], s47 offen sc0 sc1
    v_mfma_f32_32x32x16_bf16 a[72:87], a[32:35], v[224:227], a[72:87]
    s_waitcnt lgkmcnt(8)
    ds_read_b64_tr_b16 a[24:25], v4 offset:20544
    ds_read_b64_tr_b16 a[26:27], v4 offset:21824
    buffer_atomic_add v3, v30, s[12:15], s88 offen sc0 sc1
    v_mfma_f32_32x32x16_bf16 a[40:55], a[36:39], v[228:231], a[40:55]
    ds_read_b64_tr_b16 a[28:29], v4 offset:20608
    ds_read_b64_tr_b16 a[30:31], v4 offset:21888
    buffer_load_dwordx4 v[112:115], v1, s[12:15], s49 offen offset:0 sc1
    v_mfma_f32_32x32x16_bf16 a[56:71], a[0:3], v[228:231], a[56:71]
    ds_read_b64_tr_b16 a[32:33], v4 offset:25440
    ds_read_b64_tr_b16 a[34:35], v4 offset:26720
    buffer_load_dwordx4 v[116:119], v1, s[12:15], s49 offen offset:1024 sc1
    v_mfma_f32_32x32x16_bf16 a[72:87], a[4:7], v[228:231], a[72:87]
    s_waitcnt lgkmcnt(8)
    ds_read_b64_tr_b16 a[36:37], v4 offset:25504
    ds_read_b64_tr_b16 a[38:39], v4 offset:26784
    buffer_load_dwordx4 v[120:123], v1, s[12:15], s49 offen offset:2048 sc1
    v_mfma_f32_32x32x16_bf16 a[40:55], a[8:11], v[232:235], a[40:55]
    ds_read_b64_tr_b16 a[0:1], v4 offset:25568
    ds_read_b64_tr_b16 a[2:3], v4 offset:26848
    v_mfma_f32_32x32x16_bf16 a[56:71], a[12:15], v[232:235], a[56:71]
    ds_read_b64_tr_b16 a[4:5], v4 offset:30560
    ds_read_b64_tr_b16 a[6:7], v4 offset:31840
    buffer_load_dwordx4 v[124:127], v1, s[12:15], s49 offen offset:3072 sc1
    v_mfma_f32_32x32x16_bf16 a[72:87], a[16:19], v[232:235], a[72:87]
    s_waitcnt lgkmcnt(8)
    ds_read_b64_tr_b16 a[8:9], v4 offset:30624
    ds_read_b64_tr_b16 a[10:11], v4 offset:31904
    v_mfma_f32_32x32x16_bf16 a[40:55], a[20:23], v[236:239], a[40:55]
    s_add_u32 s49, s49, 4096
    ds_read_b64_tr_b16 a[12:13], v4 offset:30688
    ds_read_b64_tr_b16 a[14:15], v4 offset:31968
    buffer_load_dwordx4 v[128:131], v1, s[12:15], s49 offen offset:0 sc1
    v_mfma_f32_32x32x16_bf16 a[56:71], a[24:27], v[236:239], a[56:71]
    ds_read_b64_tr_b16 a[16:17], v4 offset:25600
    ds_read_b64_tr_b16 a[18:19], v4 offset:26880
    v_mfma_f32_32x32x16_bf16 a[72:87], a[28:31], v[236:239], a[72:87]
    s_waitcnt lgkmcnt(8)
    ds_read_b64_tr_b16 a[20:21], v4 offset:25664
    ds_read_b64_tr_b16 a[22:23], v4 offset:26944
    buffer_load_dwordx4 v[132:135], v1, s[12:15], s49 offen offset:1024 sc1
    v_mfma_f32_32x32x16_bf16 a[40:55], a[32:35], v[240:243], a[40:55]
    s_add_u32 s49, s49, s28
    ds_read_b64_tr_b16 a[24:25], v4 offset:25728
    ds_read_b64_tr_b16 a[26:27], v4 offset:27008
    v_mfma_f32_32x32x16_bf16 a[56:71], a[36:39], v[240:243], a[56:71]
    ds_read_b64_tr_b16 a[28:29], v4 offset:30720
    ds_read_b64_tr_b16 a[30:31], v4 offset:32000
    buffer_load_dwordx4 v[136:139], v1, s[12:15], s49 offen offset:2048 sc1
    v_mfma_f32_32x32x16_bf16 a[72:87], a[0:3], v[240:243], a[72:87]
    s_waitcnt lgkmcnt(8)
    ds_read_b64_tr_b16 a[32:33], v4 offset:30784
    ds_read_b64_tr_b16 a[34:35], v4 offset:32064
    v_mfma_f32_32x32x16_bf16 a[40:55], a[4:7], v[244:247], a[40:55]
    ds_read_b64_tr_b16 a[36:37], v4 offset:30848
    ds_read_b64_tr_b16 a[38:39], v4 offset:32128
    buffer_load_dwordx4 v[140:143], v1, s[12:15], s49 offen offset:3072 sc1
    v_mfma_f32_32x32x16_bf16 a[56:71], a[8:11], v[244:247], a[56:71]
    s_waitcnt vmcnt(8)
    v_cmp_ne_u32 vcc, 4, v3
    s_nop 0
    s_bitcmp1_b32 vcc_lo, 0
    s_cbranch_scc1 L_spin8
L_back8:
    v_mfma_f32_32x32x16_bf16 a[72:87], a[12:15], v[244:247], a[72:87]
    s_waitcnt lgkmcnt(6)
    buffer_load_dwordx4 v[196:199], v8, s[12:15], s80 offen offset:0 sc1
    v_mfma_f32_32x32x16_bf16 a[40:55], a[16:19], v[248:251], a[40:55]
    v_cmp_ne_u32 vcc, 16, v6
    s_nop 0
    s_bitcmp1_b32 vcc_lo, 0
    s_cbranch_scc1 L_spin9
L_back9:
    buffer_load_dwordx4 v[84:87], v1, s[12:15], s48 offen offset:0 sc1
    v_mfma_f32_32x32x16_bf16 a[56:71], a[20:23], v[248:251], a[56:71]
    s_add_u32 s49, s49, 4096
    buffer_load_dwordx4 v[88:91], v1, s[12:15], s48 offen offset:1024 sc1
    v_mfma_f32_32x32x16_bf16 a[72:87], a[24:27], v[248:251], a[72:87]
    s_waitcnt lgkmcnt(0)
    buffer_load_dwordx4 v[92:95], v1, s[12:15], s48 offen offset:2048 sc1
    v_mfma_f32_32x32x16_bf16 a[40:55], a[28:31], v[252:255], a[40:55]
    v_mfma_f32_32x32x16_bf16 a[56:71], a[32:35], v[252:255], a[56:71]
    v_mfma_f32_32x32x16_bf16 a[72:87], a[36:39], v[252:255], a[72:87]
    buffer_load_dwordx4 v[200:203], v9, s[12:15], s80 offen offset:0 sc1
    buffer_load_dwordx4 v[204:207], v10, s[12:15], s80 offen offset:0 sc1
    buffer_load_dwordx4 v[208:211], v11, s[12:15], s80 offen offset:0 sc1
    buffer_load_dwordx4 v[212:215], v8, s[12:15], s80 offen offset:1024 sc1
    buffer_load_dwordx4 v[216:219], v9, s[12:15], s80 offen offset:1024 sc1
    buffer_load_dwordx4 v[220:223], v10, s[12:15], s80 offen offset:1024 sc1
    buffer_load_dwordx4 v[224:227], v11, s[12:15], s80 offen offset:1024 sc1
    v_mov_b32 v4, s78
    buffer_load_dwordx4 v[144:147], v1, s[12:15], s49 offen offset:0 sc1
    buffer_load_dwordx4 v[148:151], v1, s[12:15], s49 offen offset:1024 sc1
    v_accvgpr_read_b32 v22, a40
    v_accvgpr_read_b32 v23, a41
    v_accvgpr_read_b32 v24, a42
    v_accvgpr_read_b32 v25, a43
    v_accvgpr_read_b32 v26, a44
    v_accvgpr_read_b32 v27, a45
    v_accvgpr_read_b32 v28, a46
    v_accvgpr_read_b32 v29, a47
    v_exp_f32_e64 v14, v22 clamp
    v_exp_f32_e64 v15, v23 clamp
    v_exp_f32_e64 v16, v24 clamp
    v_exp_f32_e64 v17, v25 clamp
    v_exp_f32_e64 v18, v26 clamp
    v_exp_f32_e64 v19, v27 clamp
    v_exp_f32_e64 v20, v28 clamp
    v_exp_f32_e64 v21, v29 clamp
    v_max_f32 v22, s78, v22
    v_max_f32 v23, s78, v23
    v_max_f32 v24, s78, v24
    v_max_f32 v25, s78, v25
    v_max_f32 v26, s78, v26
    v_max_f32 v27, s78, v27
    v_max_f32 v28, s78, v28
    v_max_f32 v29, s78, v29
    v_pk_fma_f32 v[22:23], v[22:23], s[76:77], v[14:15] op_sel:[0,1,0] op_sel_hi:[1,1,1]
    v_pk_fma_f32 v[24:25], v[24:25], s[76:77], v[16:17] op_sel:[0,1,0] op_sel_hi:[1,1,1]
    v_pk_fma_f32 v[26:27], v[26:27], s[76:77], v[18:19] op_sel:[0,1,0] op_sel_hi:[1,1,1]
    v_pk_fma_f32 v[28:29], v[28:29], s[76:77], v[20:21] op_sel:[0,1,0] op_sel_hi:[1,1,1]
    v_cvt_pk_bf16_f32 v32, v22, v23
    v_cvt_pk_bf16_f32 v33, v24, v25
    v_cvt_pk_bf16_f32 v34, v26, v27
    v_cvt_pk_bf16_f32 v35, v28, v29
    buffer_load_dwordx4 v[152:155], v1, s[12:15], s49 offen offset:2048 sc1
    buffer_load_dwordx4 v[156:159], v1, s[12:15], s49 offen offset:3072 sc1
    v_accvgpr_read_b32 v22, a48
    v_accvgpr_read_b32 v23, a49
    v_accvgpr_read_b32 v24, a50
    v_accvgpr_read_b32 v25, a51
    v_accvgpr_read_b32 v26, a52
    v_accvgpr_read_b32 v27, a53
    v_accvgpr_read_b32 v28, a54
    v_accvgpr_read_b32 v29, a55
    v_exp_f32_e64 v14, v22 clamp
    v_exp_f32_e64 v15, v23 clamp
    v_exp_f32_e64 v16, v24 clamp
    v_exp_f32_e64 v17, v25 clamp
    v_exp_f32_e64 v18, v26 clamp
    v_exp_f32_e64 v19, v27 clamp
    v_exp_f32_e64 v20, v28 clamp
    v_exp_f32_e64 v21, v29 clamp
    v_max_f32 v22, s78, v22
    v_max_f32 v23, s78, v23
    v_max_f32 v24, s78, v24
    v_max_f32 v25, s78, v25
    v_max_f32 v26, s78, v26
    v_max_f32 v27, s78, v27
    v_max_f32 v28, s78, v28
    v_max_f32 v29, s78, v29
    v_pk_fma_f32 v[22:23], v[22:23], s[76:77], v[14:15] op_sel:[0,1,0] op_sel_hi:[1,1,1]
    v_pk_fma_f32 v[24:25], v[24:25], s[76:77], v[16:17] op_sel:[0,1,0] op_sel_hi:[1,1,1]
    v_pk_fma_f32 v[26:27], v[26:27], s[76:77], v[18:19] op_sel:[0,1,0] op_sel_hi:[1,1,1]
    v_pk_fma_f32 v[28:29], v[28:29], s[76:77], v[20:21] op_sel:[0,1,0] op_sel_hi:[1,1,1]
    v_cvt_pk_bf16_f32 v36, v22, v23
    v_cvt_pk_bf16_f32 v37, v24, v25
    v_cvt_pk_bf16_f32 v38, v26, v27
    v_cvt_pk_bf16_f32 v39, v28, v29
    s_add_u32 s49, s49, 4096
    buffer_load_dwordx4 v[160:163], v1, s[12:15], s49 offen offset:0 sc1
    buffer_load_dwordx4 v[164:167], v1, s[12:15], s49 offen offset:1024 sc1
    v_accvgpr_read_b32 v22, a56
    v_accvgpr_read_b32 v23, a57
    v_accvgpr_read_b32 v24, a58
    v_accvgpr_read_b32 v25, a59
    v_accvgpr_read_b32 v26, a60
    v_accvgpr_read_b32 v27, a61
    v_accvgpr_read_b32 v28, a62
    v_accvgpr_read_b32 v29, a63
    v_exp_f32_e64 v14, v22 clamp
    v_exp_f32_e64 v15, v23 clamp
    v_exp_f32_e64 v16, v24 clamp
    v_exp_f32_e64 v17, v25 clamp
    v_exp_f32_e64 v18, v26 clamp
    v_exp_f32_e64 v19, v27 clamp
    v_exp_f32_e64 v20, v28 clamp
    v_exp_f32_e64 v21, v29 clamp
    v_max_f32 v22, s78, v22
    v_max_f32 v23, s78, v23
    v_max_f32 v24, s78, v24
    v_max_f32 v25, s78, v25
    v_max_f32 v26, s78, v26
    v_max_f32 v27, s78, v27
    v_max_f32 v28, s78, v28
    v_max_f32 v29, s78, v29
    v_pk_fma_f32 v[22:23], v[22:23], s[76:77], v[14:15] op_sel:[0,1,0] op_sel_hi:[1,1,1]
    v_pk_fma_f32 v[24:25], v[24:25], s[76:77], v[16:17] op_sel:[0,1,0] op_sel_hi:[1,1,1]
    v_pk_fma_f32 v[26:27], v[26:27], s[76:77], v[18:19] op_sel:[0,1,0] op_sel_hi:[1,1,1]
    v_pk_fma_f32 v[28:29], v[28:29], s[76:77], v[20:21] op_sel:[0,1,0] op_sel_hi:[1,1,1]
    v_cvt_pk_bf16_f32 v40, v22, v23
    v_cvt_pk_bf16_f32 v41, v24, v25
    v_cvt_pk_bf16_f32 v42, v26, v27
    v_cvt_pk_bf16_f32 v43, v28, v29
    s_waitcnt vmcnt(15)
    v_cvt_pk_bf16_f32 v84, v84, v85
    v_cvt_pk_bf16_f32 v85, v86, v87
    s_waitcnt vmcnt(14)
    v_cvt_pk_bf16_f32 v88, v88, v89
    v_cvt_pk_bf16_f32 v89, v90, v91
    s_waitcnt vmcnt(13)
    v_cvt_pk_bf16_f32 v92, v92, v93
    v_cvt_pk_bf16_f32 v93, v94, v95
    ds_write_b64 v7, v[84:85] offset:0
    ds_write_b64 v7, v[88:89] offset:576
    ds_write_b64 v7, v[92:93] offset:1152
    s_waitcnt lgkmcnt(0)
    s_barrier
    ds_read_b64 a[88:89], v12 offset:0
    ds_read_b64 a[90:91], v12 offset:16
    ds_read_b64 a[96:97], v12 offset:32
    ds_read_b64 a[98:99], v12 offset:48
    ds_read_b64 a[92:93], v5 offset:1728
    ds_read_b64 a[94:95], v12 offset:1736
    ds_read_b64 a[100:101], v12 offset:1752
    ds_read_b64 a[102:103], v12 offset:3456
    ds_read_b64 a[104:105], v12 offset:3472
    ds_read_b64 a[110:111], v12 offset:3488
    ds_read_b64 a[112:113], v12 offset:3504
    ds_read_b64 a[106:107], v5 offset:5184
    ds_read_b64 a[108:109], v12 offset:5192
    ds_read_b64 a[114:115], v12 offset:5208
    buffer_load_dwordx4 v[168:171], v1, s[12:15], s49 offen offset:2048 sc1
    buffer_load_dwordx4 v[172:175], v1, s[12:15], s49 offen offset:3072 sc1
    v_accvgpr_read_b32 v22, a64
    v_accvgpr_read_b32 v23, a65
    v_accvgpr_read_b32 v24, a66
    v_accvgpr_read_b32 v25, a67
    v_accvgpr_read_b32 v26, a68
    v_accvgpr_read_b32 v27, a69
    v_accvgpr_read_b32 v28, a70
    v_accvgpr_read_b32 v29, a71
    v_exp_f32_e64 v14, v22 clamp
    v_exp_f32_e64 v15, v23 clamp
    v_exp_f32_e64 v16, v24 clamp
    v_exp_f32_e64 v17, v25 clamp
    v_exp_f32_e64 v18, v26 clamp
    v_exp_f32_e64 v19, v27 clamp
    v_exp_f32_e64 v20, v28 clamp
    v_exp_f32_e64 v21, v29 clamp
    v_max_f32 v22, s78, v22
    v_max_f32 v23, s78, v23
    v_max_f32 v24, s78, v24
    v_max_f32 v25, s78, v25
    v_max_f32 v26, s78, v26
    v_max_f32 v27, s78, v27
    v_max_f32 v28, s78, v28
    v_max_f32 v29, s78, v29
    v_pk_fma_f32 v[22:23], v[22:23], s[76:77], v[14:15] op_sel:[0,1,0] op_sel_hi:[1,1,1]
    v_pk_fma_f32 v[24:25], v[24:25], s[76:77], v[16:17] op_sel:[0,1,0] op_sel_hi:[1,1,1]
    v_pk_fma_f32 v[26:27], v[26:27], s[76:77], v[18:19] op_sel:[0,1,0] op_sel_hi:[1,1,1]
    v_pk_fma_f32 v[28:29], v[28:29], s[76:77], v[20:21] op_sel:[0,1,0] op_sel_hi:[1,1,1]
    v_cvt_pk_bf16_f32 v44, v22, v23
    v_cvt_pk_bf16_f32 v45, v24, v25
    v_cvt_pk_bf16_f32 v46, v26, v27
    v_cvt_pk_bf16_f32 v47, v28, v29
    s_waitcnt lgkmcnt(12)
    v_mfma_f32_32x32x16_bf16 v[52:67], a[88:91], v[32:35], 0
    s_waitcnt lgkmcnt(10)
    v_mfma_f32_32x32x16_bf16 v[52:67], a[96:99], v[36:39], v[52:67]
    s_waitcnt lgkmcnt(8)
    v_mfma_f32_32x32x16_bf16 v[68:83], a[92:95], v[36:39], 0
    s_waitcnt lgkmcnt(7)
    v_mfma_f32_32x32x16_bf16 v[68:83], a[98:101], v[38:41], v[68:83]
    s_add_u32 s49, s49, 4096
    buffer_load_dwordx4 v[176:179], v1, s[12:15], s49 offen offset:0 sc1
    buffer_load_dwordx4 v[180:183], v1, s[12:15], s49 offen offset:1024 sc1
    v_accvgpr_read_b32 v22, a72
    v_accvgpr_read_b32 v23, a73
    v_accvgpr_read_b32 v24, a74
    v_accvgpr_read_b32 v25, a75
    v_accvgpr_read_b32 v26, a76
    v_accvgpr_read_b32 v27, a77
    v_accvgpr_read_b32 v28, a78
    v_accvgpr_read_b32 v29, a79
    v_exp_f32_e64 v14, v22 clamp
    v_exp_f32_e64 v15, v23 clamp
    v_exp_f32_e64 v16, v24 clamp
    v_exp_f32_e64 v17, v25 clamp
    v_exp_f32_e64 v18, v26 clamp
    v_exp_f32_e64 v19, v27 clamp
    v_exp_f32_e64 v20, v28 clamp
    v_exp_f32_e64 v21, v29 clamp
    v_max_f32 v22, s78, v22
    v_max_f32 v23, s78, v23
    v_max_f32 v24, s78, v24
    v_max_f32 v25, s78, v25
    v_max_f32 v26, s78, v26
    v_max_f32 v27, s78, v27
    v_max_f32 v28, s78, v28
    v_max_f32 v29, s78, v29
    v_pk_fma_f32 v[22:23], v[22:23], s[76:77], v[14:15] op_sel:[0,1,0] op_sel_hi:[1,1,1]
    v_pk_fma_f32 v[24:25], v[24:25], s[76:77], v[16:17] op_sel:[0,1,0] op_sel_hi:[1,1,1]
    v_pk_fma_f32 v[26:27], v[26:27], s[76:77], v[18:19] op_sel:[0,1,0] op_sel_hi:[1,1,1]
    v_pk_fma_f32 v[28:29], v[28:29], s[76:77], v[20:21] op_sel:[0,1,0] op_sel_hi:[1,1,1]
    v_cvt_pk_bf16_f32 v48, v22, v23
    v_cvt_pk_bf16_f32 v49, v24, v25
    v_cvt_pk_bf16_f32 v50, v26, v27
    v_cvt_pk_bf16_f32 v51, v28, v29
    v_fma_f32 v62, v62, s76, v4
    v_rcp_f32 v62, v62
    s_nop 0
    v_pk_mul_f32 v[52:53], v[52:53], v[62:63] op_sel_hi:[1,0]
    v_pk_mul_f32 v[54:55], v[54:55], v[62:63] op_sel_hi:[1,0]
    v_pk_mul_f32 v[56:57], v[56:57], v[62:63] op_sel_hi:[1,0]
    v_pk_mul_f32 v[58:59], v[58:59], v[62:63] op_sel_hi:[1,0]
    v_pk_mul_f32 v[60:61], v[60:61], v[62:63] op_sel_hi:[1,0]
    v_cvt_pk_bf16_f32 v236, v52, v53
    v_cvt_pk_bf16_f32 v237, v54, v55
    v_cvt_pk_bf16_f32 v238, v56, v57
    v_cvt_pk_bf16_f32 v239, v58, v59
    v_cvt_pk_bf16_f32 v240, v60, v61
    s_waitcnt lgkmcnt(5)
    v_mfma_f32_32x32x16_bf16 v[52:67], a[102:105], v[42:45], 0
    s_waitcnt lgkmcnt(3)
    v_mfma_f32_32x32x16_bf16 v[52:67], a[110:113], v[46:49], v[52:67]
    buffer_store_dwordx4 v[236:239], v13, s[12:15], s43 offen offset:0 sc1
    v_fma_f32 v78, v78, s76, v4
    v_rcp_f32 v78, v78
    s_nop 0
    v_mul_f32 v68, v68, v78
    v_mul_f32 v69, v69, v78
    v_mul_f32 v70, v70, v78
    v_mul_f32 v71, v71, v78
    v_mul_f32 v72, v72, v78
    v_mul_f32 v73, v73, v78
    v_mul_f32 v74, v74, v78
    v_mul_f32 v75, v75, v78
    v_mul_f32 v76, v76, v78
    v_mul_f32 v77, v77, v78
    v_cvt_pk_bf16_f32 v241, v68, v69
    v_cvt_pk_bf16_f32 v242, v70, v71
    v_cvt_pk_bf16_f32 v243, v72, v73
    v_cvt_pk_bf16_f32 v244, v74, v75
    v_cvt_pk_bf16_f32 v245, v76, v77
    s_waitcnt lgkmcnt(1)
    v_mfma_f32_32x32x16_bf16 v[68:83], a[106:109], v[46:49], 0
    s_waitcnt lgkmcnt(0)
    v_mfma_f32_32x32x16_bf16 v[68:83], a[112:115], v[48:51], v[68:83]
    buffer_store_dwordx4 v[240:243], v13, s[12:15], s43 offen offset:512 sc1
    v_fma_f32 v62, v62, s76, v4
    v_rcp_f32 v62, v62
    s_nop 0
    v_mul_f32 v52, v52, v62
    v_mul_f32 v53, v53, v62
    v_mul_f32 v54, v54, v62
    v_mul_f32 v55, v55, v62
    v_mul_f32 v56, v56, v62
    v_mul_f32 v57, v57, v62
    v_mul_f32 v58, v58, v62
    v_mul_f32 v59, v59, v62
    v_mul_f32 v60, v60, v62
    v_mul_f32 v61, v61, v62
    v_cvt_pk_bf16_f32 v246, v52, v53
    v_cvt_pk_bf16_f32 v247, v54, v55
    v_cvt_pk_bf16_f32 v248, v56, v57
    v_cvt_pk_bf16_f32 v249, v58, v59
    v_cvt_pk_bf16_f32 v250, v60, v61
    v_fma_f32 v78, v78, s76, v4
    v_rcp_f32 v78, v78
    s_nop 0
    v_pk_mul_f32 v[68:69], v[68:69], v[78:79] op_sel_hi:[1,0]
    v_pk_mul_f32 v[70:71], v[70:71], v[78:79] op_sel_hi:[1,0]
    v_pk_mul_f32 v[72:73], v[72:73], v[78:79] op_sel_hi:[1,0]
    v_pk_mul_f32 v[74:75], v[74:75], v[78:79] op_sel_hi:[1,0]
    v_pk_mul_f32 v[76:77], v[76:77], v[78:79] op_sel_hi:[1,0]
    v_cvt_pk_bf16_f32 v251, v68, v69
    v_cvt_pk_bf16_f32 v252, v70, v71
    v_cvt_pk_bf16_f32 v253, v72, v73
    v_cvt_pk_bf16_f32 v254, v74, v75
    v_cvt_pk_bf16_f32 v255, v76, v77
    buffer_store_dwordx4 v[244:247], v13, s[12:15], s43 offen offset:1024 sc1
    buffer_store_dwordx4 v[248:251], v13, s[12:15], s43 offen offset:1536 sc1
    buffer_store_dwordx4 v[252:255], v13, s[12:15], s43 offen offset:2048 sc1
    v_mfma_f32_16x16x32_bf16 a[0:3], a[128:131], v[196:199], 0
    s_add_u32 s88, s88, 16384
    v_mov_b32 v3, 0
    v_mfma_f32_16x16x32_bf16 a[4:7], a[132:135], v[196:199], 0
    buffer_atomic_add v3, v30, s[12:15], s88 offen sc0 sc1
    v_mfma_f32_16x16x32_bf16 a[8:11], a[136:139], v[196:199], 0
    v_mfma_f32_16x16x32_bf16 a[12:15], a[140:143], v[196:199], 0
    buffer_load_dwordx4 v[184:187], v1, s[12:15], s49 offen offset:2048 sc1
    v_mfma_f32_16x16x32_bf16 a[16:19], a[144:147], v[196:199], 0
    s_waitcnt vmcnt(23)
    v_mfma_f32_16x16x32_bf16 a[20:23], a[128:131], v[200:203], 0
    v_mfma_f32_16x16x32_bf16 a[24:27], a[132:135], v[200:203], 0
    buffer_load_dwordx4 v[188:191], v1, s[12:15], s49 offen offset:3072 sc1
    v_mfma_f32_16x16x32_bf16 a[28:31], a[136:139], v[200:203], 0
    s_add_u32 s49, s49, 4096
    v_mfma_f32_16x16x32_bf16 a[32:35], a[140:143], v[200:203], 0
    v_mfma_f32_16x16x32_bf16 a[36:39], a[144:147], v[200:203], 0
    buffer_load_dwordx4 v[228:231], v8, s[12:15], s81 offen offset:0 sc1
    s_waitcnt vmcnt(24)
    v_mfma_f32_16x16x32_bf16 a[88:91], a[128:131], v[204:207], 0
    v_mfma_f32_16x16x32_bf16 a[92:95], a[132:135], v[204:207], 0
    v_mfma_f32_16x16x32_bf16 a[96:99], a[136:139], v[204:207], 0
    v_mfma_f32_16x16x32_bf16 a[100:103], a[140:143], v[204:207], 0
    buffer_load_dwordx4 v[192:195], v1, s[12:15], s49 offen offset:0 sc1
    v_mfma_f32_16x16x32_bf16 a[104:107], a[144:147], v[204:207], 0
    buffer_load_dwordx4 v[232:235], v9, s[12:15], s81 offen offset:0 sc1
    s_waitcnt vmcnt(25)
    v_mfma_f32_16x16x32_bf16 a[108:111], a[128:131], v[208:211], 0
    v_mfma_f32_16x16x32_bf16 a[112:115], a[132:135], v[208:211], 0
    v_mfma_f32_16x16x32_bf16 a[116:119], a[136:139], v[208:211], 0
    v_mfma_f32_16x16x32_bf16 a[120:123], a[140:143], v[208:211], 0
    v_mfma_f32_16x16x32_bf16 a[124:127], a[144:147], v[208:211], 0
    buffer_load_dwordx4 v[196:199], v10, s[12:15], s81 offen offset:0 sc1
    s_waitcnt vmcnt(25)
    v_mfma_f32_16x16x32_bf16 a[0:3], a[148:151], v[212:215], a[0:3]
    buffer_load_dwordx4 a[40:43], v1, s[12:15], s49 offen offset:1024 sc1
    v_mfma_f32_16x16x32_bf16 a[4:7], a[152:155], v[212:215], a[4:7]
    v_mfma_f32_16x16x32_bf16 a[8:11], a[156:159], v[212:215], a[8:11]
    v_mfma_f32_16x16x32_bf16 a[12:15], a[160:163], v[212:215], a[12:15]
    v_mfma_f32_16x16x32_bf16 a[16:19], a[164:167], v[212:215], a[16:19]
    buffer_load_dwordx4 v[200:203], v11, s[12:15], s81 offen offset:0 sc1
    s_waitcnt vmcnt(26)
    v_mfma_f32_16x16x32_bf16 a[20:23], a[148:151], v[216:219], a[20:23]
    v_mfma_f32_16x16x32_bf16 a[24:27], a[152:155], v[216:219], a[24:27]
    v_mfma_f32_16x16x32_bf16 a[28:31], a[156:159], v[216:219], a[28:31]
    v_mfma_f32_16x16x32_bf16 a[32:35], a[160:163], v[216:219], a[32:35]
    buffer_load_dwordx4 a[44:47], v1, s[12:15], s49 offen offset:2048 sc1
    v_mfma_f32_16x16x32_bf16 a[36:39], a[164:167], v[216:219], a[36:39]
    buffer_load_dwordx4 v[204:207], v8, s[12:15], s81 offen offset:1024 sc1
    s_waitcnt vmcnt(27)
    v_mfma_f32_16x16x32_bf16 a[88:91], a[148:151], v[220:223], a[88:91]
    v_mfma_f32_16x16x32_bf16 a[92:95], a[152:155], v[220:223], a[92:95]
    v_mfma_f32_16x16x32_bf16 a[96:99], a[156:159], v[220:223], a[96:99]
    v_mfma_f32_16x16x32_bf16 a[100:103], a[160:163], v[220:223], a[100:103]
    v_mfma_f32_16x16x32_bf16 a[104:107], a[164:167], v[220:223], a[104:107]
    buffer_load_dwordx4 v[208:211], v9, s[12:15], s81 offen offset:1024 sc1
    s_waitcnt vmcnt(27)
    v_mfma_f32_16x16x32_bf16 a[108:111], a[148:151], v[224:227], a[108:111]
    buffer_load_dwordx4 a[48:51], v1, s[12:15], s49 offen offset:3072 sc1
    v_mfma_f32_16x16x32_bf16 a[112:115], a[152:155], v[224:227], a[112:115]
    s_add_u32 s49, s49, 4096
    v_mfma_f32_16x16x32_bf16 a[116:119], a[156:159], v[224:227], a[116:119]
    v_mfma_f32_16x16x32_bf16 a[120:123], a[160:163], v[224:227], a[120:123]
    v_mfma_f32_16x16x32_bf16 a[124:127], a[164:167], v[224:227], a[124:127]
    buffer_load_dwordx4 v[212:215], v10, s[12:15], s81 offen offset:1024 sc1
    s_waitcnt vmcnt(10)
    v_mfma_f32_16x16x32_bf16 a[0:3], a[168:171], v[228:231], a[0:3]
    v_mfma_f32_16x16x32_bf16 a[4:7], a[172:175], v[228:231], a[4:7]
    buffer_load_dwordx4 a[52:55], v1, s[12:15], s49 offen offset:0 sc1
    v_mfma_f32_16x16x32_bf16 a[8:11], a[176:179], v[228:231], a[8:11]
    v_mfma_f32_16x16x32_bf16 a[12:15], a[180:183], v[228:231], a[12:15]
    v_mfma_f32_16x16x32_bf16 a[16:19], a[184:187], v[228:231], a[16:19]
    buffer_load_dwordx4 v[216:219], v11, s[12:15], s81 offen offset:1024 sc1
    v_cmp_ne_u32 vcc, 4, v3
    s_nop 0
    s_bitcmp1_b32 vcc_lo, 0
    s_cbranch_scc1 L_spin10
L_back10:
    s_waitcnt vmcnt(10)
    v_mfma_f32_16x16x32_bf16 a[20:23], a[168:171], v[232:235], a[20:23]
    v_mov_b32 v22, 1
    v_mfma_f32_16x16x32_bf16 a[24:27], a[172:175], v[232:235], a[24:27]
    buffer_atomic_add v22, v30, s[12:15], s45 offen sc1
    v_mfma_f32_16x16x32_bf16 a[28:31], a[176:179], v[232:235], a[28:31]
    s_mul_i32 s90, s64, 16128
    v_mfma_f32_16x16x32_bf16 a[32:35], a[180:183], v[232:235], a[32:35]
    s_add_u32 s90, s90, 8192
    buffer_load_dwordx4 a[56:59], v1, s[12:15], s49 offen offset:1024 sc1
    v_mfma_f32_16x16x32_bf16 a[36:39], a[184:187], v[232:235], a[36:39]
    s_movk_i32 s91, 1280
    buffer_load_dwordx4 v[220:223], v8, s[12:15], s82 offen offset:0 sc1
    s_waitcnt vmcnt(12)
    v_mfma_f32_16x16x32_bf16 a[88:91], a[168:171], v[196:199], a[88:91]
    s_movk_i32 s93, 336
    v_add_u32 v22, 0, v0
    v_mul_u32_u24 v23, 205, v22
    v_mfma_f32_16x16x32_bf16 a[92:95], a[172:175], v[196:199], a[92:95]
    v_lshrrev_b32 v23, 11, v23
    v_mul_u32_u24 v12, 10, v23
    v_mfma_f32_16x16x32_bf16 a[96:99], a[176:179], v[196:199], a[96:99]
    v_sub_u32 v22, v22, v12
    v_lshlrev_b32 v22, 4, v22
    v_mfma_f32_16x16x32_bf16 a[100:103], a[180:183], v[196:199], a[100:103]
    v_mad_u32_u24 v12, v23, s91, v22
    v_mad_u32_u24 v15, v23, s93, v22
    v_mfma_f32_16x16x32_bf16 a[104:107], a[184:187], v[196:199], a[104:107]
    buffer_load_dwordx4 v[224:227], v9, s[12:15], s82 offen offset:0 sc1
    s_waitcnt vmcnt(11)
    v_mfma_f32_16x16x32_bf16 a[108:111], a[168:171], v[200:203], a[108:111]
    buffer_load_dwordx4 a[60:63], v1, s[56:59], s49 offen offset:2048 sc1
    v_mfma_f32_16x16x32_bf16 a[112:115], a[172:175], v[200:203], a[112:115]
    v_add_u32 v15, s90, v15
    v_add_u32 v22, 64, v0
    v_mfma_f32_16x16x32_bf16 a[116:119], a[176:179], v[200:203], a[116:119]
    v_mul_u32_u24 v23, 205, v22
    v_lshrrev_b32 v23, 11, v23
    v_mfma_f32_16x16x32_bf16 a[120:123], a[180:183], v[200:203], a[120:123]
    v_mul_u32_u24 v13, 10, v23
    v_sub_u32 v22, v22, v13
    v_mfma_f32_16x16x32_bf16 a[124:127], a[184:187], v[200:203], a[124:127]
    buffer_load_dwordx4 v[228:231], v10, s[12:15], s82 offen offset:0 sc1
    s_waitcnt vmcnt(11)
    v_mfma_f32_16x16x32_bf16 a[0:3], a[188:191], v[204:207], a[0:3]
    v_lshlrev_b32 v22, 4, v22
    v_mad_u32_u24 v13, v23, s91, v22
    v_mfma_f32_16x16x32_bf16 a[4:7], a[192:195], v[204:207], a[4:7]
    buffer_load_dwordx4 a[64:67], v1, s[56:59], s49 offen offset:3072 sc1
    v_mfma_f32_16x16x32_bf16 a[8:11], a[196:199], v[204:207], a[8:11]
    s_add_u32 s49, s49, 4096
    v_mad_u32_u24 v16, v23, s93, v22
    v_add_u32 v16, s90, v16
    v_mfma_f32_16x16x32_bf16 a[12:15], a[200:203], v[204:207], a[12:15]
    v_and_b32 v22, 31, v0
    v_add_u32 v22, 128, v22
    v_mfma_f32_16x16x32_bf16 a[16:19], a[204:207], v[204:207], a[16:19]
    buffer_load_dwordx4 v[232:235], v11, s[12:15], s82 offen offset:0 sc1
    s_waitcnt vmcnt(12)
    v_mfma_f32_16x16x32_bf16 a[20:23], a[188:191], v[208:211], a[20:23]
    v_mul_u32_u24 v23, 205, v22
    v_lshrrev_b32 v23, 11, v23
    v_mfma_f32_16x16x32_bf16 a[24:27], a[192:195], v[208:211], a[24:27]
    v_mul_u32_u24 v14, 10, v23
    v_sub_u32 v22, v22, v14
    v_mfma_f32_16x16x32_bf16 a[28:31], a[196:199], v[208:211], a[28:31]
    v_lshlrev_b32 v22, 4, v22
    v_mad_u32_u24 v14, v23, s91, v22
    v_mfma_f32_16x16x32_bf16 a[32:35], a[200:203], v[208:211], a[32:35]
    buffer_load_dwordx4 a[68:71], v1, s[56:59], s49 offen offset:0 sc1
    v_mfma_f32_16x16x32_bf16 a[36:39], a[204:207], v[208:211], a[36:39]
    buffer_load_dwordx4 v[196:199], v8, s[12:15], s82 offen offset:1024 sc1
    s_waitcnt vmcnt(12)
    v_mfma_f32_16x16x32_bf16 a[88:91], a[188:191], v[212:215], a[88:91]
    v_mad_u32_u24 v17, v23, s93, v22
    v_add_u32 v17, s90, v17
    v_mfma_f32_16x16x32_bf16 a[92:95], a[192:195], v[212:215], a[92:95]
    v_lshrrev_b32 v23, 5, v0
    v_lshl_add_u32 v14, v23, 30, v14
    v_mfma_f32_16x16x32_bf16 a[96:99], a[196:199], v[212:215], a[96:99]
    v_and_b32 v22, 15, v0
    v_mul_u32_u24 v22, 336, v22
    v_mfma_f32_16x16x32_bf16 a[100:103], a[200:203], v[212:215], a[100:103]
    v_lshl_add_u32 v22, v23, 4, v22
    v_bfe_u32 v23, v0, 4, 1
    v_mfma_f32_16x16x32_bf16 a[104:107], a[204:207], v[212:215], a[104:107]
    buffer_load_dwordx4 v[200:203], v9, s[12:15], s82 offen offset:1024 sc1
    s_waitcnt vmcnt(11)
    v_mfma_f32_16x16x32_bf16 a[108:111], a[188:191], v[216:219], a[108:111]
    buffer_load_dwordx4 a[72:75], v1, s[56:59], s49 offen offset:1024 sc1
    v_mfma_f32_16x16x32_bf16 a[112:115], a[192:195], v[216:219], a[112:115]
    v_mul_u32_u24 v23, 160, v23
    v_add_u32 v22, v22, v23
    v_mfma_f32_16x16x32_bf16 a[116:119], a[196:199], v[216:219], a[116:119]
    s_add_u32 s90, s90, 90112
    v_add_u32 v21, s90, v22
    v_mfma_f32_16x16x32_bf16 a[120:123], a[200:203], v[216:219], a[120:123]
    s_add_u32 s90, s64, 1
    v_mfma_f32_16x16x32_bf16 a[124:127], a[204:207], v[216:219], a[124:127]
    s_and_b32 s90, s90, 3
    buffer_load_dwordx4 v[204:207], v10, s[12:15], s82 offen offset:1024 sc1
    s_waitcnt vmcnt(10)
    v_mfma_f32_16x16x32_bf16 a[0:3], a[208:211], v[220:223], a[0:3]
    s_add_u32 s88, s88, 16384
    v_mov_b32 v3, 0
    v_mfma_f32_16x16x32_bf16 a[4:7], a[212:215], v[220:223], a[4:7]
    s_mul_i32 s90, s90, 16128
    buffer_atomic_add v3, v30, s[12:15], s88 offen sc0 sc1
    v_mfma_f32_16x16x32_bf16 a[8:11], a[216:219], v[220:223], a[8:11]
    s_add_u32 s90, s90, 8192
    v_add_u32 v18, s90, v22
    v_mfma_f32_16x16x32_bf16 a[12:15], a[220:223], v[220:223], a[12:15]
    s_add_u32 s90, s64, 2
    buffer_load_dwordx4 a[76:79], v1, s[56:59], s49 offen offset:2048 sc1
    v_mfma_f32_16x16x32_bf16 a[16:19], a[224:227], v[220:223], a[16:19]
    s_and_b32 s90, s90, 3
    buffer_load_dwordx4 v[208:211], v11, s[12:15], s82 offen offset:1024 sc1
    s_waitcnt vmcnt(12)
    v_mfma_f32_16x16x32_bf16 a[20:23], a[208:211], v[224:227], a[20:23]
    s_mul_i32 s90, s90, 16128
    v_mfma_f32_16x16x32_bf16 a[24:27], a[212:215], v[224:227], a[24:27]
    s_add_u32 s90, s90, 13568
    v_add_u32 v19, s90, v22
    v_mfma_f32_16x16x32_bf16 a[28:31], a[216:219], v[224:227], a[28:31]
    s_add_u32 s90, s64, 3
    v_mfma_f32_16x16x32_bf16 a[32:35], a[220:223], v[224:227], a[32:35]
    s_and_b32 s90, s90, 3
    v_mfma_f32_16x16x32_bf16 a[36:39], a[224:227], v[224:227], a[36:39]
    s_mul_i32 s90, s90, 16128
    buffer_load_dwordx4 v[212:215], v8, s[12:15], s83 offen offset:0 sc1
L_pg1_4:
    s_cbranch_execz L_pgret1
    s_waitcnt vmcnt(11)
    v_mfma_f32_16x16x32_bf16 a[88:91], a[208:211], v[228:231], a[88:91]
    s_add_u32 s90, s90, 18944
    buffer_load_dwordx4 v[32:35], v1, s[56:59], s49 offen offset:3072 sc1
    v_mfma_f32_16x16x32_bf16 a[92:95], a[212:215], v[228:231], a[92:95]
    s_add_u32 s49, s49, 4096
    v_add_u32 v20, s90, v22
    v_mfma_f32_16x16x32_bf16 a[96:99], a[216:219], v[228:231], a[96:99]
    v_mfma_f32_16x16x32_bf16 a[100:103], a[220:223], v[228:231], a[100:103]
    v_mfma_f32_16x16x32_bf16 a[104:107], a[224:227], v[228:231], a[104:107]
    buffer_load_dwordx4 v[216:219], v9, s[12:15], s83 offen offset:0 sc1
    s_waitcnt vmcnt(11)
    v_mfma_f32_16x16x32_bf16 a[108:111], a[208:211], v[232:235], a[108:111]
    v_mfma_f32_16x16x32_bf16 a[112:115], a[212:215], v[232:235], a[112:115]
    buffer_load_dwordx4 v[36:39], v1, s[56:59], s49 offen offset:0 sc1
    v_mfma_f32_16x16x32_bf16 a[116:119], a[216:219], v[232:235], a[116:119]
    v_mfma_f32_16x16x32_bf16 a[120:123], a[220:223], v[232:235], a[120:123]
    v_mfma_f32_16x16x32_bf16 a[124:127], a[224:227], v[232:235], a[124:127]
    buffer_load_dwordx4 v[220:223], v10, s[12:15], s83 offen offset:0 sc1
    s_waitcnt vmcnt(11)
    v_mfma_f32_16x16x32_bf16 a[0:3], a[228:231], v[196:199], a[0:3]
    v_mfma_f32_16x16x32_bf16 a[4:7], a[232:235], v[196:199], a[4:7]
    v_mfma_f32_16x16x32_bf16 a[8:11], a[236:239], v[196:199], a[8:11]
    v_mfma_f32_16x16x32_bf16 a[12:15], a[240:243], v[196:199], a[12:15]
    buffer_load_dwordx4 v[40:43], v1, s[56:59], s49 offen offset:1024 sc1
    v_mfma_f32_16x16x32_bf16 a[16:19], a[244:247], v[196:199], a[16:19]
    buffer_load_dwordx4 v[224:227], v11, s[12:15], s83 offen offset:0 sc1
    s_waitcnt vmcnt(12)
    v_mfma_f32_16x16x32_bf16 a[20:23], a[228:231], v[200:203], a[20:23]
    v_mfma_f32_16x16x32_bf16 a[24:27], a[232:235], v[200:203], a[24:27]
    v_mfma_f32_16x16x32_bf16 a[28:31], a[236:239], v[200:203], a[28:31]
    v_mfma_f32_16x16x32_bf16 a[32:35], a[240:243], v[200:203], a[32:35]
    v_mfma_f32_16x16x32_bf16 a[36:39], a[244:247], v[200:203], a[36:39]
    buffer_load_dwordx4 v[228:231], v8, s[12:15], s83 offen offset:1024 sc1
    s_waitcnt vmcnt(11)
    v_mfma_f32_16x16x32_bf16 a[88:91], a[228:231], v[204:207], a[88:91]
    buffer_load_dwordx4 v[44:47], v1, s[56:59], s49 offen offset:2048 sc1
    v_mfma_f32_16x16x32_bf16 a[92:95], a[232:235], v[204:207], a[92:95]
    v_mfma_f32_16x16x32_bf16 a[96:99], a[236:239], v[204:207], a[96:99]
    v_mfma_f32_16x16x32_bf16 a[100:103], a[240:243], v[204:207], a[100:103]
    v_mfma_f32_16x16x32_bf16 a[104:107], a[244:247], v[204:207], a[104:107]
    buffer_load_dwordx4 v[232:235], v9, s[12:15], s83 offen offset:1024 sc1
    s_waitcnt vmcnt(10)
    v_mfma_f32_16x16x32_bf16 a[108:111], a[228:231], v[208:211], a[108:111]
    v_mfma_f32_16x16x32_bf16 a[112:115], a[232:235], v[208:211], a[112:115]
    buffer_load_dwordx4 v[48:51], v1, s[56:59], s49 offen offset:3072 sc1
    v_mfma_f32_16x16x32_bf16 a[116:119], a[236:239], v[208:211], a[116:119]
    s_add_u32 s49, s49, s29
    v_mfma_f32_16x16x32_bf16 a[120:123], a[240:243], v[208:211], a[120:123]
    s_add_u32 s49, s49, 4096
    v_mfma_f32_16x16x32_bf16 a[124:127], a[244:247], v[208:211], a[124:127]
    buffer_load_dwordx4 v[196:199], v10, s[12:15], s83 offen offset:1024 sc1
    s_waitcnt vmcnt(11)
    v_mfma_f32_16x16x32_bf16 a[0:3], v[96:99], v[212:215], a[0:3]
    v_mfma_f32_16x16x32_bf16 a[4:7], v[100:103], v[212:215], a[4:7]
    v_mfma_f32_16x16x32_bf16 a[8:11], v[104:107], v[212:215], a[8:11]
    v_mfma_f32_16x16x32_bf16 a[12:15], v[108:111], v[212:215], a[12:15]
    buffer_load_dwordx4 v[52:55], v1, s[12:15], s49 offen offset:0 sc1
    v_mfma_f32_16x16x32_bf16 a[16:19], v[112:115], v[212:215], a[16:19]
    buffer_load_dwordx4 v[200:203], v11, s[12:15], s83 offen offset:1024 sc1
    v_cmp_ne_u32 vcc, 4, v3
    s_nop 0
    s_bitcmp1_b32 vcc_lo, 0
    s_cbranch_scc1 L_spin11
L_back11:
    s_waitcnt vmcnt(11)
    v_mfma_f32_16x16x32_bf16 a[20:23], v[96:99], v[216:219], a[20:23]
    v_mfma_f32_16x16x32_bf16 a[24:27], v[100:103], v[216:219], a[24:27]
    v_mfma_f32_16x16x32_bf16 a[28:31], v[104:107], v[216:219], a[28:31]
    v_mfma_f32_16x16x32_bf16 a[32:35], v[108:111], v[216:219], a[32:35]
    v_mfma_f32_16x16x32_bf16 a[36:39], v[112:115], v[216:219], a[36:39]
    buffer_load_dwordx4 v[204:207], v8, s[12:15], s84 offen offset:0 sc1
    s_waitcnt vmcnt(10)
    v_mfma_f32_16x16x32_bf16 a[88:91], v[96:99], v[220:223], a[88:91]
    buffer_load_dwordx4 v[56:59], v1, s[12:15], s49 offen offset:1024 sc1
    v_mfma_f32_16x16x32_bf16 a[92:95], v[100:103], v[220:223], a[92:95]
    v_mfma_f32_16x16x32_bf16 a[96:99], v[104:107], v[220:223], a[96:99]
    v_mfma_f32_16x16x32_bf16 a[100:103], v[108:111], v[220:223], a[100:103]
    v_mfma_f32_16x16x32_bf16 a[104:107], v[112:115], v[220:223], a[104:107]
    buffer_load_dwordx4 v[208:211], v9, s[12:15], s84 offen offset:0 sc1
    s_waitcnt vmcnt(10)
    v_mfma_f32_16x16x32_bf16 a[108:111], v[96:99], v[224:227], a[108:111]
    v_mfma_f32_16x16x32_bf16 a[112:115], v[100:103], v[224:227], a[112:115]
    v_mfma_f32_16x16x32_bf16 a[116:119], v[104:107], v[224:227], a[116:119]
    v_mfma_f32_16x16x32_bf16 a[120:123], v[108:111], v[224:227], a[120:123]
    buffer_load_dwordx4 v[60:63], v1, s[12:15], s49 offen offset:2048 sc1
    v_mfma_f32_16x16x32_bf16 a[124:127], v[112:115], v[224:227], a[124:127]
    buffer_load_dwordx4 v[212:215], v10, s[12:15], s84 offen offset:0 sc1
    s_waitcnt vmcnt(11)
    v_mfma_f32_16x16x32_bf16 a[0:3], v[116:119], v[228:231], a[0:3]
    v_mfma_f32_16x16x32_bf16 a[4:7], v[120:123], v[228:231], a[4:7]
    v_mfma_f32_16x16x32_bf16 a[8:11], v[124:127], v[228:231], a[8:11]
    v_mfma_f32_16x16x32_bf16 a[12:15], v[128:131], v[228:231], a[12:15]
    v_mfma_f32_16x16x32_bf16 a[16:19], v[132:135], v[228:231], a[16:19]
    buffer_load_dwordx4 v[216:219], v11, s[12:15], s84 offen offset:0 sc1
    s_waitcnt vmcnt(10)
    v_mfma_f32_16x16x32_bf16 a[20:23], v[116:119], v[232:235], a[20:23]
    buffer_load_dwordx4 v[64:67], v1, s[12:15], s49 offen offset:3072 sc1
    v_mfma_f32_16x16x32_bf16 a[24:27], v[120:123], v[232:235], a[24:27]
    s_add_u32 s49, s49, 4096
    v_mfma_f32_16x16x32_bf16 a[28:31], v[124:127], v[232:235], a[28:31]
    v_mfma_f32_16x16x32_bf16 a[32:35], v[128:131], v[232:235], a[32:35]
    v_mfma_f32_16x16x32_bf16 a[36:39], v[132:135], v[232:235], a[36:39]
    buffer_load_dwordx4 v[220:223], v8, s[12:15], s84 offen offset:1024 sc1
    s_waitcnt vmcnt(10)
    v_mfma_f32_16x16x32_bf16 a[88:91], v[116:119], v[196:199], a[88:91]
    buffer_load_dwordx4 v[68:71], v1, s[12:15], s49 offen offset:0 sc1
    v_mfma_f32_16x16x32_bf16 a[92:95], v[120:123], v[196:199], a[92:95]
    v_mfma_f32_16x16x32_bf16 a[96:99], v[124:127], v[196:199], a[96:99]
    v_mfma_f32_16x16x32_bf16 a[100:103], v[128:131], v[196:199], a[100:103]
    v_mfma_f32_16x16x32_bf16 a[104:107], v[132:135], v[196:199], a[104:107]
    buffer_load_dwordx4 v[224:227], v9, s[12:15], s84 offen offset:1024 sc1
    s_waitcnt vmcnt(10)
    v_mfma_f32_16x16x32_bf16 a[108:111], v[116:119], v[200:203], a[108:111]
    v_mfma_f32_16x16x32_bf16 a[112:115], v[120:123], v[200:203], a[112:115]
    v_mfma_f32_16x16x32_bf16 a[116:119], v[124:127], v[200:203], a[116:119]
    v_mfma_f32_16x16x32_bf16 a[120:123], v[128:131], v[200:203], a[120:123]
    buffer_load_dwordx4 v[72:75], v1, s[12:15], s49 offen offset:1024 sc1
    v_mfma_f32_16x16x32_bf16 a[124:127], v[132:135], v[200:203], a[124:127]
    buffer_load_dwordx4 v[228:231], v10, s[12:15], s84 offen offset:1024 sc1
    s_waitcnt vmcnt(11)
    v_mfma_f32_16x16x32_bf16 a[0:3], v[136:139], v[204:207], a[0:3]
    v_mfma_f32_16x16x32_bf16 a[4:7], v[140:143], v[204:207], a[4:7]
    v_mfma_f32_16x16x32_bf16 a[8:11], v[144:147], v[204:207], a[8:11]
    v_mfma_f32_16x16x32_bf16 a[12:15], v[148:151], v[204:207], a[12:15]
    v_mfma_f32_16x16x32_bf16 a[16:19], v[152:155], v[204:207], a[16:19]
    buffer_load_dwordx4 v[232:235], v11, s[12:15], s84 offen offset:1024 sc1
    s_waitcnt vmcnt(10)
    v_mfma_f32_16x16x32_bf16 a[20:23], v[136:139], v[208:211], a[20:23]
    buffer_load_dwordx4 v[76:79], v1, s[12:15], s49 offen offset:2048 sc1
    v_mfma_f32_16x16x32_bf16 a[24:27], v[140:143], v[208:211], a[24:27]
    v_mfma_f32_16x16x32_bf16 a[28:31], v[144:147], v[208:211], a[28:31]
    v_mfma_f32_16x16x32_bf16 a[32:35], v[148:151], v[208:211], a[32:35]
    v_mfma_f32_16x16x32_bf16 a[36:39], v[152:155], v[208:211], a[36:39]
    buffer_load_dwordx4 v[196:199], v8, s[12:15], s84 offen offset:2048 sc1
    s_waitcnt vmcnt(10)
    v_mfma_f32_16x16x32_bf16 a[88:91], v[136:139], v[212:215], a[88:91]
    v_mfma_f32_16x16x32_bf16 a[92:95], v[140:143], v[212:215], a[92:95]
    buffer_load_dwordx4 v[80:83], v1, s[12:15], s49 offen offset:3072 sc1
    v_mfma_f32_16x16x32_bf16 a[96:99], v[144:147], v[212:215], a[96:99]
    s_add_u32 s49, s49, 4096
    v_mfma_f32_16x16x32_bf16 a[100:103], v[148:151], v[212:215], a[100:103]
    v_mfma_f32_16x16x32_bf16 a[104:107], v[152:155], v[212:215], a[104:107]
    buffer_load_dwordx4 v[200:203], v9, s[12:15], s84 offen offset:2048 sc1
    s_waitcnt vmcnt(11)
    v_mfma_f32_16x16x32_bf16 a[108:111], v[136:139], v[216:219], a[108:111]
    v_mfma_f32_16x16x32_bf16 a[112:115], v[140:143], v[216:219], a[112:115]
    v_mfma_f32_16x16x32_bf16 a[116:119], v[144:147], v[216:219], a[116:119]
    v_mfma_f32_16x16x32_bf16 a[120:123], v[148:151], v[216:219], a[120:123]
    buffer_load_dwordx4 v[84:87], v1, s[12:15], s49 offen offset:0 sc1
    v_mfma_f32_16x16x32_bf16 a[124:127], v[152:155], v[216:219], a[124:127]
    buffer_load_dwordx4 v[204:207], v10, s[12:15], s84 offen offset:2048 sc1
    s_waitcnt vmcnt(11)
    v_mfma_f32_16x16x32_bf16 a[0:3], v[156:159], v[220:223], a[0:3]
    v_mfma_f32_16x16x32_bf16 a[4:7], v[160:163], v[220:223], a[4:7]
    v_mfma_f32_16x16x32_bf16 a[8:11], v[164:167], v[220:223], a[8:11]
    v_mfma_f32_16x16x32_bf16 a[12:15], v[168:171], v[220:223], a[12:15]
    v_mfma_f32_16x16x32_bf16 a[16:19], v[172:175], v[220:223], a[16:19]
    buffer_load_dwordx4 v[208:211], v11, s[12:15], s84 offen offset:2048 sc1
    s_waitcnt vmcnt(10)
    v_mfma_f32_16x16x32_bf16 a[20:23], v[156:159], v[224:227], a[20:23]
    buffer_load_dwordx4 v[88:91], v1, s[12:15], s49 offen offset:1024 sc1
    v_mfma_f32_16x16x32_bf16 a[24:27], v[160:163], v[224:227], a[24:27]
    v_mfma_f32_16x16x32_bf16 a[28:31], v[164:167], v[224:227], a[28:31]
    v_mfma_f32_16x16x32_bf16 a[32:35], v[168:171], v[224:227], a[32:35]
    v_mfma_f32_16x16x32_bf16 a[36:39], v[172:175], v[224:227], a[36:39]
    buffer_load_dwordx4 v[212:215], v8, s[12:15], s84 offen offset:3072 sc1
    s_waitcnt vmcnt(10)
    v_mfma_f32_16x16x32_bf16 a[88:91], v[156:159], v[228:231], a[88:91]
    v_mfma_f32_16x16x32_bf16 a[92:95], v[160:163], v[228:231], a[92:95]
    v_mfma_f32_16x16x32_bf16 a[96:99], v[164:167], v[228:231], a[96:99]
    v_mfma_f32_16x16x32_bf16 a[100:103], v[168:171], v[228:231], a[100:103]
    buffer_load_dwordx4 a[128:131], v1, s[12:15], s49 offen offset:2048 sc1
    v_mfma_f32_16x16x32_bf16 a[104:107], v[172:175], v[228:231], a[104:107]
    buffer_load_dwordx4 v[216:219], v9, s[12:15], s84 offen offset:3072 sc1
    s_waitcnt vmcnt(11)
    v_mfma_f32_16x16x32_bf16 a[108:111], v[156:159], v[232:235], a[108:111]
    v_mfma_f32_16x16x32_bf16 a[112:115], v[160:163], v[232:235], a[112:115]
    v_mfma_f32_16x16x32_bf16 a[116:119], v[164:167], v[232:235], a[116:119]
    v_mfma_f32_16x16x32_bf16 a[120:123], v[168:171], v[232:235], a[120:123]
    buffer_load_dwordx4 a[132:135], v1, s[12:15], s49 offen offset:3072 sc1
    v_mfma_f32_16x16x32_bf16 a[124:127], v[172:175], v[232:235], a[124:127]
    s_add_u32 s49, s49, 4096
    buffer_load_dwordx4 v[220:223], v10, s[12:15], s84 offen offset:3072 sc1
    s_waitcnt vmcnt(11)
    v_mfma_f32_16x16x32_bf16 a[0:3], v[176:179], v[196:199], a[0:3]
    s_add_u32 s88, s88, 16384
    v_mov_b32 v3, 0
    v_mfma_f32_16x16x32_bf16 a[4:7], v[180:183], v[196:199], a[4:7]
    buffer_atomic_add v3, v30, s[12:15], s88 offen sc0 sc1
    v_mfma_f32_16x16x32_bf16 a[8:11], v[184:187], v[196:199], a[8:11]
    buffer_load_dwordx4 v[116:119], v12, s[4:7], s89 offen
    v_mfma_f32_16x16x32_bf16 a[12:15], v[188:191], v[196:199], a[12:15]
    buffer_load_dwordx4 v[120:123], v13, s[4:7], s89 offen
    v_mfma_f32_16x16x32_bf16 a[16:19], v[192:195], v[196:199], a[16:19]
    buffer_load_dwordx4 v[224:227], v11, s[12:15], s84 offen offset:3072 sc1
    s_waitcnt vmcnt(13)
    v_mfma_f32_16x16x32_bf16 a[20:23], v[176:179], v[200:203], a[20:23]
    buffer_load_dwordx4 a[136:139], v1, s[12:15], s49 offen offset:0 sc1
    v_mfma_f32_16x16x32_bf16 a[24:27], v[180:183], v[200:203], a[24:27]
    buffer_load_dwordx4 v[124:127], v14, s[4:7], s89 offen
    v_mfma_f32_16x16x32_bf16 a[28:31], v[184:187], v[200:203], a[28:31]
    v_mfma_f32_16x16x32_bf16 a[32:35], v[188:191], v[200:203], a[32:35]
    v_mfma_f32_16x16x32_bf16 a[36:39], v[192:195], v[200:203], a[36:39]
    buffer_load_dwordx4 v[228:231], v8, s[12:15], s85 offen offset:0 sc1
    s_waitcnt vmcnt(14)
    v_mfma_f32_16x16x32_bf16 a[88:91], v[176:179], v[204:207], a[88:91]
    v_mfma_f32_16x16x32_bf16 a[92:95], v[180:183], v[204:207], a[92:95]
    v_mfma_f32_16x16x32_bf16 a[96:99], v[184:187], v[204:207], a[96:99]
    v_mfma_f32_16x16x32_bf16 a[100:103], v[188:191], v[204:207], a[100:103]
    buffer_load_dwordx4 a[140:143], v1, s[12:15], s49 offen offset:1024 sc1
    v_mfma_f32_16x16x32_bf16 a[104:107], v[192:195], v[204:207], a[104:107]
    buffer_load_dwordx4 v[232:235], v9, s[12:15], s85 offen offset:0 sc1
    s_waitcnt vmcnt(15)
    v_mfma_f32_16x16x32_bf16 a[108:111], v[176:179], v[208:211], a[108:111]
    v_mfma_f32_16x16x32_bf16 a[112:115], v[180:183], v[208:211], a[112:115]
    v_mfma_f32_16x16x32_bf16 a[116:119], v[184:187], v[208:211], a[116:119]
    v_mfma_f32_16x16x32_bf16 a[120:123], v[188:191], v[208:211], a[120:123]
    v_mfma_f32_16x16x32_bf16 a[124:127], v[192:195], v[208:211], a[124:127]
    buffer_load_dwordx4 v[196:199], v10, s[12:15], s85 offen offset:0 sc1
    s_waitcnt vmcnt(14)
    v_mfma_f32_16x16x32_bf16 a[0:3], a[40:43], v[212:215], a[0:3]
    buffer_load_dwordx4 a[144:147], v1, s[12:15], s49 offen offset:2048 sc1
    v_mfma_f32_16x16x32_bf16 a[4:7], a[44:47], v[212:215], a[4:7]
    v_mfma_f32_16x16x32_bf16 a[8:11], a[48:51], v[212:215], a[8:11]
    v_mfma_f32_16x16x32_bf16 a[12:15], a[52:55], v[212:215], a[12:15]
    v_mfma_f32_16x16x32_bf16 a[16:19], a[56:59], v[212:215], a[16:19]
    buffer_load_dwordx4 v[200:203], v11, s[12:15], s85 offen offset:0 sc1
    s_waitcnt vmcnt(14)
    v_mfma_f32_16x16x32_bf16 a[20:23], a[40:43], v[216:219], a[20:23]
    v_mfma_f32_16x16x32_bf16 a[24:27], a[44:47], v[216:219], a[24:27]
    buffer_load_dwordx4 a[148:151], v1, s[12:15], s49 offen offset:3072 sc1
    v_mfma_f32_16x16x32_bf16 a[28:31], a[48:51], v[216:219], a[28:31]
    s_add_u32 s49, s49, 4096
    v_mfma_f32_16x16x32_bf16 a[32:35], a[52:55], v[216:219], a[32:35]
    v_mfma_f32_16x16x32_bf16 a[36:39], a[56:59], v[216:219], a[36:39]
    buffer_load_dwordx4 v[204:207], v8, s[12:15], s85 offen offset:1024 sc1
    s_waitcnt vmcnt(14)
    v_mfma_f32_16x16x32_bf16 a[88:91], a[40:43], v[220:223], a[88:91]
    v_mfma_f32_16x16x32_bf16 a[92:95], a[44:47], v[220:223], a[92:95]
    v_mfma_f32_16x16x32_bf16 a[96:99], a[48:51], v[220:223], a[96:99]
    v_mfma_f32_16x16x32_bf16 a[100:103], a[52:55], v[220:223], a[100:103]
    buffer_load_dwordx4 a[152:155], v1, s[12:15], s49 offen offset:0 sc1
    v_mfma_f32_16x16x32_bf16 a[104:107], a[56:59], v[220:223], a[104:107]
    buffer_load_dwordx4 v[208:211], v9, s[12:15], s85 offen offset:1024 sc1
    s_waitcnt vmcnt(12)
    v_mfma_f32_16x16x32_bf16 a[108:111], a[40:43], v[224:227], a[108:111]
    v_mfma_f32_16x16x32_bf16 a[112:115], a[44:47], v[224:227], a[112:115]
    v_mfma_f32_16x16x32_bf16 a[116:119], a[48:51], v[224:227], a[116:119]
    v_mfma_f32_16x16x32_bf16 a[120:123], a[52:55], v[224:227], a[120:123]
    v_mfma_f32_16x16x32_bf16 a[124:127], a[56:59], v[224:227], a[124:127]
    buffer_load_dwordx4 v[212:215], v10, s[12:15], s85 offen offset:1024 sc1
    s_waitcnt vmcnt(10)
    v_mfma_f32_16x16x32_bf16 a[0:3], a[60:63], v[228:231], a[0:3]
    buffer_load_dwordx4 a[156:159], v1, s[12:15], s49 offen offset:1024 sc1
    v_mfma_f32_16x16x32_bf16 a[4:7], a[64:67], v[228:231], a[4:7]
    v_mfma_f32_16x16x32_bf16 a[8:11], a[68:71], v[228:231], a[8:11]
    v_mfma_f32_16x16x32_bf16 a[12:15], a[72:75], v[228:231], a[12:15]
    v_mfma_f32_16x16x32_bf16 a[16:19], a[76:79], v[228:231], a[16:19]
    buffer_load_dwordx4 v[216:219], v11, s[12:15], s85 offen offset:1024 sc1
    v_cmp_ne_u32 vcc, 4, v3
    s_nop 0
    s_bitcmp1_b32 vcc_lo, 0
    s_cbranch_scc1 L_spin12
L_back12:
    s_waitcnt vmcnt(10)
    v_mfma_f32_16x16x32_bf16 a[20:23], a[60:63], v[232:235], a[20:23]
    v_mfma_f32_16x16x32_bf16 a[24:27], a[64:67], v[232:235], a[24:27]
    buffer_load_dwordx4 a[160:163], v1, s[12:15], s49 offen offset:2048 sc1
    v_mfma_f32_16x16x32_bf16 a[28:31], a[68:71], v[232:235], a[28:31]
    v_mfma_f32_16x16x32_bf16 a[32:35], a[72:75], v[232:235], a[32:35]
    v_mfma_f32_16x16x32_bf16 a[36:39], a[76:79], v[232:235], a[36:39]
    buffer_load_dwordx4 v[220:223], v8, s[12:15], s86 offen offset:0 sc1
    s_waitcnt vmcnt(11)
    v_mfma_f32_16x16x32_bf16 a[88:91], a[60:63], v[196:199], a[88:91]
    v_mfma_f32_16x16x32_bf16 a[92:95], a[64:67], v[196:199], a[92:95]
    v_mfma_f32_16x16x32_bf16 a[96:99], a[68:71], v[196:199], a[96:99]
    v_mfma_f32_16x16x32_bf16 a[100:103], a[72:75], v[196:199], a[100:103]
    buffer_load_dwordx4 a[164:167], v1, s[12:15], s49 offen offset:3072 sc1
    v_mfma_f32_16x16x32_bf16 a[104:107], a[76:79], v[196:199], a[104:107]
    s_add_u32 s49, s49, 4096
    buffer_load_dwordx4 v[224:227], v9, s[12:15], s86 offen offset:0 sc1
    s_waitcnt vmcnt(11)
    v_mfma_f32_16x16x32_bf16 a[108:111], a[60:63], v[200:203], a[108:111]
    v_mfma_f32_16x16x32_bf16 a[112:115], a[64:67], v[200:203], a[112:115]
    v_mfma_f32_16x16x32_bf16 a[116:119], a[68:71], v[200:203], a[116:119]
    v_mfma_f32_16x16x32_bf16 a[120:123], a[72:75], v[200:203], a[120:123]
    v_mfma_f32_16x16x32_bf16 a[124:127], a[76:79], v[200:203], a[124:127]
    buffer_load_dwordx4 v[228:231], v10, s[12:15], s86 offen offset:0 sc1
    s_waitcnt vmcnt(10)
    v_mfma_f32_16x16x32_bf16 a[0:3], v[32:35], v[204:207], a[0:3]
    buffer_load_dwordx4 a[168:171], v1, s[12:15], s49 offen offset:0 sc1
    v_mfma_f32_16x16x32_bf16 a[4:7], v[36:39], v[204:207], a[4:7]
    v_mfma_f32_16x16x32_bf16 a[8:11], v[40:43], v[204:207], a[8:11]
    v_mfma_f32_16x16x32_bf16 a[12:15], v[44:47], v[204:207], a[12:15]
    v_mfma_f32_16x16x32_bf16 a[16:19], v[48:51], v[204:207], a[16:19]
    buffer_load_dwordx4 v[232:235], v11, s[12:15], s86 offen offset:0 sc1
    s_waitcnt vmcnt(10)
    v_mfma_f32_16x16x32_bf16 a[20:23], v[32:35], v[208:211], a[20:23]
    v_mfma_f32_16x16x32_bf16 a[24:27], v[36:39], v[208:211], a[24:27]
    v_mfma_f32_16x16x32_bf16 a[28:31], v[40:43], v[208:211], a[28:31]
    v_lshlrev_b32 v128, 16, v116
    v_and_b32 v129, s75, v116
    v_mfma_f32_16x16x32_bf16 a[32:35], v[44:47], v[208:211], a[32:35]
    buffer_load_dwordx4 a[172:175], v1, s[12:15], s49 offen offset:1024 sc1
    v_mfma_f32_16x16x32_bf16 a[36:39], v[48:51], v[208:211], a[36:39]
    buffer_load_dwordx4 v[196:199], v8, s[12:15], s86 offen offset:1024 sc1
    s_waitcnt vmcnt(11)
    v_mfma_f32_16x16x32_bf16 a[88:91], v[32:35], v[212:215], a[88:91]
    v_lshlrev_b32 v130, 16, v117
    v_and_b32 v131, s75, v117
    v_mfma_f32_16x16x32_bf16 a[92:95], v[36:39], v[212:215], a[92:95]
    v_lshlrev_b32 v132, 16, v118
    v_and_b32 v133, s75, v118
    v_mfma_f32_16x16x32_bf16 a[96:99], v[40:43], v[212:215], a[96:99]
    v_lshlrev_b32 v134, 16, v119
    v_and_b32 v135, s75, v119
    v_mfma_f32_16x16x32_bf16 a[100:103], v[44:47], v[212:215], a[100:103]
    v_lshlrev_b32 v136, 16, v120
    v_and_b32 v137, s75, v120
    v_mfma_f32_16x16x32_bf16 a[104:107], v[48:51], v[212:215], a[104:107]
    buffer_load_dwordx4 v[200:203], v9, s[12:15], s86 offen offset:1024 sc1
    s_waitcnt vmcnt(10)
    v_mfma_f32_16x16x32_bf16 a[108:111], v[32:35], v[216:219], a[108:111]
    buffer_load_dwordx4 a[176:179], v1, s[12:15], s49 offen offset:2048 sc1
    v_mfma_f32_16x16x32_bf16 a[112:115], v[36:39], v[216:219], a[112:115]
    v_lshlrev_b32 v138, 16, v121
    v_and_b32 v139, s75, v121
    v_mfma_f32_16x16x32_bf16 a[116:119], v[40:43], v[216:219], a[116:119]
    v_lshlrev_b32 v140, 16, v122
    v_and_b32 v141, s75, v122
    v_mfma_f32_16x16x32_bf16 a[120:123], v[44:47], v[216:219], a[120:123]
    v_lshlrev_b32 v142, 16, v123
    v_and_b32 v143, s75, v123
    v_mfma_f32_16x16x32_bf16 a[124:127], v[48:51], v[216:219], a[124:127]
    buffer_load_dwordx4 v[204:207], v10, s[12:15], s86 offen offset:1024 sc1
    s_waitcnt vmcnt(10)
    v_mfma_f32_16x16x32_bf16 a[0:3], v[52:55], v[220:223], a[0:3]
    v_lshlrev_b32 v144, 16, v124
    v_and_b32 v145, s75, v124
    v_mfma_f32_16x16x32_bf16 a[4:7], v[56:59], v[220:223], a[4:7]
    buffer_load_dwordx4 a[180:183], v1, s[12:15], s49 offen offset:3072 sc1
    v_mfma_f32_16x16x32_bf16 a[8:11], v[60:63], v[220:223], a[8:11]
    s_add_u32 s49, s49, 4096
    v_lshlrev_b32 v146, 16, v125
    v_and_b32 v147, s75, v125
    v_mfma_f32_16x16x32_bf16 a[12:15], v[64:67], v[220:223], a[12:15]
    v_lshlrev_b32 v148, 16, v126
    v_and_b32 v149, s75, v126
    v_mfma_f32_16x16x32_bf16 a[16:19], v[68:71], v[220:223], a[16:19]
    buffer_load_dwordx4 v[208:211], v11, s[12:15], s86 offen offset:1024 sc1
    s_waitcnt vmcnt(10)
    v_mfma_f32_16x16x32_bf16 a[20:23], v[52:55], v[224:227], a[20:23]
    v_lshlrev_b32 v150, 16, v127
    v_and_b32 v151, s75, v127
    v_mfma_f32_16x16x32_bf16 a[24:27], v[56:59], v[224:227], a[24:27]
    v_mfma_f32_16x16x32_bf16 a[28:31], v[60:63], v[224:227], a[28:31]
    v_mfma_f32_16x16x32_bf16 a[32:35], v[64:67], v[224:227], a[32:35]
    buffer_load_dwordx4 a[184:187], v1, s[12:15], s49 offen offset:0 sc1
    v_mfma_f32_16x16x32_bf16 a[36:39], v[68:71], v[224:227], a[36:39]
    buffer_load_dwordx4 v[212:215], v8, s[12:15], s86 offen offset:2048 sc1
    s_waitcnt vmcnt(11)
    v_mfma_f32_16x16x32_bf16 a[88:91], v[52:55], v[228:231], a[88:91]
    v_mfma_f32_16x16x32_bf16 a[92:95], v[56:59], v[228:231], a[92:95]
    v_mfma_f32_16x16x32_bf16 a[96:99], v[60:63], v[228:231], a[96:99]
    v_mfma_f32_16x16x32_bf16 a[100:103], v[64:67], v[228:231], a[100:103]
    v_mfma_f32_16x16x32_bf16 a[104:107], v[68:71], v[228:231], a[104:107]
    buffer_load_dwordx4 v[216:219], v8, s[12:15], s86 offen offset:3072 sc1
    s_waitcnt vmcnt(10)
    v_mfma_f32_16x16x32_bf16 a[108:111], v[52:55], v[232:235], a[108:111]
    v_mfma_f32_16x16x32_bf16 a[112:115], v[56:59], v[232:235], a[112:115]
    v_mfma_f32_16x16x32_bf16 a[116:119], v[60:63], v[232:235], a[116:119]
    v_mfma_f32_16x16x32_bf16 a[120:123], v[64:67], v[232:235], a[120:123]
    v_mfma_f32_16x16x32_bf16 a[124:127], v[68:71], v[232:235], a[124:127]
    buffer_load_dwordx4 v[220:223], v8, s[12:15], s87 offen offset:0 sc1
    s_waitcnt vmcnt(9)
    v_mfma_f32_16x16x32_bf16 a[0:3], v[72:75], v[196:199], a[0:3]
    v_mfma_f32_16x16x32_bf16 a[4:7], v[76:79], v[196:199], a[4:7]
    v_mfma_f32_16x16x32_bf16 a[8:11], v[80:83], v[196:199], a[8:11]
    v_mfma_f32_16x16x32_bf16 a[12:15], v[84:87], v[196:199], a[12:15]
    v_mfma_f32_16x16x32_bf16 a[16:19], v[88:91], v[196:199], a[16:19]
    buffer_load_dwordx4 v[224:227], v9, s[12:15], s86 offen offset:2048 sc1
    s_waitcnt vmcnt(9)
    v_mfma_f32_16x16x32_bf16 a[20:23], v[72:75], v[200:203], a[20:23]
    v_mfma_f32_16x16x32_bf16 a[24:27], v[76:79], v[200:203], a[24:27]
    v_mfma_f32_16x16x32_bf16 a[28:31], v[80:83], v[200:203], a[28:31]
    v_mfma_f32_16x16x32_bf16 a[32:35], v[84:87], v[200:203], a[32:35]
    v_mfma_f32_16x16x32_bf16 a[36:39], v[88:91], v[200:203], a[36:39]
    buffer_load_dwordx4 v[228:231], v9, s[12:15], s86 offen offset:3072 sc1
    s_waitcnt vmcnt(8)
    v_mfma_f32_16x16x32_bf16 a[88:91], v[72:75], v[204:207], a[88:91]
    v_mfma_f32_16x16x32_bf16 a[92:95], v[76:79], v[204:207], a[92:95]
    v_mfma_f32_16x16x32_bf16 a[96:99], v[80:83], v[204:207], a[96:99]
    v_mfma_f32_16x16x32_bf16 a[100:103], v[84:87], v[204:207], a[100:103]
    v_mfma_f32_16x16x32_bf16 a[104:107], v[88:91], v[204:207], a[104:107]
    buffer_load_dwordx4 v[232:235], v9, s[12:15], s87 offen offset:0 sc1
    s_waitcnt vmcnt(7)
    v_mfma_f32_16x16x32_bf16 a[108:111], v[72:75], v[208:211], a[108:111]
    v_mfma_f32_16x16x32_bf16 a[112:115], v[76:79], v[208:211], a[112:115]
    v_mfma_f32_16x16x32_bf16 a[116:119], v[80:83], v[208:211], a[116:119]
    v_mfma_f32_16x16x32_bf16 a[120:123], v[84:87], v[208:211], a[120:123]
    v_mfma_f32_16x16x32_bf16 a[124:127], v[88:91], v[208:211], a[124:127]
    buffer_load_dwordx4 v[196:199], v10, s[12:15], s86 offen offset:2048 sc1
    s_waitcnt vmcnt(6)
    v_mfma_f32_16x16x32_bf16 a[0:3], a[128:131], v[212:215], a[0:3]
    v_mfma_f32_16x16x32_bf16 a[4:7], a[132:135], v[212:215], a[4:7]
    v_mfma_f32_16x16x32_bf16 a[8:11], a[136:139], v[212:215], a[8:11]
    v_mfma_f32_16x16x32_bf16 a[12:15], a[140:143], v[212:215], a[12:15]
    v_mfma_f32_16x16x32_bf16 a[16:19], a[144:147], v[212:215], a[16:19]
    buffer_load_dwordx4 v[200:203], v10, s[12:15], s86 offen offset:3072 sc1
    s_waitcnt vmcnt(6)
    v_mfma_f32_16x16x32_bf16 a[0:3], a[148:151], v[216:219], a[0:3]
    v_mfma_f32_16x16x32_bf16 a[4:7], a[152:155], v[216:219], a[4:7]
    v_mfma_f32_16x16x32_bf16 a[8:11], a[156:159], v[216:219], a[8:11]
    v_mfma_f32_16x16x32_bf16 a[12:15], a[160:163], v[216:219], a[12:15]
    v_mfma_f32_16x16x32_bf16 a[16:19], a[164:167], v[216:219], a[16:19]
    buffer_load_dwordx4 v[204:207], v10, s[12:15], s87 offen offset:0 sc1
    s_waitcnt vmcnt(6)
    v_mfma_f32_16x16x32_bf16 a[0:3], a[168:171], v[220:223], a[0:3]
    v_mfma_f32_16x16x32_bf16 a[4:7], a[172:175], v[220:223], a[4:7]
    v_mfma_f32_16x16x32_bf16 a[8:11], a[176:179], v[220:223], a[8:11]
    v_mfma_f32_16x16x32_bf16 a[12:15], a[180:183], v[220:223], a[12:15]
    v_mfma_f32_16x16x32_bf16 a[16:19], a[184:187], v[220:223], a[16:19]
    buffer_load_dwordx4 v[208:211], v11, s[12:15], s86 offen offset:2048 sc1
    s_waitcnt vmcnt(6)
    v_mfma_f32_16x16x32_bf16 a[20:23], a[128:131], v[224:227], a[20:23]
    v_mfma_f32_16x16x32_bf16 a[24:27], a[132:135], v[224:227], a[24:27]
    v_mfma_f32_16x16x32_bf16 a[28:31], a[136:139], v[224:227], a[28:31]
    v_mfma_f32_16x16x32_bf16 a[32:35], a[140:143], v[224:227], a[32:35]
    ds_write_b128 v18, a[0:3] offset:0
    v_mfma_f32_16x16x32_bf16 a[36:39], a[144:147], v[224:227], a[36:39]
    buffer_load_dwordx4 v[212:215], v11, s[12:15], s86 offen offset:3072 sc1
    s_waitcnt vmcnt(6)
    v_mfma_f32_16x16x32_bf16 a[20:23], a[148:151], v[228:231], a[20:23]
    ds_write_b128 v18, a[4:7] offset:32
    v_mfma_f32_16x16x32_bf16 a[24:27], a[152:155], v[228:231], a[24:27]
    ds_write_b128 v18, a[8:11] offset:64
    v_mfma_f32_16x16x32_bf16 a[28:31], a[156:159], v[228:231], a[28:31]
    ds_write_b128 v18, a[12:15] offset:96
    v_mfma_f32_16x16x32_bf16 a[32:35], a[160:163], v[228:231], a[32:35]
    ds_write_b128 v18, a[16:19] offset:128
    v_mfma_f32_16x16x32_bf16 a[36:39], a[164:167], v[228:231], a[36:39]
    buffer_load_dwordx4 v[216:219], v11, s[12:15], s87 offen offset:0 sc1
    s_waitcnt vmcnt(6)
    v_mfma_f32_16x16x32_bf16 a[20:23], a[168:171], v[232:235], a[20:23]
    v_mfma_f32_16x16x32_bf16 a[24:27], a[172:175], v[232:235], a[24:27]
    v_mfma_f32_16x16x32_bf16 a[28:31], a[176:179], v[232:235], a[28:31]
    v_mfma_f32_16x16x32_bf16 a[32:35], a[180:183], v[232:235], a[32:35]
    v_mfma_f32_16x16x32_bf16 a[36:39], a[184:187], v[232:235], a[36:39]
    s_waitcnt vmcnt(5)
    v_mfma_f32_16x16x32_bf16 a[88:91], a[128:131], v[196:199], a[88:91]
    v_mfma_f32_16x16x32_bf16 a[92:95], a[132:135], v[196:199], a[92:95]
    v_mfma_f32_16x16x32_bf16 a[96:99], a[136:139], v[196:199], a[96:99]
    v_mfma_f32_16x16x32_bf16 a[100:103], a[140:143], v[196:199], a[100:103]
    ds_write_b128 v19, a[20:23] offset:0
    v_mfma_f32_16x16x32_bf16 a[104:107], a[144:147], v[196:199], a[104:107]
    ds_write_b128 v19, a[24:27] offset:32
    s_waitcnt vmcnt(4)
    v_mfma_f32_16x16x32_bf16 a[88:91], a[148:151], v[200:203], a[88:91]
    ds_write_b128 v19, a[28:31] offset:64
    v_mfma_f32_16x16x32_bf16 a[92:95], a[152:155], v[200:203], a[92:95]
    ds_write_b128 v19, a[32:35] offset:96
    v_mfma_f32_16x16x32_bf16 a[96:99], a[156:159], v[200:203], a[96:99]
    ds_write_b128 v19, a[36:39] offset:128
    v_mfma_f32_16x16x32_bf16 a[100:103], a[160:163], v[200:203], a[100:103]
    v_mfma_f32_16x16x32_bf16 a[104:107], a[164:167], v[200:203], a[104:107]
    s_waitcnt vmcnt(3)
    v_mfma_f32_16x16x32_bf16 a[88:91], a[168:171], v[204:207], a[88:91]
    v_mfma_f32_16x16x32_bf16 a[92:95], a[172:175], v[204:207], a[92:95]
    v_mfma_f32_16x16x32_bf16 a[96:99], a[176:179], v[204:207], a[96:99]
    v_mfma_f32_16x16x32_bf16 a[100:103], a[180:183], v[204:207], a[100:103]
    v_mfma_f32_16x16x32_bf16 a[104:107], a[184:187], v[204:207], a[104:107]
    s_waitcnt vmcnt(2)
    v_mfma_f32_16x16x32_bf16 a[108:111], a[128:131], v[208:211], a[108:111]
    v_mfma_f32_16x16x32_bf16 a[112:115], a[132:135], v[208:211], a[112:115]
    v_mfma_f32_16x16x32_bf16 a[116:119], a[136:139], v[208:211], a[116:119]
    v_mfma_f32_16x16x32_bf16 a[120:123], a[140:143], v[208:211], a[120:123]
    ds_write_b128 v20, a[88:91] offset:0
    v_mfma_f32_16x16x32_bf16 a[124:127], a[144:147], v[208:211], a[124:127]
    ds_write_b128 v20, a[92:95] offset:32
    s_waitcnt vmcnt(1)
    v_mfma_f32_16x16x32_bf16 a[108:111], a[148:151], v[212:215], a[108:111]
    ds_write_b128 v20, a[96:99] offset:64
    v_mfma_f32_16x16x32_bf16 a[112:115], a[152:155], v[212:215], a[112:115]
    ds_write_b128 v20, a[100:103] offset:96
    v_mfma_f32_16x16x32_bf16 a[116:119], a[156:159], v[212:215], a[116:119]
    ds_write_b128 v20, a[104:107] offset:128
    v_mfma_f32_16x16x32_bf16 a[120:123], a[160:163], v[212:215], a[120:123]
    v_mfma_f32_16x16x32_bf16 a[124:127], a[164:167], v[212:215], a[124:127]
    s_waitcnt vmcnt(0)
    v_mfma_f32_16x16x32_bf16 a[108:111], a[168:171], v[216:219], a[108:111]
    v_mfma_f32_16x16x32_bf16 a[112:115], a[172:175], v[216:219], a[112:115]
    s_waitcnt lgkmcnt(0)
    s_barrier
    v_mfma_f32_16x16x32_bf16 a[116:119], a[176:179], v[216:219], a[116:119]
    ds_read_b128 v[152:155], v15 offset:0
    ds_read_b128 v[156:159], v15 offset:160
    v_mfma_f32_16x16x32_bf16 a[120:123], a[180:183], v[216:219], a[120:123]
    ds_read_b128 v[32:35], v15 offset:5376
    ds_read_b128 v[36:39], v15 offset:5536
    v_mfma_f32_16x16x32_bf16 a[124:127], a[184:187], v[216:219], a[124:127]
    ds_read_b128 v[56:59], v15 offset:10752
    ds_read_b128 v[60:63], v15 offset:10912
    ds_read_b128 v[160:163], v16 offset:0
    ds_read_b128 v[164:167], v16 offset:160
    ds_read_b128 v[40:43], v16 offset:5376
    ds_read_b128 v[44:47], v16 offset:5536
    ds_read_b128 v[64:67], v16 offset:10752
    ds_read_b128 v[68:71], v16 offset:10912
    ds_read_b128 v[168:171], v17 offset:0
    ds_read_b128 v[172:175], v17 offset:160
    ds_read_b128 v[48:51], v17 offset:5376
    ds_read_b128 v[52:55], v17 offset:5536
    ds_read_b128 v[72:75], v17 offset:10752
    ds_read_b128 v[76:79], v17 offset:10912
    v_add_u32 v15, 90112, v15
    v_add_u32 v16, 90112, v16
    v_add_u32 v17, 90112, v17
    ds_write_b128 v21, a[108:111] offset:0
    ds_write_b128 v21, a[112:115] offset:32
    ds_write_b128 v21, a[116:119] offset:64
    ds_write_b128 v21, a[120:123] offset:96
    ds_write_b128 v21, a[124:127] offset:128
    ds_read_b128 v[196:199], v15 offset:0
    ds_read_b128 v[200:203], v15 offset:160
    ds_read_b128 v[204:207], v16 offset:0
    ds_read_b128 v[208:211], v16 offset:160
    ds_read_b128 v[212:215], v17 offset:0
    ds_read_b128 v[216:219], v17 offset:160
    s_waitcnt lgkmcnt(15)
    v_pk_add_f32 v[128:129], v[128:129], v[152:153]
    v_pk_add_f32 v[130:131], v[130:131], v[154:155]
    v_pk_add_f32 v[132:133], v[132:133], v[156:157]
    v_pk_add_f32 v[134:135], v[134:135], v[158:159]
    v_pk_add_f32 v[128:129], v[128:129], v[32:33]
    v_pk_add_f32 v[130:131], v[130:131], v[34:35]
    v_pk_add_f32 v[132:133], v[132:133], v[36:37]
    v_pk_add_f32 v[134:135], v[134:135], v[38:39]
    v_pk_add_f32 v[128:129], v[128:129], v[56:57]
    v_pk_add_f32 v[130:131], v[130:131], v[58:59]
    v_pk_add_f32 v[132:133], v[132:133], v[60:61]
    v_pk_add_f32 v[134:135], v[134:135], v[62:63]
    v_pk_add_f32 v[136:137], v[136:137], v[160:161]
    v_pk_add_f32 v[138:139], v[138:139], v[162:163]
    v_pk_add_f32 v[140:141], v[140:141], v[164:165]
    v_pk_add_f32 v[142:143], v[142:143], v[166:167]
    v_pk_add_f32 v[136:137], v[136:137], v[40:41]
    v_pk_add_f32 v[138:139], v[138:139], v[42:43]
    v_pk_add_f32 v[140:141], v[140:141], v[44:45]
    v_pk_add_f32 v[142:143], v[142:143], v[46:47]
    v_pk_add_f32 v[136:137], v[136:137], v[64:65]
    v_pk_add_f32 v[138:139], v[138:139], v[66:67]
    v_pk_add_f32 v[140:141], v[140:141], v[68:69]
    v_pk_add_f32 v[142:143], v[142:143], v[70:71]
    v_pk_add_f32 v[144:145], v[144:145], v[168:169]
    v_pk_add_f32 v[146:147], v[146:147], v[170:171]
    v_pk_add_f32 v[148:149], v[148:149], v[172:173]
    v_pk_add_f32 v[150:151], v[150:151], v[174:175]
    s_waitcnt lgkmcnt(14)
    v_pk_add_f32 v[144:145], v[144:145], v[48:49]
    v_pk_add_f32 v[146:147], v[146:147], v[50:51]
    s_waitcnt lgkmcnt(13)
    v_pk_add_f32 v[148:149], v[148:149], v[52:53]
L_pg1_5:
    s_cbranch_execz L_pgret1
    v_pk_add_f32 v[150:151], v[150:151], v[54:55]
    s_waitcnt lgkmcnt(12)
    v_pk_add_f32 v[144:145], v[144:145], v[72:73]
    v_pk_add_f32 v[146:147], v[146:147], v[74:75]
    s_waitcnt lgkmcnt(11)
    v_pk_add_f32 v[148:149], v[148:149], v[76:77]
    v_pk_add_f32 v[150:151], v[150:151], v[78:79]
    s_waitcnt lgkmcnt(5)
    v_pk_add_f32 v[128:129], v[128:129], v[196:197]
    v_pk_add_f32 v[130:131], v[130:131], v[198:199]
    s_waitcnt lgkmcnt(4)
    v_pk_add_f32 v[132:133], v[132:133], v[200:201]
    v_pk_add_f32 v[134:135], v[134:135], v[202:203]
    v_cvt_pk_bf16_f32 v128, v128, v129
    v_cvt_pk_bf16_f32 v129, v130, v131
    v_cvt_pk_bf16_f32 v130, v132, v133
    v_cvt_pk_bf16_f32 v131, v134, v135
    buffer_store_dwordx4 v[128:131], v12, s[20:23], s89 offen
    s_waitcnt lgkmcnt(3)
    v_pk_add_f32 v[136:137], v[136:137], v[204:205]
    v_pk_add_f32 v[138:139], v[138:139], v[206:207]
    s_waitcnt lgkmcnt(2)
    v_pk_add_f32 v[140:141], v[140:141], v[208:209]
    v_pk_add_f32 v[142:143], v[142:143], v[210:211]
    v_cvt_pk_bf16_f32 v136, v136, v137
    v_cvt_pk_bf16_f32 v137, v138, v139
    v_cvt_pk_bf16_f32 v138, v140, v141
    v_cvt_pk_bf16_f32 v139, v142, v143
    buffer_store_dwordx4 v[136:139], v13, s[20:23], s89 offen
    s_waitcnt lgkmcnt(1)
    v_pk_add_f32 v[144:145], v[144:145], v[212:213]
    v_pk_add_f32 v[146:147], v[146:147], v[214:215]
    s_waitcnt lgkmcnt(0)
    v_pk_add_f32 v[148:149], v[148:149], v[216:217]
    v_pk_add_f32 v[150:151], v[150:151], v[218:219]
    v_cvt_pk_bf16_f32 v144, v144, v145
    v_cvt_pk_bf16_f32 v145, v146, v147
    v_cvt_pk_bf16_f32 v146, v148, v149
    v_cvt_pk_bf16_f32 v147, v150, v151
    buffer_store_dwordx4 v[144:147], v14, s[20:23], s89 offen
L_end:
    s_endpgm
L_spin0:
    s_mov_b32 s79, 0
L_spinl0:
    s_sleep 2
    buffer_load_dword v19, v18, s[24:27], 0 offen sc1
    s_waitcnt vmcnt(0)
    v_cmp_ne_u32 vcc, 1, v19
    s_cbranch_vccz L_back0
    s_add_u32 s79, s79, 1
    s_cmp_lt_u32 s79, 0x8000
    s_cbranch_scc1 L_spinl0
    s_branch L_back0
L_spin1:
    s_mov_b32 s79, 0
L_spinl1:
    s_sleep 2
    buffer_load_dword v22, v23, s[12:15], 0 offen sc1
    s_waitcnt vmcnt(0)
    v_cmp_ne_u32 vcc, 1, v22
    s_cbranch_vccz L_back1
    s_add_u32 s79, s79, 1
    s_cmp_lt_u32 s79, 0x8000
    s_cbranch_scc1 L_spinl1
    s_branch L_back1
L_spin2:
    s_mov_b32 s79, 0
L_spinl2:
    s_sleep 2
    v_mov_b32 v3, 0
    buffer_atomic_add v3, v30, s[12:15], s88 offen sc0 sc1
    s_waitcnt vmcnt(0)
    v_cmp_ne_u32 vcc, 4, v3
    s_nop 0
    s_bitcmp1_b32 vcc_lo, 0
    s_cbranch_scc0 L_back2
    s_add_u32 s79, s79, 1
    s_cmp_lt_u32 s79, 0x8000
    s_cbranch_scc1 L_spinl2
    s_branch L_back2
L_spin3:
    s_mov_b32 s79, 0
L_spinl3:
    s_sleep 2
    v_mov_b32 v3, 0
    buffer_atomic_add v3, v30, s[12:15], s88 offen sc0 sc1
    s_waitcnt vmcnt(0)
    v_cmp_ne_u32 vcc, 4, v3
    s_nop 0
    s_bitcmp1_b32 vcc_lo, 0
    s_cbranch_scc0 L_back3
    s_add_u32 s79, s79, 1
    s_cmp_lt_u32 s79, 0x8000
    s_cbranch_scc1 L_spinl3
    s_branch L_back3
L_spin4:
    s_mov_b32 s79, 0
L_spinl4:
    s_sleep 2
    v_mov_b32 v3, 0
    buffer_atomic_add v3, v30, s[12:15], s88 offen sc0 sc1
    s_waitcnt vmcnt(0)
    v_cmp_ne_u32 vcc, 4, v3
    s_nop 0
    s_bitcmp1_b32 vcc_lo, 0
    s_cbranch_scc0 L_back4
    s_add_u32 s79, s79, 1
    s_cmp_lt_u32 s79, 0x8000
    s_cbranch_scc1 L_spinl4
    s_branch L_back4
L_spin5:
    s_mov_b32 s79, 0
L_spinl5:
    s_sleep 2
    v_mov_b32 v3, 0
    buffer_atomic_add v3, v30, s[12:15], s88 offen sc0 sc1
    s_waitcnt vmcnt(0)
    v_cmp_ne_u32 vcc, 4, v3
    s_nop 0
    s_bitcmp1_b32 vcc_lo, 0
    s_cbranch_scc0 L_back5
    s_add_u32 s79, s79, 1
    s_cmp_lt_u32 s79, 0x8000
    s_cbranch_scc1 L_spinl5
    s_branch L_back5
L_spin6:
    s_mov_b32 s79, 0
L_spinl6:
    s_sleep 2
    buffer_load_dword v19, v18, s[24:27], 0 offen sc1
    s_waitcnt vmcnt(0)
    v_cmp_ne_u32 vcc, 1, v19
    s_cbranch_vccz L_back6
    s_add_u32 s79, s79, 1
    s_cmp_lt_u32 s79, 0x8000
    s_cbranch_scc1 L_spinl6
    s_branch L_back6
L_spin7:
    s_mov_b32 s79, 0
L_spinl7:
    s_sleep 2
    buffer_load_dword v22, v23, s[12:15], 0 offen sc1
    s_waitcnt vmcnt(0)
    v_cmp_ne_u32 vcc, 1, v22
    s_cbranch_vccz L_back7
    s_add_u32 s79, s79, 1
    s_cmp_lt_u32 s79, 0x8000
    s_cbranch_scc1 L_spinl7
    s_branch L_back7
L_spin8:
    s_mov_b32 s79, 0
L_spinl8:
    s_sleep 2
    v_mov_b32 v3, 0
    buffer_atomic_add v3, v30, s[12:15], s88 offen sc0 sc1
    s_waitcnt vmcnt(0)
    v_cmp_ne_u32 vcc, 4, v3
    s_nop 0
    s_bitcmp1_b32 vcc_lo, 0
    s_cbranch_scc0 L_back8
    s_add_u32 s79, s79, 1
    s_cmp_lt_u32 s79, 0x8000
    s_cbranch_scc1 L_spinl8
    s_branch L_back8
L_spin9:
    s_mov_b32 s79, 0
L_spinl9:
    s_sleep 2
    v_mov_b32 v6, 0
    buffer_atomic_add v6, v30, s[12:15], s47 offen sc0 sc1
    s_waitcnt vmcnt(0)
    v_cmp_ne_u32 vcc, 16, v6
    s_nop 0
    s_bitcmp1_b32 vcc_lo, 0
    s_cbranch_scc0 L_back9
    s_add_u32 s79, s79, 1
    s_cmp_lt_u32 s79, 0x8000
    s_cbranch_scc1 L_spinl9
    s_branch L_back9
L_spin10:
    s_mov_b32 s79, 0
L_spinl10:
    s_sleep 2
    v_mov_b32 v3, 0
    buffer_atomic_add v3, v30, s[12:15], s88 offen sc0 sc1
    s_waitcnt vmcnt(0)
    v_cmp_ne_u32 vcc, 4, v3
    s_nop 0
    s_bitcmp1_b32 vcc_lo, 0
    s_cbranch_scc0 L_back10
    s_add_u32 s79, s79, 1
    s_cmp_lt_u32 s79, 0x8000
    s_cbranch_scc1 L_spinl10
    s_branch L_back10
L_spin11:
    s_mov_b32 s79, 0
L_spinl11:
    s_sleep 2
    v_mov_b32 v3, 0
    buffer_atomic_add v3, v30, s[12:15], s88 offen sc0 sc1
    s_waitcnt vmcnt(0)
    v_cmp_ne_u32 vcc, 4, v3
    s_nop 0
    s_bitcmp1_b32 vcc_lo, 0
    s_cbranch_scc0 L_back11
    s_add_u32 s79, s79, 1
    s_cmp_lt_u32 s79, 0x8000
    s_cbranch_scc1 L_spinl11
    s_branch L_back11
L_spin12:
    s_mov_b32 s79, 0
L_spinl12:
    s_sleep 2
    v_mov_b32 v3, 0
    buffer_atomic_add v3, v30, s[12:15], s88 offen sc0 sc1
    s_waitcnt vmcnt(0)
    v_cmp_ne_u32 vcc, 4, v3
    s_nop 0
    s_bitcmp1_b32 vcc_lo, 0
    s_cbranch_scc0 L_back12
    s_add_u32 s79, s79, 1
    s_cmp_lt_u32 s79, 0x8000
    s_cbranch_scc1 L_spinl12
    s_branch L_back12
    s_endpgm
.p2align 7
.type L_tab,@object
L_tab:
.long 10485760, 10486784, 10487808, 10488832, 10489856, 10874880, 10875904, 10876928
.long 10877952, 10878976, 11264000, 11265024, 11266048, 11267072, 11268096, 11653120
.long 11654144, 11655168, 11656192, 11657216, 12042240, 12043264, 12044288, 12045312
.long 12046336, 12431360, 12432384, 12433408, 12434432, 12435456, 12820480, 12821504
.long 12822528, 12823552, 12824576, 13209600, 13210624, 13211648, 13212672, 13213696
.size L_tab, .-L_tab
L_codeend:
.section .rodata,"a"
.p2align 6
.amdhsa_kernel parallel_sum__linear_attn_block__dense_activation_silu__prompt_kernel
  .amdhsa_next_free_vgpr 512
  .amdhsa_next_free_sgpr 102
  .amdhsa_accum_offset 256
  .amdhsa_group_segment_fixed_size 0
  .amdhsa_kernarg_size 72
  .amdhsa_user_sgpr_count 2
  .amdhsa_user_sgpr_kernarg_segment_ptr 1
  .amdhsa_system_sgpr_workgroup_id_x 1
  .amdhsa_float_denorm_mode_32 3
.end_amdhsa_kernel
```
